```python
import torch

def _softmax(x, axis=-1):
    return torch.softmax(x, dim=axis)
def _gelu(x):
    return torch.nn.functional.gelu(x, approximate="tanh")
def _silu(x):
    return torch.nn.functional.silu(x)
def _sigmoid(x):
    return torch.sigmoid(x)
def _layernorm(x, axis=-1, eps=1e-5):
    m = x.mean(dim=axis, keepdim=True)
    v = x.var(dim=axis, keepdim=True, unbiased=False)
    return (x - m) / torch.sqrt(v + eps)
def _scatter_add(tgt, idx, src, axis=0):
    return tgt.clone().index_add_(axis, idx, src)
def _segment_sum(src, seg, n):
    out = torch.zeros((n,) + src.shape[1:], dtype=src.dtype)
    return out.index_add_(0, seg, src)
def _pad(x, pw):
    flat = tuple(v for pair in reversed(pw) for v in pair)
    return torch.nn.functional.pad(x, flat)

kernel_name = 'standalone__mixer_channel_mlp__prompt'

def setup_inputs():

    _w = (lambda a: (lambda t: t.to(torch.bfloat16) if t.is_floating_point() else t)(torch.as_tensor(a)))
    B, S, D, F = 1, 2048, 1024, 3584
    return {
        "x": _w((lambda *s: torch.randn(*s, dtype=torch.bfloat16) * 0.05)(B, S, D)),
        "w1": _w((lambda *s: torch.randn(*s, dtype=torch.bfloat16) * 0.8)(D, F) * (D ** -0.5)),
        "b1": _w((lambda *s: torch.randn(*s, dtype=torch.bfloat16) * 0.4)(F)),
        "w2": _w((lambda *s: torch.randn(*s, dtype=torch.bfloat16) * 0.05)(F, D) * (F ** -0.5)),
        "b2": _w((lambda *s: torch.randn(*s, dtype=torch.bfloat16) * 0.05)(D)),
    }

def reference(x, w1, b1, w2, b2):
    y = _layernorm(x, axis=-1)
    h = _gelu(torch.einsum("bsd,df->bsf", y, w1) + b1)
    return torch.einsum("bsf,fd->bsd", h, w2) + b2
```

```asm
; @launch grid=(256,1,1) block=(512,1,1) lds=163840
.amdgcn_target "amdgcn-amd-amdhsa--gfx950"
.text
.globl standalone__mixer_channel_mlp__prompt_kernel
.p2align 8
.type standalone__mixer_channel_mlp__prompt_kernel,@function
standalone__mixer_channel_mlp__prompt_kernel:
    s_cmp_ge_u32 s2, 256
    s_cbranch_scc1 L_end
    s_load_dwordx16 s[4:19], s[0:1], 0
    v_lshrrev_b32 v1, 6, v0
    v_and_b32 v254, 63, v0
    v_readfirstlane_b32 s3, v1
    s_lshr_b32 s56, s2, 1
    s_and_b32 s56, s56, 3
    s_lshl_b32 s56, s56, 2
    s_lshr_b32 s60, s2, 6
    s_add_u32 s56, s56, s60
    s_and_b32 s58, s2, 1
    s_lshr_b32 s57, s2, 3
    s_and_b32 s57, s57, 7
    s_lshl_b32 s59, s58, 3
    s_add_u32 s59, s59, s57
    s_lshl_b32 s99, s56, 4
    s_add_u32 s99, s99, s59
    s_cmp_lt_u32 s3, 4
    s_cbranch_scc1 L_compute
    s_cmp_ge_u32 s3, 6
    s_cbranch_scc1 L_service
    s_and_b32 s61, s3, 1
    v_lshrrev_b32 v1, 3, v254
    v_and_b32 v2, 7, v254
    v_xor_b32 v2, v2, v1
    v_lshlrev_b32 v2, 4, v2
    v_lshl_add_u32 v2, v1, 11, v2
    s_lshl_b32 s62, s56, 18
    s_lshl_b32 s63, s61, 17
    s_add_u32 s62, s62, s63
    s_add_u32 s63, s62, 0
    v_add_u32 v8, s63, v2
    s_add_u32 s63, s62, 15360
    v_add_u32 v9, s63, v2
    s_add_u32 s63, s62, 30720
    v_add_u32 v10, s63, v2
    s_add_u32 s63, s62, 46080
    v_add_u32 v11, s63, v2
    s_add_u32 s63, s62, 65536
    v_add_u32 v12, s63, v2
    s_add_u32 s63, s62, 80896
    v_add_u32 v13, s63, v2
    s_add_u32 s63, s62, 96256
    v_add_u32 v14, s63, v2
    s_add_u32 s63, s62, 111616
    v_add_u32 v15, s63, v2
    s_mul_i32 s62, s61, 229376
    s_mul_i32 s63, s59, 448
    s_add_u32 s62, s62, s63
    s_lshl_b32 s64, s61, 13
    s_mul_i32 s65, s61, 14336
    s_add_u32 s65, s65, 16384
    s_and_b32 s70, s56, 14
    s_mov_b32 s74, 0
    s_waitcnt lgkmcnt(0)
    s_mov_b32 s20, s4
    s_mov_b32 s21, s5
    s_mov_b32 s22, 4194304
    s_mov_b32 s23, 0x20000
    s_mov_b32 s24, s6
    s_mov_b32 s25, s7
    s_mov_b32 s26, 7340032
    s_mov_b32 s27, 0x20000
    s_xor_b32 s67, s70, s74
    s_lshl_b32 s66, s67, 7
    s_mul_i32 s67, s67, 458752
    s_add_u32 s70, s70, 1
    s_and_b32 s70, s70, 15
    s_add_u32 m0, s64, 0
    s_nop 0
    buffer_load_dwordx4 v8, s[20:23], s66 offen offset:0 lds
    buffer_load_dwordx4 v9, s[20:23], s66 offen offset:1024 lds
    buffer_load_dwordx4 v10, s[20:23], s66 offen offset:2048 lds
    buffer_load_dwordx4 v11, s[20:23], s66 offen offset:3072 lds
    s_add_u32 m0, s64, 4096
    s_nop 0
    buffer_load_dwordx4 v12, s[20:23], s66 offen offset:0 lds
    buffer_load_dwordx4 v13, s[20:23], s66 offen offset:1024 lds
    buffer_load_dwordx4 v14, s[20:23], s66 offen offset:2048 lds
    buffer_load_dwordx4 v15, s[20:23], s66 offen offset:3072 lds
    v_add_u32 v1, 0, v254
    v_mul_u32_u24 v2, 2341, v1
    v_lshrrev_b32 v2, 16, v2
    v_mul_u32_u24 v3, 28, v2
    v_sub_u32 v3, v1, v3
    v_lshrrev_b32 v4, 2, v2
    v_and_b32 v4, 2, v4
    v_xor_b32 v3, v3, v4
    v_mul_u32_u24 v2, 7168, v2
    v_lshl_add_u32 v2, v3, 4, v2
    v_add_u32 v2, s62, v2
    v_mov_b32 v16, v2
    v_add_u32 v23, 111616, v2
    s_add_u32 m0, s65, 0
    s_nop 0
    buffer_load_dwordx4 v16, s[24:27], s67 offen offset:0 lds
    s_add_u32 m0, s65, 4096
    s_nop 0
    buffer_load_dwordx4 v23, s[24:27], s67 offen offset:3072 lds
    v_add_u32 v1, 64, v254
    v_mul_u32_u24 v2, 2341, v1
    v_lshrrev_b32 v2, 16, v2
    v_mul_u32_u24 v3, 28, v2
    v_sub_u32 v3, v1, v3
    v_lshrrev_b32 v4, 2, v2
    v_and_b32 v4, 2, v4
    v_xor_b32 v3, v3, v4
    v_mul_u32_u24 v2, 7168, v2
    v_lshl_add_u32 v2, v3, 4, v2
    v_add_u32 v2, s62, v2
    v_subrev_u32 v17, 1024, v2
    v_add_u32 v24, 114688, v2
    s_add_u32 m0, s65, 0
    s_nop 0
    buffer_load_dwordx4 v17, s[24:27], s67 offen offset:1024 lds
    s_add_u32 m0, s65, 8192
    s_nop 0
    buffer_load_dwordx4 v24, s[24:27], s67 offen offset:0 lds
    v_add_u32 v1, 128, v254
    v_mul_u32_u24 v2, 2341, v1
    v_lshrrev_b32 v2, 16, v2
    v_mul_u32_u24 v3, 28, v2
    v_sub_u32 v3, v1, v3
    v_lshrrev_b32 v4, 2, v2
    v_and_b32 v4, 2, v4
    v_xor_b32 v3, v3, v4
    v_mul_u32_u24 v2, 7168, v2
    v_lshl_add_u32 v2, v3, 4, v2
    v_add_u32 v2, s62, v2
    v_subrev_u32 v18, 2048, v2
    v_add_u32 v25, 113664, v2
    s_add_u32 m0, s65, 0
    s_nop 0
    buffer_load_dwordx4 v18, s[24:27], s67 offen offset:2048 lds
    s_add_u32 m0, s65, 8192
    s_nop 0
    buffer_load_dwordx4 v25, s[24:27], s67 offen offset:1024 lds
    v_add_u32 v1, 192, v254
    v_mul_u32_u24 v2, 2341, v1
    v_lshrrev_b32 v2, 16, v2
    v_mul_u32_u24 v3, 28, v2
    v_sub_u32 v3, v1, v3
    v_lshrrev_b32 v4, 2, v2
    v_and_b32 v4, 2, v4
    v_xor_b32 v3, v3, v4
    v_mul_u32_u24 v2, 7168, v2
    v_lshl_add_u32 v2, v3, 4, v2
    v_add_u32 v2, s62, v2
    v_subrev_u32 v19, 3072, v2
    v_add_u32 v26, 112640, v2
    s_add_u32 m0, s65, 0
    s_nop 0
    buffer_load_dwordx4 v19, s[24:27], s67 offen offset:3072 lds
    s_add_u32 m0, s65, 8192
    s_nop 0
    buffer_load_dwordx4 v26, s[24:27], s67 offen offset:2048 lds
    v_add_u32 v1, 256, v254
    v_mul_u32_u24 v2, 2341, v1
    v_lshrrev_b32 v2, 16, v2
    v_mul_u32_u24 v3, 28, v2
    v_sub_u32 v3, v1, v3
    v_lshrrev_b32 v4, 2, v2
    v_and_b32 v4, 2, v4
    v_xor_b32 v3, v3, v4
    v_mul_u32_u24 v2, 7168, v2
    v_lshl_add_u32 v2, v3, 4, v2
    v_add_u32 v2, s62, v2
    v_mov_b32 v20, v2
    v_add_u32 v27, 111616, v2
    s_add_u32 m0, s65, 4096
    s_nop 0
    buffer_load_dwordx4 v20, s[24:27], s67 offen offset:0 lds
    s_add_u32 m0, s65, 8192
    s_nop 0
    buffer_load_dwordx4 v27, s[24:27], s67 offen offset:3072 lds
    v_add_u32 v1, 320, v254
    v_mul_u32_u24 v2, 2341, v1
    v_lshrrev_b32 v2, 16, v2
    v_mul_u32_u24 v3, 28, v2
    v_sub_u32 v3, v1, v3
    v_lshrrev_b32 v4, 2, v2
    v_and_b32 v4, 2, v4
    v_xor_b32 v3, v3, v4
    v_mul_u32_u24 v2, 7168, v2
    v_lshl_add_u32 v2, v3, 4, v2
    v_add_u32 v2, s62, v2
    v_subrev_u32 v21, 1024, v2
    v_add_u32 v28, 114688, v2
    s_add_u32 m0, s65, 4096
    s_nop 0
    buffer_load_dwordx4 v21, s[24:27], s67 offen offset:1024 lds
    s_add_u32 m0, s65, 12288
    s_nop 0
    buffer_load_dwordx4 v28, s[24:27], s67 offen offset:0 lds
    v_add_u32 v1, 384, v254
    v_mul_u32_u24 v2, 2341, v1
    v_lshrrev_b32 v2, 16, v2
    v_mul_u32_u24 v3, 28, v2
    v_sub_u32 v3, v1, v3
    v_lshrrev_b32 v4, 2, v2
    v_and_b32 v4, 2, v4
    v_xor_b32 v3, v3, v4
    v_mul_u32_u24 v2, 7168, v2
    v_lshl_add_u32 v2, v3, 4, v2
    v_add_u32 v2, s62, v2
    v_subrev_u32 v22, 2048, v2
    v_add_u32 v29, 113664, v2
    s_add_u32 m0, s65, 4096
    s_nop 0
    buffer_load_dwordx4 v22, s[24:27], s67 offen offset:2048 lds
    s_add_u32 m0, s65, 12288
    s_nop 0
    buffer_load_dwordx4 v29, s[24:27], s67 offen offset:1024 lds
    s_barrier
    s_mov_b32 s28, s10
    s_mov_b32 s29, s11
    s_mov_b32 s30, 7340032
    s_mov_b32 s31, 0x20000
    s_add_u32 s32, s18, 67108864
    s_addc_u32 s33, s19, 0
    s_mov_b32 s34, 33554432
    s_mov_b32 s35, 0x20000
    s_add_u32 s40, s18, 16777216
    s_addc_u32 s41, s19, 0
    s_mov_b32 s42, 18874368
    s_mov_b32 s43, 0x20000
    v_min_u32 v3, 55, v254
    v_lshlrev_b32 v32, 7, v3
    s_lshl_b32 s68, s2, 2
    s_lshl_b32 s69, s61, 1
    s_add_u32 s68, s68, s69
    s_mul_i32 s68, s68, 7168
    s_add_u32 s69, s68, 7168
    s_lshr_b32 s96, s3, 1
    s_and_b32 s96, s96, 1
    s_lshl_b32 s97, s96, 12
    s_mov_b32 s60, s57
    s_lshl_b32 s63, s58, 3
    s_add_u32 s76, s60, s63
    s_and_b32 s62, s56, 3
    s_add_u32 s62, s62, 0
    s_cmp_ge_u32 s62, 7
    s_cselect_b32 s63, 7, 0
    s_sub_u32 s62, s62, s63
    s_cmp_ge_u32 s62, s57
    s_addc_u32 s60, s62, 0
    s_lshl_b32 s63, s58, 3
    s_add_u32 s77, s60, s63
    s_and_b32 s62, s56, 3
    s_add_u32 s62, s62, 1
    s_cmp_ge_u32 s62, 7
    s_cselect_b32 s63, 7, 0
    s_sub_u32 s62, s62, s63
    s_cmp_ge_u32 s62, s57
    s_addc_u32 s60, s62, 0
    s_lshl_b32 s63, s58, 3
    s_add_u32 s78, s60, s63
    s_and_b32 s62, s56, 3
    s_add_u32 s62, s62, 2
    s_cmp_ge_u32 s62, 7
    s_cselect_b32 s63, 7, 0
    s_sub_u32 s62, s62, s63
    s_cmp_ge_u32 s62, s57
    s_addc_u32 s60, s62, 0
    s_lshl_b32 s63, s58, 3
    s_add_u32 s79, s60, s63
    s_and_b32 s62, s56, 3
    s_add_u32 s62, s62, 3
    s_cmp_ge_u32 s62, 7
    s_cselect_b32 s63, 7, 0
    s_sub_u32 s62, s62, s63
    s_cmp_ge_u32 s62, s57
    s_addc_u32 s60, s62, 0
    s_lshl_b32 s63, s58, 3
    s_add_u32 s80, s60, s63
    s_and_b32 s62, s56, 3
    s_add_u32 s62, s62, 4
    s_cmp_ge_u32 s62, 7
    s_cselect_b32 s63, 7, 0
    s_sub_u32 s62, s62, s63
    s_cmp_ge_u32 s62, s57
    s_addc_u32 s60, s62, 0
    s_lshl_b32 s63, s58, 3
    s_add_u32 s81, s60, s63
    s_and_b32 s62, s56, 3
    s_add_u32 s62, s62, 5
    s_cmp_ge_u32 s62, 7
    s_cselect_b32 s63, 7, 0
    s_sub_u32 s62, s62, s63
    s_cmp_ge_u32 s62, s57
    s_addc_u32 s60, s62, 0
    s_lshl_b32 s63, s58, 3
    s_add_u32 s82, s60, s63
    s_and_b32 s62, s56, 3
    s_add_u32 s62, s62, 6
    s_cmp_ge_u32 s62, 7
    s_cselect_b32 s63, 7, 0
    s_sub_u32 s62, s62, s63
    s_cmp_ge_u32 s62, s57
    s_addc_u32 s60, s62, 0
    s_lshl_b32 s63, s58, 3
    s_add_u32 s83, s60, s63
    s_and_b32 s100, s99, 0xf8
    s_lshl_b32 s100, s100, 9
    s_add_u32 s100, s100, 8912896
    s_lshl_b32 s101, s99, 9
    s_add_u32 s101, s101, 8912896
    v_mov_b32 v208, 0
    v_mov_b32 v209, 0
    v_mov_b32 v210, 0
    v_mov_b32 v211, 0
    v_mov_b32 v212, 0
    v_mov_b32 v213, 0
    v_mov_b32 v214, 0
    v_mov_b32 v215, 0
    v_mov_b32 v216, 0
    v_mov_b32 v217, 0
    v_mov_b32 v218, 0
    v_mov_b32 v219, 0
    v_mov_b32 v220, 0
    v_mov_b32 v221, 0
    v_mov_b32 v222, 0
    v_mov_b32 v223, 0
    v_mov_b32 v224, 0
    v_mov_b32 v225, 0
    v_mov_b32 v226, 0
    v_mov_b32 v227, 0
    s_and_b32 s60, s3, 1
    s_cmp_eq_u32 s60, 0
    s_cbranch_scc1 L_ssAd
    s_lshl_b32 s62, s96, 15
    s_lshl_b32 s63, s57, 8
    s_add_u32 s62, s62, s63
    v_lshrrev_b32 v216, 4, v254
    v_add_u32 v216, 0, v216
    v_and_b32 v217, 7, v216
    v_lshlrev_b32 v217, 1, v217
    v_and_b32 v218, 15, v254
    v_xor_b32 v217, v217, v218
    v_lshlrev_b32 v216, 11, v216
    v_lshl_add_u32 v216, v217, 4, v216
    s_sub_u32 s63, s62, 0
    v_add_u32 v208, s63, v216
    v_lshrrev_b32 v216, 4, v254
    v_add_u32 v216, 4, v216
    v_and_b32 v217, 7, v216
    v_lshlrev_b32 v217, 1, v217
    v_and_b32 v218, 15, v254
    v_xor_b32 v217, v217, v218
    v_lshlrev_b32 v216, 11, v216
    v_lshl_add_u32 v216, v217, 4, v216
    s_sub_u32 s63, s62, 1024
    v_add_u32 v209, s63, v216
    v_lshrrev_b32 v216, 4, v254
    v_add_u32 v216, 8, v216
    v_and_b32 v217, 7, v216
    v_lshlrev_b32 v217, 1, v217
    v_and_b32 v218, 15, v254
    v_xor_b32 v217, v217, v218
    v_lshlrev_b32 v216, 11, v216
    v_lshl_add_u32 v216, v217, 4, v216
    s_sub_u32 s63, s62, 2048
    v_add_u32 v210, s63, v216
    v_lshrrev_b32 v216, 4, v254
    v_add_u32 v216, 12, v216
    v_and_b32 v217, 7, v216
    v_lshlrev_b32 v217, 1, v217
    v_and_b32 v218, 15, v254
    v_xor_b32 v217, v217, v218
    v_lshlrev_b32 v216, 11, v216
    v_lshl_add_u32 v216, v217, 4, v216
    s_sub_u32 s63, s62, 3072
    v_add_u32 v211, s63, v216
    v_and_b32 v212, 7, v254
    v_lshlrev_b32 v212, 9, v212
    v_and_b32 v216, 8, v254
    v_lshl_add_u32 v212, v216, 4, v212
    v_add_u32 v214, 131072, v212
    s_mul_i32 s76, s76, 458752
    s_mul_i32 s77, s77, 458752
    s_mul_i32 s78, s78, 458752
    s_mul_i32 s79, s79, 458752
    s_mul_i32 s80, s80, 458752
    s_mul_i32 s81, s81, 458752
    s_mul_i32 s82, s82, 458752
    s_mul_i32 s83, s83, 458752
    s_branch L_ssEd
L_ssAd:
    v_lshrrev_b32 v226, 3, v254
    v_lshlrev_b32 v226, 2, v226
    s_mov_b32 s60, 2083038417
    v_lshrrev_b32 v226, v226, s60
    v_and_b32 v226, 15, v226
    v_and_b32 v224, 7, v254
    v_lshlrev_b32 v224, 4, v224
    v_lshl_add_u32 v224, v226, 7, v224
    v_lshrrev_b32 v226, 3, v254
    v_lshlrev_b32 v226, 2, v226
    s_mov_b32 s60, 2825359589
    v_lshrrev_b32 v226, v226, s60
    v_and_b32 v226, 15, v226
    v_and_b32 v225, 7, v254
    v_lshlrev_b32 v225, 4, v225
    v_lshl_add_u32 v225, v226, 7, v225
    s_cmp_eq_u32 s96, 0
    s_cselect_b64 vcc, -1, 0
    s_lshl_b32 s60, s96, 13
    v_cndmask_b32 v216, v225, v224, vcc
    v_cndmask_b32 v217, v224, v225, vcc
    v_add_u32 v216, s60, v216
    v_add_u32 v217, s60, v217
    v_add_u32 v208, 0, v216
    v_add_u32 v209, 1024, v217
    v_add_u32 v210, 2048, v217
    v_add_u32 v211, 3072, v216
    v_add_u32 v212, 0, v217
    v_add_u32 v213, 1024, v216
    v_add_u32 v214, 2048, v216
    v_add_u32 v215, 3072, v217
    s_lshl_b32 s60, s96, 16
    v_add_u32 v218, s60, v224
    v_add_u32 v219, s60, v225
    v_lshlrev_b32 v220, 4, v254
    s_lshl_b32 s60, s96, 15
    v_add_u32 v221, s60, v220
    v_add_u32 v220, s97, v220
    v_and_b32 v222, 7, v254
    v_lshlrev_b32 v222, 9, v222
    s_lshl_b32 s60, s96, 7
    v_mov_b32 v223, s60
    v_mov_b32 v224, 1
    v_mov_b32 v225, 0
    v_add_u32 v227, 131072, v223
    s_lshl_b32 s60, s56, 4
    s_add_u32 s76, s76, s60
    s_lshl_b32 s76, s76, 17
    s_add_u32 s77, s77, s60
    s_lshl_b32 s77, s77, 17
    s_add_u32 s78, s78, s60
    s_lshl_b32 s78, s78, 17
    s_add_u32 s79, s79, s60
    s_lshl_b32 s79, s79, 17
    s_add_u32 s80, s80, s60
    s_lshl_b32 s80, s80, 17
    s_add_u32 s81, s81, s60
    s_lshl_b32 s81, s81, 17
    s_add_u32 s82, s82, s60
    s_lshl_b32 s82, s82, 17
    s_add_u32 s83, s83, s60
    s_lshl_b32 s83, s83, 17
L_ssEd:
    s_xor_b32 s67, s70, s74
    s_lshl_b32 s66, s67, 7
    s_mul_i32 s67, s67, 458752
    s_add_u32 s70, s70, 1
    s_and_b32 s70, s70, 15
    s_add_u32 m0, s65, 45056
    s_nop 0
    buffer_load_dwordx4 v16, s[24:27], s67 offen offset:0 lds
    buffer_load_dwordx4 v17, s[24:27], s67 offen offset:1024 lds
    buffer_load_dwordx4 v18, s[24:27], s67 offen offset:2048 lds
    buffer_load_dwordx4 v19, s[24:27], s67 offen offset:3072 lds
    s_add_u32 m0, s64, 45056
    s_nop 0
    buffer_load_dwordx4 v8, s[20:23], s66 offen offset:0 lds
    buffer_load_dwordx4 v9, s[20:23], s66 offen offset:1024 lds
    buffer_load_dwordx4 v10, s[20:23], s66 offen offset:2048 lds
    buffer_load_dwordx4 v11, s[20:23], s66 offen offset:3072 lds
    s_add_u32 m0, s65, 49152
    s_nop 0
    buffer_load_dwordx4 v20, s[24:27], s67 offen offset:0 lds
    buffer_load_dwordx4 v21, s[24:27], s67 offen offset:1024 lds
    buffer_load_dwordx4 v22, s[24:27], s67 offen offset:2048 lds
    buffer_load_dwordx4 v23, s[24:27], s67 offen offset:3072 lds
    s_add_u32 m0, s64, 49152
    s_nop 0
    buffer_load_dwordx4 v12, s[20:23], s66 offen offset:0 lds
    buffer_load_dwordx4 v13, s[20:23], s66 offen offset:1024 lds
    s_waitcnt vmcnt(14)
    s_barrier
    buffer_load_dwordx4 v14, s[20:23], s66 offen offset:2048 lds
    buffer_load_dwordx4 v15, s[20:23], s66 offen offset:3072 lds
    s_add_u32 m0, s65, 53248
    s_nop 0
    buffer_load_dwordx4 v24, s[24:27], s67 offen offset:0 lds
    buffer_load_dwordx4 v25, s[24:27], s67 offen offset:1024 lds
    buffer_load_dwordx4 v26, s[24:27], s67 offen offset:2048 lds
    buffer_load_dwordx4 v27, s[24:27], s67 offen offset:3072 lds
    s_add_u32 m0, s65, 57344
    s_nop 0
    buffer_load_dwordx4 v28, s[24:27], s67 offen offset:0 lds
    buffer_load_dwordx4 v29, s[24:27], s67 offen offset:1024 lds
    s_xor_b32 s67, s70, s74
    s_lshl_b32 s66, s67, 7
    s_mul_i32 s67, s67, 458752
    s_add_u32 s70, s70, 1
    s_and_b32 s70, s70, 15
    s_add_u32 m0, s65, 90112
    s_nop 0
    buffer_load_dwordx4 v16, s[24:27], s67 offen offset:0 lds
    buffer_load_dwordx4 v17, s[24:27], s67 offen offset:1024 lds
    buffer_load_dwordx4 v18, s[24:27], s67 offen offset:2048 lds
    buffer_load_dwordx4 v19, s[24:27], s67 offen offset:3072 lds
    s_add_u32 m0, s64, 90112
    s_nop 0
    buffer_load_dwordx4 v8, s[20:23], s66 offen offset:0 lds
    buffer_load_dwordx4 v9, s[20:23], s66 offen offset:1024 lds
    buffer_load_dwordx4 v10, s[20:23], s66 offen offset:2048 lds
    buffer_load_dwordx4 v11, s[20:23], s66 offen offset:3072 lds
    s_add_u32 m0, s65, 94208
    s_nop 0
    buffer_load_dwordx4 v20, s[24:27], s67 offen offset:0 lds
    buffer_load_dwordx4 v21, s[24:27], s67 offen offset:1024 lds
    buffer_load_dwordx4 v22, s[24:27], s67 offen offset:2048 lds
    buffer_load_dwordx4 v23, s[24:27], s67 offen offset:3072 lds
    s_add_u32 m0, s64, 94208
    s_nop 0
    buffer_load_dwordx4 v12, s[20:23], s66 offen offset:0 lds
    buffer_load_dwordx4 v13, s[20:23], s66 offen offset:1024 lds
    s_waitcnt vmcnt(14)
    s_barrier
    buffer_load_dwordx4 v14, s[20:23], s66 offen offset:2048 lds
    buffer_load_dwordx4 v15, s[20:23], s66 offen offset:3072 lds
    s_add_u32 m0, s65, 98304
    s_nop 0
    buffer_load_dwordx4 v24, s[24:27], s67 offen offset:0 lds
    buffer_load_dwordx4 v25, s[24:27], s67 offen offset:1024 lds
    buffer_load_dwordx4 v26, s[24:27], s67 offen offset:2048 lds
    buffer_load_dwordx4 v27, s[24:27], s67 offen offset:3072 lds
    s_add_u32 m0, s65, 102400
    s_nop 0
    buffer_load_dwordx4 v28, s[24:27], s67 offen offset:0 lds
    buffer_load_dwordx4 v29, s[24:27], s67 offen offset:1024 lds
    s_xor_b32 s67, s70, s74
    s_lshl_b32 s66, s67, 7
    s_mul_i32 s67, s67, 458752
    s_add_u32 s70, s70, 1
    s_and_b32 s70, s70, 15
    s_add_u32 m0, s65, 0
    s_nop 0
    buffer_load_dwordx4 v16, s[24:27], s67 offen offset:0 lds
    buffer_load_dwordx4 v17, s[24:27], s67 offen offset:1024 lds
    buffer_load_dwordx4 v18, s[24:27], s67 offen offset:2048 lds
    buffer_load_dwordx4 v19, s[24:27], s67 offen offset:3072 lds
    s_add_u32 m0, s64, 0
    s_nop 0
    buffer_load_dwordx4 v8, s[20:23], s66 offen offset:0 lds
    buffer_load_dwordx4 v9, s[20:23], s66 offen offset:1024 lds
    buffer_load_dwordx4 v10, s[20:23], s66 offen offset:2048 lds
    buffer_load_dwordx4 v11, s[20:23], s66 offen offset:3072 lds
    s_add_u32 m0, s65, 4096
    s_nop 0
    buffer_load_dwordx4 v20, s[24:27], s67 offen offset:0 lds
    buffer_load_dwordx4 v21, s[24:27], s67 offen offset:1024 lds
    buffer_load_dwordx4 v22, s[24:27], s67 offen offset:2048 lds
    buffer_load_dwordx4 v23, s[24:27], s67 offen offset:3072 lds
    s_add_u32 m0, s64, 4096
    s_nop 0
    buffer_load_dwordx4 v12, s[20:23], s66 offen offset:0 lds
    buffer_load_dwordx4 v13, s[20:23], s66 offen offset:1024 lds
    buffer_load_dwordx4 v14, s[20:23], s66 offen offset:2048 lds
    buffer_load_dwordx4 v15, s[20:23], s66 offen offset:3072 lds
    s_waitcnt vmcnt(16)
    s_barrier
    s_add_u32 m0, s65, 8192
    s_nop 0
    buffer_load_dwordx4 v24, s[24:27], s67 offen offset:0 lds
    buffer_load_dwordx4 v25, s[24:27], s67 offen offset:1024 lds
    buffer_load_dwordx4 v26, s[24:27], s67 offen offset:2048 lds
    buffer_load_dwordx4 v27, s[24:27], s67 offen offset:3072 lds
    s_add_u32 m0, s65, 12288
    s_nop 0
    buffer_load_dwordx4 v28, s[24:27], s67 offen offset:0 lds
    buffer_load_dwordx4 v29, s[24:27], s67 offen offset:1024 lds
    s_xor_b32 s67, s70, s74
    s_lshl_b32 s66, s67, 7
    s_mul_i32 s67, s67, 458752
    s_add_u32 s70, s70, 1
    s_and_b32 s70, s70, 15
    s_add_u32 m0, s65, 45056
    s_nop 0
    buffer_load_dwordx4 v16, s[24:27], s67 offen offset:0 lds
    buffer_load_dwordx4 v17, s[24:27], s67 offen offset:1024 lds
    buffer_load_dwordx4 v18, s[24:27], s67 offen offset:2048 lds
    buffer_load_dwordx4 v19, s[24:27], s67 offen offset:3072 lds
    s_add_u32 m0, s64, 45056
    s_nop 0
    buffer_load_dwordx4 v8, s[20:23], s66 offen offset:0 lds
    buffer_load_dwordx4 v9, s[20:23], s66 offen offset:1024 lds
    buffer_load_dwordx4 v10, s[20:23], s66 offen offset:2048 lds
    buffer_load_dwordx4 v11, s[20:23], s66 offen offset:3072 lds
    s_add_u32 m0, s65, 49152
    s_nop 0
    buffer_load_dwordx4 v20, s[24:27], s67 offen offset:0 lds
    buffer_load_dwordx4 v21, s[24:27], s67 offen offset:1024 lds
    buffer_load_dwordx4 v22, s[24:27], s67 offen offset:2048 lds
    buffer_load_dwordx4 v23, s[24:27], s67 offen offset:3072 lds
    s_add_u32 m0, s64, 49152
    s_nop 0
    buffer_load_dwordx4 v12, s[20:23], s66 offen offset:0 lds
    buffer_load_dwordx4 v13, s[20:23], s66 offen offset:1024 lds
    buffer_load_dwordx4 v14, s[20:23], s66 offen offset:2048 lds
    buffer_load_dwordx4 v15, s[20:23], s66 offen offset:3072 lds
    s_add_u32 m0, s65, 53248
    s_nop 0
    buffer_load_dwordx4 v24, s[24:27], s67 offen offset:0 lds
    buffer_load_dwordx4 v25, s[24:27], s67 offen offset:1024 lds
    s_waitcnt vmcnt(18)
    s_barrier
    buffer_load_dwordx4 v26, s[24:27], s67 offen offset:2048 lds
    buffer_load_dwordx4 v27, s[24:27], s67 offen offset:3072 lds
    s_add_u32 m0, s65, 57344
    s_nop 0
    buffer_load_dwordx4 v28, s[24:27], s67 offen offset:0 lds
    buffer_load_dwordx4 v29, s[24:27], s67 offen offset:1024 lds
    s_xor_b32 s67, s70, s74
    s_lshl_b32 s66, s67, 7
    s_mul_i32 s67, s67, 458752
    s_add_u32 s70, s70, 1
    s_and_b32 s70, s70, 15
    s_add_u32 m0, s65, 90112
    s_nop 0
    buffer_load_dwordx4 v16, s[24:27], s67 offen offset:0 lds
    buffer_load_dwordx4 v17, s[24:27], s67 offen offset:1024 lds
    buffer_load_dwordx4 v18, s[24:27], s67 offen offset:2048 lds
    buffer_load_dwordx4 v19, s[24:27], s67 offen offset:3072 lds
    s_add_u32 m0, s64, 90112
    s_nop 0
    buffer_load_dwordx4 v8, s[20:23], s66 offen offset:0 lds
    buffer_load_dwordx4 v9, s[20:23], s66 offen offset:1024 lds
    buffer_load_dwordx4 v10, s[20:23], s66 offen offset:2048 lds
    buffer_load_dwordx4 v11, s[20:23], s66 offen offset:3072 lds
    s_add_u32 m0, s65, 94208
    s_nop 0
    buffer_load_dwordx4 v20, s[24:27], s67 offen offset:0 lds
    buffer_load_dwordx4 v21, s[24:27], s67 offen offset:1024 lds
    buffer_load_dwordx4 v22, s[24:27], s67 offen offset:2048 lds
    buffer_load_dwordx4 v23, s[24:27], s67 offen offset:3072 lds
    s_add_u32 m0, s64, 94208
    s_nop 0
    buffer_load_dwordx4 v12, s[20:23], s66 offen offset:0 lds
    buffer_load_dwordx4 v13, s[20:23], s66 offen offset:1024 lds
    buffer_load_dwordx4 v14, s[20:23], s66 offen offset:2048 lds
    buffer_load_dwordx4 v15, s[20:23], s66 offen offset:3072 lds
    s_add_u32 m0, s65, 98304
    s_nop 0
    buffer_load_dwordx4 v24, s[24:27], s67 offen offset:0 lds
    buffer_load_dwordx4 v25, s[24:27], s67 offen offset:1024 lds
    buffer_load_dwordx4 v26, s[24:27], s67 offen offset:2048 lds
    buffer_load_dwordx4 v27, s[24:27], s67 offen offset:3072 lds
    s_waitcnt vmcnt(20)
    s_barrier
    s_add_u32 m0, s65, 102400
    s_nop 0
    buffer_load_dwordx4 v28, s[24:27], s67 offen offset:0 lds
    buffer_load_dwordx4 v29, s[24:27], s67 offen offset:1024 lds
    s_xor_b32 s67, s70, s74
    s_lshl_b32 s66, s67, 7
    s_mul_i32 s67, s67, 458752
    s_add_u32 s70, s70, 1
    s_and_b32 s70, s70, 15
    s_add_u32 m0, s65, 0
    s_nop 0
    buffer_load_dwordx4 v16, s[24:27], s67 offen offset:0 lds
    buffer_load_dwordx4 v17, s[24:27], s67 offen offset:1024 lds
    buffer_load_dwordx4 v18, s[24:27], s67 offen offset:2048 lds
    buffer_load_dwordx4 v19, s[24:27], s67 offen offset:3072 lds
    s_add_u32 m0, s64, 0
    s_nop 0
    buffer_load_dwordx4 v8, s[20:23], s66 offen offset:0 lds
    buffer_load_dwordx4 v9, s[20:23], s66 offen offset:1024 lds
    buffer_load_dwordx4 v10, s[20:23], s66 offen offset:2048 lds
    buffer_load_dwordx4 v11, s[20:23], s66 offen offset:3072 lds
    s_add_u32 m0, s65, 4096
    s_nop 0
    buffer_load_dwordx4 v20, s[24:27], s67 offen offset:0 lds
    buffer_load_dwordx4 v21, s[24:27], s67 offen offset:1024 lds
    buffer_load_dwordx4 v22, s[24:27], s67 offen offset:2048 lds
    buffer_load_dwordx4 v23, s[24:27], s67 offen offset:3072 lds
    s_add_u32 m0, s64, 4096
    s_nop 0
    buffer_load_dwordx4 v12, s[20:23], s66 offen offset:0 lds
    buffer_load_dwordx4 v13, s[20:23], s66 offen offset:1024 lds
    buffer_load_dwordx4 v14, s[20:23], s66 offen offset:2048 lds
    buffer_load_dwordx4 v15, s[20:23], s66 offen offset:3072 lds
    s_add_u32 m0, s65, 8192
    s_nop 0
    buffer_load_dwordx4 v24, s[24:27], s67 offen offset:0 lds
    buffer_load_dwordx4 v25, s[24:27], s67 offen offset:1024 lds
    buffer_load_dwordx4 v26, s[24:27], s67 offen offset:2048 lds
    buffer_load_dwordx4 v27, s[24:27], s67 offen offset:3072 lds
    s_add_u32 m0, s65, 12288
    s_nop 0
    buffer_load_dwordx4 v28, s[24:27], s67 offen offset:0 lds
    buffer_load_dwordx4 v29, s[24:27], s67 offen offset:1024 lds
    s_waitcnt vmcnt(22)
    s_barrier
    s_xor_b32 s67, s70, s74
    s_lshl_b32 s66, s67, 7
    s_mul_i32 s67, s67, 458752
    s_add_u32 s70, s70, 1
    s_and_b32 s70, s70, 15
    s_add_u32 m0, s65, 45056
    s_nop 0
    buffer_load_dwordx4 v16, s[24:27], s67 offen offset:0 lds
    buffer_load_dwordx4 v17, s[24:27], s67 offen offset:1024 lds
    buffer_load_dwordx4 v18, s[24:27], s67 offen offset:2048 lds
    buffer_load_dwordx4 v19, s[24:27], s67 offen offset:3072 lds
    s_add_u32 m0, s64, 45056
    s_nop 0
    buffer_load_dwordx4 v8, s[20:23], s66 offen offset:0 lds
    buffer_load_dwordx4 v9, s[20:23], s66 offen offset:1024 lds
    buffer_load_dwordx4 v10, s[20:23], s66 offen offset:2048 lds
    buffer_load_dwordx4 v11, s[20:23], s66 offen offset:3072 lds
    s_add_u32 m0, s65, 49152
    s_nop 0
    buffer_load_dwordx4 v20, s[24:27], s67 offen offset:0 lds
    buffer_load_dwordx4 v21, s[24:27], s67 offen offset:1024 lds
    buffer_load_dwordx4 v22, s[24:27], s67 offen offset:2048 lds
    buffer_load_dwordx4 v23, s[24:27], s67 offen offset:3072 lds
    s_add_u32 m0, s64, 49152
    s_nop 0
    buffer_load_dwordx4 v12, s[20:23], s66 offen offset:0 lds
    buffer_load_dwordx4 v13, s[20:23], s66 offen offset:1024 lds
    buffer_load_dwordx4 v14, s[20:23], s66 offen offset:2048 lds
    buffer_load_dwordx4 v15, s[20:23], s66 offen offset:3072 lds
    s_add_u32 m0, s65, 53248
    s_nop 0
    buffer_load_dwordx4 v24, s[24:27], s67 offen offset:0 lds
    buffer_load_dwordx4 v25, s[24:27], s67 offen offset:1024 lds
    buffer_load_dwordx4 v26, s[24:27], s67 offen offset:2048 lds
    buffer_load_dwordx4 v27, s[24:27], s67 offen offset:3072 lds
    s_add_u32 m0, s65, 57344
    s_nop 0
    buffer_load_dwordx4 v28, s[24:27], s67 offen offset:0 lds
    buffer_load_dwordx4 v29, s[24:27], s67 offen offset:1024 lds
    s_waitcnt vmcnt(22)
    s_barrier
    s_xor_b32 s67, s70, s74
    s_lshl_b32 s66, s67, 7
    s_mul_i32 s67, s67, 458752
    s_add_u32 s70, s70, 1
    s_and_b32 s70, s70, 15
    s_add_u32 m0, s65, 90112
    s_nop 0
    buffer_load_dwordx4 v16, s[24:27], s67 offen offset:0 lds
    buffer_load_dwordx4 v17, s[24:27], s67 offen offset:1024 lds
    buffer_load_dwordx4 v18, s[24:27], s67 offen offset:2048 lds
    buffer_load_dwordx4 v19, s[24:27], s67 offen offset:3072 lds
    s_add_u32 m0, s64, 90112
    s_nop 0
    buffer_load_dwordx4 v8, s[20:23], s66 offen offset:0 lds
    buffer_load_dwordx4 v9, s[20:23], s66 offen offset:1024 lds
    buffer_load_dwordx4 v10, s[20:23], s66 offen offset:2048 lds
    buffer_load_dwordx4 v11, s[20:23], s66 offen offset:3072 lds
    s_add_u32 m0, s65, 94208
    s_nop 0
    buffer_load_dwordx4 v20, s[24:27], s67 offen offset:0 lds
    buffer_load_dwordx4 v21, s[24:27], s67 offen offset:1024 lds
    buffer_load_dwordx4 v22, s[24:27], s67 offen offset:2048 lds
    buffer_load_dwordx4 v23, s[24:27], s67 offen offset:3072 lds
    s_add_u32 m0, s64, 94208
    s_nop 0
    buffer_load_dwordx4 v12, s[20:23], s66 offen offset:0 lds
    buffer_load_dwordx4 v13, s[20:23], s66 offen offset:1024 lds
    buffer_load_dwordx4 v14, s[20:23], s66 offen offset:2048 lds
    buffer_load_dwordx4 v15, s[20:23], s66 offen offset:3072 lds
    s_add_u32 m0, s65, 98304
    s_nop 0
    buffer_load_dwordx4 v24, s[24:27], s67 offen offset:0 lds
    buffer_load_dwordx4 v25, s[24:27], s67 offen offset:1024 lds
    buffer_load_dwordx4 v26, s[24:27], s67 offen offset:2048 lds
    buffer_load_dwordx4 v27, s[24:27], s67 offen offset:3072 lds
    s_add_u32 m0, s65, 102400
    s_nop 0
    buffer_load_dwordx4 v28, s[24:27], s67 offen offset:0 lds
    buffer_load_dwordx4 v29, s[24:27], s67 offen offset:1024 lds
    s_waitcnt vmcnt(22)
    s_barrier
    s_xor_b32 s67, s70, s74
    s_lshl_b32 s66, s67, 7
    s_mul_i32 s67, s67, 458752
    s_add_u32 s70, s70, 1
    s_and_b32 s70, s70, 15
    s_add_u32 m0, s65, 0
    s_nop 0
    buffer_load_dwordx4 v16, s[24:27], s67 offen offset:0 lds
    buffer_load_dwordx4 v17, s[24:27], s67 offen offset:1024 lds
    buffer_load_dwordx4 v18, s[24:27], s67 offen offset:2048 lds
    buffer_load_dwordx4 v19, s[24:27], s67 offen offset:3072 lds
    s_add_u32 m0, s64, 0
    s_nop 0
    buffer_load_dwordx4 v8, s[20:23], s66 offen offset:0 lds
    buffer_load_dwordx4 v9, s[20:23], s66 offen offset:1024 lds
    buffer_load_dwordx4 v10, s[20:23], s66 offen offset:2048 lds
    buffer_load_dwordx4 v11, s[20:23], s66 offen offset:3072 lds
    s_add_u32 m0, s65, 4096
    s_nop 0
    buffer_load_dwordx4 v20, s[24:27], s67 offen offset:0 lds
    buffer_load_dwordx4 v21, s[24:27], s67 offen offset:1024 lds
    buffer_load_dwordx4 v22, s[24:27], s67 offen offset:2048 lds
    buffer_load_dwordx4 v23, s[24:27], s67 offen offset:3072 lds
    s_add_u32 m0, s64, 4096
    s_nop 0
    buffer_load_dwordx4 v12, s[20:23], s66 offen offset:0 lds
    buffer_load_dwordx4 v13, s[20:23], s66 offen offset:1024 lds
    buffer_load_dwordx4 v14, s[20:23], s66 offen offset:2048 lds
    buffer_load_dwordx4 v15, s[20:23], s66 offen offset:3072 lds
    s_add_u32 m0, s65, 8192
    s_nop 0
    buffer_load_dwordx4 v24, s[24:27], s67 offen offset:0 lds
    buffer_load_dwordx4 v25, s[24:27], s67 offen offset:1024 lds
    buffer_load_dwordx4 v26, s[24:27], s67 offen offset:2048 lds
    buffer_load_dwordx4 v27, s[24:27], s67 offen offset:3072 lds
    s_add_u32 m0, s65, 12288
    s_nop 0
    buffer_load_dwordx4 v28, s[24:27], s67 offen offset:0 lds
    buffer_load_dwordx4 v29, s[24:27], s67 offen offset:1024 lds
    s_waitcnt vmcnt(22)
    s_barrier
    s_xor_b32 s67, s70, s74
    s_lshl_b32 s66, s67, 7
    s_mul_i32 s67, s67, 458752
    s_add_u32 s70, s70, 1
    s_and_b32 s70, s70, 15
    s_add_u32 m0, s65, 45056
    s_nop 0
    buffer_load_dwordx4 v16, s[24:27], s67 offen offset:0 lds
    buffer_load_dwordx4 v17, s[24:27], s67 offen offset:1024 lds
    buffer_load_dwordx4 v18, s[24:27], s67 offen offset:2048 lds
    buffer_load_dwordx4 v19, s[24:27], s67 offen offset:3072 lds
    s_add_u32 m0, s64, 45056
    s_nop 0
    buffer_load_dwordx4 v8, s[20:23], s66 offen offset:0 lds
    buffer_load_dwordx4 v9, s[20:23], s66 offen offset:1024 lds
    buffer_load_dwordx4 v10, s[20:23], s66 offen offset:2048 lds
    buffer_load_dwordx4 v11, s[20:23], s66 offen offset:3072 lds
    s_add_u32 m0, s65, 49152
    s_nop 0
    buffer_load_dwordx4 v20, s[24:27], s67 offen offset:0 lds
    buffer_load_dwordx4 v21, s[24:27], s67 offen offset:1024 lds
    buffer_load_dwordx4 v22, s[24:27], s67 offen offset:2048 lds
    buffer_load_dwordx4 v23, s[24:27], s67 offen offset:3072 lds
    s_add_u32 m0, s64, 49152
    s_nop 0
    buffer_load_dwordx4 v12, s[20:23], s66 offen offset:0 lds
    buffer_load_dwordx4 v13, s[20:23], s66 offen offset:1024 lds
    buffer_load_dwordx4 v14, s[20:23], s66 offen offset:2048 lds
    buffer_load_dwordx4 v15, s[20:23], s66 offen offset:3072 lds
    s_add_u32 m0, s65, 53248
    s_nop 0
    buffer_load_dwordx4 v24, s[24:27], s67 offen offset:0 lds
    buffer_load_dwordx4 v25, s[24:27], s67 offen offset:1024 lds
    buffer_load_dwordx4 v26, s[24:27], s67 offen offset:2048 lds
    buffer_load_dwordx4 v27, s[24:27], s67 offen offset:3072 lds
    s_add_u32 m0, s65, 57344
    s_nop 0
    buffer_load_dwordx4 v28, s[24:27], s67 offen offset:0 lds
    buffer_load_dwordx4 v29, s[24:27], s67 offen offset:1024 lds
    s_waitcnt vmcnt(22)
    s_barrier
    s_xor_b32 s67, s70, s74
    s_lshl_b32 s66, s67, 7
    s_mul_i32 s67, s67, 458752
    s_add_u32 s70, s70, 1
    s_and_b32 s70, s70, 15
    s_add_u32 m0, s65, 90112
    s_nop 0
    buffer_load_dwordx4 v16, s[24:27], s67 offen offset:0 lds
    buffer_load_dwordx4 v17, s[24:27], s67 offen offset:1024 lds
    buffer_load_dwordx4 v18, s[24:27], s67 offen offset:2048 lds
    buffer_load_dwordx4 v19, s[24:27], s67 offen offset:3072 lds
    s_add_u32 m0, s64, 90112
    s_nop 0
    buffer_load_dwordx4 v8, s[20:23], s66 offen offset:0 lds
    buffer_load_dwordx4 v9, s[20:23], s66 offen offset:1024 lds
    buffer_load_dwordx4 v10, s[20:23], s66 offen offset:2048 lds
    buffer_load_dwordx4 v11, s[20:23], s66 offen offset:3072 lds
    s_add_u32 m0, s65, 94208
    s_nop 0
    buffer_load_dwordx4 v20, s[24:27], s67 offen offset:0 lds
    buffer_load_dwordx4 v21, s[24:27], s67 offen offset:1024 lds
    buffer_load_dwordx4 v22, s[24:27], s67 offen offset:2048 lds
    buffer_load_dwordx4 v23, s[24:27], s67 offen offset:3072 lds
    s_add_u32 m0, s64, 94208
    s_nop 0
    buffer_load_dwordx4 v12, s[20:23], s66 offen offset:0 lds
    buffer_load_dwordx4 v13, s[20:23], s66 offen offset:1024 lds
    buffer_load_dwordx4 v14, s[20:23], s66 offen offset:2048 lds
    buffer_load_dwordx4 v15, s[20:23], s66 offen offset:3072 lds
    s_add_u32 m0, s65, 98304
    s_nop 0
    buffer_load_dwordx4 v24, s[24:27], s67 offen offset:0 lds
    buffer_load_dwordx4 v25, s[24:27], s67 offen offset:1024 lds
    buffer_load_dwordx4 v26, s[24:27], s67 offen offset:2048 lds
    buffer_load_dwordx4 v27, s[24:27], s67 offen offset:3072 lds
    s_add_u32 m0, s65, 102400
    s_nop 0
    buffer_load_dwordx4 v28, s[24:27], s67 offen offset:0 lds
    buffer_load_dwordx4 v29, s[24:27], s67 offen offset:1024 lds
    s_waitcnt vmcnt(22)
    s_barrier
    s_xor_b32 s67, s70, s74
    s_lshl_b32 s66, s67, 7
    s_mul_i32 s67, s67, 458752
    s_add_u32 s70, s70, 1
    s_and_b32 s70, s70, 15
    s_add_u32 m0, s65, 0
    s_nop 0
    buffer_load_dwordx4 v16, s[24:27], s67 offen offset:0 lds
    buffer_load_dwordx4 v17, s[24:27], s67 offen offset:1024 lds
    buffer_load_dwordx4 v18, s[24:27], s67 offen offset:2048 lds
    buffer_load_dwordx4 v19, s[24:27], s67 offen offset:3072 lds
    s_add_u32 m0, s64, 0
    s_nop 0
    buffer_load_dwordx4 v8, s[20:23], s66 offen offset:0 lds
    buffer_load_dwordx4 v9, s[20:23], s66 offen offset:1024 lds
    buffer_load_dwordx4 v10, s[20:23], s66 offen offset:2048 lds
    buffer_load_dwordx4 v11, s[20:23], s66 offen offset:3072 lds
    s_add_u32 m0, s65, 4096
    s_nop 0
    buffer_load_dwordx4 v20, s[24:27], s67 offen offset:0 lds
    buffer_load_dwordx4 v21, s[24:27], s67 offen offset:1024 lds
    buffer_load_dwordx4 v22, s[24:27], s67 offen offset:2048 lds
    buffer_load_dwordx4 v23, s[24:27], s67 offen offset:3072 lds
    s_add_u32 m0, s64, 4096
    s_nop 0
    buffer_load_dwordx4 v12, s[20:23], s66 offen offset:0 lds
    buffer_load_dwordx4 v13, s[20:23], s66 offen offset:1024 lds
    buffer_load_dwordx4 v14, s[20:23], s66 offen offset:2048 lds
    buffer_load_dwordx4 v15, s[20:23], s66 offen offset:3072 lds
    s_add_u32 m0, s65, 8192
    s_nop 0
    buffer_load_dwordx4 v24, s[24:27], s67 offen offset:0 lds
    buffer_load_dwordx4 v25, s[24:27], s67 offen offset:1024 lds
    buffer_load_dwordx4 v26, s[24:27], s67 offen offset:2048 lds
    buffer_load_dwordx4 v27, s[24:27], s67 offen offset:3072 lds
    s_add_u32 m0, s65, 12288
    s_nop 0
    buffer_load_dwordx4 v28, s[24:27], s67 offen offset:0 lds
    buffer_load_dwordx4 v29, s[24:27], s67 offen offset:1024 lds
    s_waitcnt vmcnt(22)
    s_barrier
    s_xor_b32 s67, s70, s74
    s_lshl_b32 s66, s67, 7
    s_mul_i32 s67, s67, 458752
    s_add_u32 s70, s70, 1
    s_and_b32 s70, s70, 15
    s_add_u32 m0, s65, 45056
    s_nop 0
    buffer_load_dwordx4 v16, s[24:27], s67 offen offset:0 lds
    buffer_load_dwordx4 v17, s[24:27], s67 offen offset:1024 lds
    buffer_load_dwordx4 v18, s[24:27], s67 offen offset:2048 lds
    buffer_load_dwordx4 v19, s[24:27], s67 offen offset:3072 lds
    s_add_u32 m0, s64, 45056
    s_nop 0
    buffer_load_dwordx4 v8, s[20:23], s66 offen offset:0 lds
    buffer_load_dwordx4 v9, s[20:23], s66 offen offset:1024 lds
    buffer_load_dwordx4 v10, s[20:23], s66 offen offset:2048 lds
    buffer_load_dwordx4 v11, s[20:23], s66 offen offset:3072 lds
    s_add_u32 m0, s65, 49152
    s_nop 0
    buffer_load_dwordx4 v20, s[24:27], s67 offen offset:0 lds
    buffer_load_dwordx4 v21, s[24:27], s67 offen offset:1024 lds
    buffer_load_dwordx4 v22, s[24:27], s67 offen offset:2048 lds
    buffer_load_dwordx4 v23, s[24:27], s67 offen offset:3072 lds
    s_add_u32 m0, s64, 49152
    s_nop 0
    buffer_load_dwordx4 v12, s[20:23], s66 offen offset:0 lds
    buffer_load_dwordx4 v13, s[20:23], s66 offen offset:1024 lds
    buffer_load_dwordx4 v14, s[20:23], s66 offen offset:2048 lds
    buffer_load_dwordx4 v15, s[20:23], s66 offen offset:3072 lds
    s_add_u32 m0, s65, 53248
    s_nop 0
    buffer_load_dwordx4 v24, s[24:27], s67 offen offset:0 lds
    buffer_load_dwordx4 v25, s[24:27], s67 offen offset:1024 lds
    buffer_load_dwordx4 v26, s[24:27], s67 offen offset:2048 lds
    buffer_load_dwordx4 v27, s[24:27], s67 offen offset:3072 lds
    s_add_u32 m0, s65, 57344
    s_nop 0
    buffer_load_dwordx4 v28, s[24:27], s67 offen offset:0 lds
    buffer_load_dwordx4 v29, s[24:27], s67 offen offset:1024 lds
    s_waitcnt vmcnt(22)
    s_barrier
    s_xor_b32 s67, s70, s74
    s_lshl_b32 s66, s67, 7
    s_mul_i32 s67, s67, 458752
    s_add_u32 s70, s70, 1
    s_and_b32 s70, s70, 15
    s_add_u32 m0, s65, 90112
    s_nop 0
    buffer_load_dwordx4 v16, s[24:27], s67 offen offset:0 lds
    buffer_load_dwordx4 v17, s[24:27], s67 offen offset:1024 lds
    buffer_load_dwordx4 v18, s[24:27], s67 offen offset:2048 lds
    buffer_load_dwordx4 v19, s[24:27], s67 offen offset:3072 lds
    s_add_u32 m0, s64, 90112
    s_nop 0
    buffer_load_dwordx4 v8, s[20:23], s66 offen offset:0 lds
    buffer_load_dwordx4 v9, s[20:23], s66 offen offset:1024 lds
    buffer_load_dwordx4 v10, s[20:23], s66 offen offset:2048 lds
    buffer_load_dwordx4 v11, s[20:23], s66 offen offset:3072 lds
    s_add_u32 m0, s65, 94208
    s_nop 0
    buffer_load_dwordx4 v20, s[24:27], s67 offen offset:0 lds
    buffer_load_dwordx4 v21, s[24:27], s67 offen offset:1024 lds
    buffer_load_dwordx4 v22, s[24:27], s67 offen offset:2048 lds
    buffer_load_dwordx4 v23, s[24:27], s67 offen offset:3072 lds
    s_add_u32 m0, s64, 94208
    s_nop 0
    buffer_load_dwordx4 v12, s[20:23], s66 offen offset:0 lds
    buffer_load_dwordx4 v13, s[20:23], s66 offen offset:1024 lds
    buffer_load_dwordx4 v14, s[20:23], s66 offen offset:2048 lds
    buffer_load_dwordx4 v15, s[20:23], s66 offen offset:3072 lds
    s_add_u32 m0, s65, 98304
    s_nop 0
    buffer_load_dwordx4 v24, s[24:27], s67 offen offset:0 lds
    buffer_load_dwordx4 v25, s[24:27], s67 offen offset:1024 lds
    buffer_load_dwordx4 v26, s[24:27], s67 offen offset:2048 lds
    buffer_load_dwordx4 v27, s[24:27], s67 offen offset:3072 lds
    s_add_u32 m0, s65, 102400
    s_nop 0
    buffer_load_dwordx4 v28, s[24:27], s67 offen offset:0 lds
    buffer_load_dwordx4 v29, s[24:27], s67 offen offset:1024 lds
    s_waitcnt vmcnt(22)
    s_barrier
    s_xor_b32 s67, s70, s74
    s_lshl_b32 s66, s67, 7
    s_mul_i32 s67, s67, 458752
    s_add_u32 s70, s70, 1
    s_and_b32 s70, s70, 15
    s_add_u32 m0, s65, 0
    s_nop 0
    buffer_load_dwordx4 v16, s[24:27], s67 offen offset:0 lds
    buffer_load_dwordx4 v17, s[24:27], s67 offen offset:1024 lds
    buffer_load_dwordx4 v18, s[24:27], s67 offen offset:2048 lds
    buffer_load_dwordx4 v19, s[24:27], s67 offen offset:3072 lds
    s_add_u32 m0, s64, 0
    s_nop 0
    buffer_load_dwordx4 v8, s[20:23], s66 offen offset:0 lds
    buffer_load_dwordx4 v9, s[20:23], s66 offen offset:1024 lds
    buffer_load_dwordx4 v10, s[20:23], s66 offen offset:2048 lds
    buffer_load_dwordx4 v11, s[20:23], s66 offen offset:3072 lds
    s_add_u32 m0, s65, 4096
    s_nop 0
    buffer_load_dwordx4 v20, s[24:27], s67 offen offset:0 lds
    buffer_load_dwordx4 v21, s[24:27], s67 offen offset:1024 lds
    buffer_load_dwordx4 v22, s[24:27], s67 offen offset:2048 lds
    buffer_load_dwordx4 v23, s[24:27], s67 offen offset:3072 lds
    s_add_u32 m0, s64, 4096
    s_nop 0
    buffer_load_dwordx4 v12, s[20:23], s66 offen offset:0 lds
    buffer_load_dwordx4 v13, s[20:23], s66 offen offset:1024 lds
    buffer_load_dwordx4 v14, s[20:23], s66 offen offset:2048 lds
    buffer_load_dwordx4 v15, s[20:23], s66 offen offset:3072 lds
    s_add_u32 m0, s65, 8192
    s_nop 0
    buffer_load_dwordx4 v24, s[24:27], s67 offen offset:0 lds
    buffer_load_dwordx4 v25, s[24:27], s67 offen offset:1024 lds
    buffer_load_dwordx4 v26, s[24:27], s67 offen offset:2048 lds
    buffer_load_dwordx4 v27, s[24:27], s67 offen offset:3072 lds
    s_add_u32 m0, s65, 12288
    s_nop 0
    buffer_load_dwordx4 v28, s[24:27], s67 offen offset:0 lds
    buffer_load_dwordx4 v29, s[24:27], s67 offen offset:1024 lds
    s_waitcnt vmcnt(22)
    s_barrier
    s_waitcnt vmcnt(0)
    s_barrier
    s_cmp_eq_u32 s3, 4
    s_cbranch_scc1 L_streamA
    s_branch L_streamB
L_service:
    s_and_b32 s61, s3, 1
    v_lshrrev_b32 v1, 4, v254
    v_and_b32 v2, 15, v254
    v_lshlrev_b32 v2, 4, v2
    v_lshl_add_u32 v2, v1, 11, v2
    s_lshl_b32 s62, s99, 3
    s_lshl_b32 s63, s61, 2
    s_add_u32 s62, s62, s63
    s_lshl_b32 s64, s62, 11
    s_lshl_b32 s65, s62, 3
    s_add_u32 s65, s65, 8388608
    v_lshlrev_b32 v3, 3, v1
    v_lshrrev_b32 v4, 5, v254
    v_and_b32 v5, 31, v254
    v_min_u32 v5, 27, v5
    s_and_b32 s66, s56, 1
    s_mul_i32 s67, s66, 43
    s_lshr_b32 s67, s67, 7
    s_mul_i32 s67, s67, 3
    s_sub_u32 s67, s66, s67
    s_mul_i32 s67, s67, 45056
    s_mul_i32 s68, s61, 14336
    s_add_u32 s67, s67, s68
    s_add_u32 s67, s67, 16384
    v_mul_u32_u24 v6, 448, v4
    v_add_u32 v6, s67, v6
    v_xor_b32 v150, 2, v5
    v_lshl_add_u32 v150, v150, 4, v6
    v_lshl_add_u32 v6, v5, 4, v6
    v_lshlrev_b32 v7, 5, v5
    v_lshl_add_u32 v7, v4, 4, v7
    s_lshl_b32 s68, s59, 4
    s_add_u32 s69, s68, s56
    s_mul_i32 s69, s69, 896
    s_add_u32 s69, s69, 8454144
    s_mul_i32 s68, s68, 896
    s_add_u32 s68, s68, 8454144
    v_mov_b32 v112, -1
    v_mov_b32 v156, 0
    v_mov_b32 v113, -1
    v_mov_b32 v157, 0
    v_mov_b32 v114, -1
    v_mov_b32 v158, 0
    v_mov_b32 v115, -1
    v_mov_b32 v159, 0
    v_and_b32 v117, 31, v254
    v_lshlrev_b32 v117, 4, v117
    v_add_u32 v136, 158720, v7
    v_lshlrev_b32 v137, 2, v254
    v_min_u32 v144, 55, v254
    v_lshlrev_b32 v145, 4, v144
    v_add_u32 v146, 3584, v145
    v_add_u32 v147, 7168, v145
    v_add_u32 v148, 10752, v145
    v_lshlrev_b32 v160, 4, v254
    v_lshlrev_b32 v161, 3, v144
    s_lshl_b32 s71, s56, 10
    s_add_u32 s71, s71, 8388608
    s_mul_i32 s75, s59, 448
    v_and_b32 v152, 7, v254
    v_lshlrev_b32 v152, 7, v152
    s_waitcnt lgkmcnt(0)
    s_mov_b32 s20, s4
    s_mov_b32 s21, s5
    s_mov_b32 s22, 4194304
    s_mov_b32 s23, 0x20000
    s_add_u32 s40, s18, 16777216
    s_addc_u32 s41, s19, 0
    s_mov_b32 s42, 18874368
    s_mov_b32 s43, 0x20000
    s_mov_b32 s28, s10
    s_mov_b32 s29, s11
    s_mov_b32 s30, 7340032
    s_mov_b32 s31, 0x20000
    s_add_u32 s32, s18, 67108864
    s_addc_u32 s33, s19, 0
    s_mov_b32 s34, 33554432
    s_mov_b32 s35, 0x20000
    s_mov_b32 s44, s8
    s_mov_b32 s45, s9
    s_mov_b32 s46, 7168
    s_mov_b32 s47, 0x20000
    s_mov_b32 s52, s16
    s_mov_b32 s53, s17
    s_mov_b32 s54, 256
    s_mov_b32 s55, 0x20000
    s_mov_b32 s48, s12
    s_mov_b32 s49, s13
    s_mov_b32 s50, 2048
    s_mov_b32 s51, 0x20000
    v_and_b32 v189, 31, v254
    v_lshlrev_b32 v189, 3, v189
    s_lshl_b32 s98, s57, 8
    v_lshlrev_b32 v184, 7, v144
    s_lshl_b32 s74, s2, 2
    s_lshl_b32 s67, s61, 1
    s_add_u32 s74, s74, s67
    s_mul_i32 s74, s74, 7168
    s_add_u32 s67, s74, 7168
    s_barrier
    buffer_store_dwordx2 v[112:113], v3, s[40:43], s65 offen sc1
    s_cmp_eq_u32 s61, 0
    s_cbranch_scc1 L_sv_r0
    buffer_store_dwordx4 v[112:115], v7, s[40:43], s69 offen sc1
    s_branch L_sv_r1
L_sv_r0:
    s_lshl_b32 s70, s99, 9
    s_add_u32 s72, s70, 8912896
    buffer_store_dwordx4 v[156:159], v117, s[40:43], s72 offen sc1
    s_add_u32 s72, s70, 9175040
    buffer_store_dwordx4 v[156:159], v117, s[40:43], s72 offen sc1
    s_add_u32 s72, s70, 9043968
    buffer_store_dwordx4 v[156:159], v117, s[40:43], s72 offen sc1
L_sv_r1:
    s_lshr_b32 s96, s3, 1
    s_and_b32 s96, s96, 1
    s_lshl_b32 s97, s96, 12
    s_mov_b32 s60, s57
    s_lshl_b32 s63, s58, 3
    s_add_u32 s76, s60, s63
    s_and_b32 s62, s56, 3
    s_add_u32 s62, s62, 0
    s_cmp_ge_u32 s62, 7
    s_cselect_b32 s63, 7, 0
    s_sub_u32 s62, s62, s63
    s_cmp_ge_u32 s62, s57
    s_addc_u32 s60, s62, 0
    s_lshl_b32 s63, s58, 3
    s_add_u32 s77, s60, s63
    s_and_b32 s62, s56, 3
    s_add_u32 s62, s62, 1
    s_cmp_ge_u32 s62, 7
    s_cselect_b32 s63, 7, 0
    s_sub_u32 s62, s62, s63
    s_cmp_ge_u32 s62, s57
    s_addc_u32 s60, s62, 0
    s_lshl_b32 s63, s58, 3
    s_add_u32 s78, s60, s63
    s_and_b32 s62, s56, 3
    s_add_u32 s62, s62, 2
    s_cmp_ge_u32 s62, 7
    s_cselect_b32 s63, 7, 0
    s_sub_u32 s62, s62, s63
    s_cmp_ge_u32 s62, s57
    s_addc_u32 s60, s62, 0
    s_lshl_b32 s63, s58, 3
    s_add_u32 s79, s60, s63
    s_and_b32 s62, s56, 3
    s_add_u32 s62, s62, 3
    s_cmp_ge_u32 s62, 7
    s_cselect_b32 s63, 7, 0
    s_sub_u32 s62, s62, s63
    s_cmp_ge_u32 s62, s57
    s_addc_u32 s60, s62, 0
    s_lshl_b32 s63, s58, 3
    s_add_u32 s80, s60, s63
    s_and_b32 s62, s56, 3
    s_add_u32 s62, s62, 4
    s_cmp_ge_u32 s62, 7
    s_cselect_b32 s63, 7, 0
    s_sub_u32 s62, s62, s63
    s_cmp_ge_u32 s62, s57
    s_addc_u32 s60, s62, 0
    s_lshl_b32 s63, s58, 3
    s_add_u32 s81, s60, s63
    s_and_b32 s62, s56, 3
    s_add_u32 s62, s62, 5
    s_cmp_ge_u32 s62, 7
    s_cselect_b32 s63, 7, 0
    s_sub_u32 s62, s62, s63
    s_cmp_ge_u32 s62, s57
    s_addc_u32 s60, s62, 0
    s_lshl_b32 s63, s58, 3
    s_add_u32 s82, s60, s63
    s_and_b32 s62, s56, 3
    s_add_u32 s62, s62, 6
    s_cmp_ge_u32 s62, 7
    s_cselect_b32 s63, 7, 0
    s_sub_u32 s62, s62, s63
    s_cmp_ge_u32 s62, s57
    s_addc_u32 s60, s62, 0
    s_lshl_b32 s63, s58, 3
    s_add_u32 s83, s60, s63
    s_and_b32 s100, s99, 0xf8
    s_lshl_b32 s100, s100, 9
    s_add_u32 s100, s100, 8912896
    s_lshl_b32 s101, s99, 9
    s_add_u32 s101, s101, 8912896
    v_mov_b32 v208, 0
    v_mov_b32 v209, 0
    v_mov_b32 v210, 0
    v_mov_b32 v211, 0
    v_mov_b32 v212, 0
    v_mov_b32 v213, 0
    v_mov_b32 v214, 0
    v_mov_b32 v215, 0
    v_mov_b32 v216, 0
    v_mov_b32 v217, 0
    v_mov_b32 v218, 0
    v_mov_b32 v219, 0
    v_mov_b32 v220, 0
    v_mov_b32 v221, 0
    v_mov_b32 v222, 0
    v_mov_b32 v223, 0
    v_mov_b32 v224, 0
    v_mov_b32 v225, 0
    v_mov_b32 v226, 0
    v_mov_b32 v227, 0
    s_and_b32 s60, s3, 1
    s_cmp_eq_u32 s60, 0
    s_cbranch_scc1 L_ssAs
    s_lshl_b32 s62, s96, 15
    s_lshl_b32 s63, s57, 8
    s_add_u32 s62, s62, s63
    v_lshrrev_b32 v216, 4, v254
    v_add_u32 v216, 0, v216
    v_and_b32 v217, 7, v216
    v_lshlrev_b32 v217, 1, v217
    v_and_b32 v218, 15, v254
    v_xor_b32 v217, v217, v218
    v_lshlrev_b32 v216, 11, v216
    v_lshl_add_u32 v216, v217, 4, v216
    s_sub_u32 s63, s62, 0
    v_add_u32 v208, s63, v216
    v_lshrrev_b32 v216, 4, v254
    v_add_u32 v216, 4, v216
    v_and_b32 v217, 7, v216
    v_lshlrev_b32 v217, 1, v217
    v_and_b32 v218, 15, v254
    v_xor_b32 v217, v217, v218
    v_lshlrev_b32 v216, 11, v216
    v_lshl_add_u32 v216, v217, 4, v216
    s_sub_u32 s63, s62, 1024
    v_add_u32 v209, s63, v216
    v_lshrrev_b32 v216, 4, v254
    v_add_u32 v216, 8, v216
    v_and_b32 v217, 7, v216
    v_lshlrev_b32 v217, 1, v217
    v_and_b32 v218, 15, v254
    v_xor_b32 v217, v217, v218
    v_lshlrev_b32 v216, 11, v216
    v_lshl_add_u32 v216, v217, 4, v216
    s_sub_u32 s63, s62, 2048
    v_add_u32 v210, s63, v216
    v_lshrrev_b32 v216, 4, v254
    v_add_u32 v216, 12, v216
    v_and_b32 v217, 7, v216
    v_lshlrev_b32 v217, 1, v217
    v_and_b32 v218, 15, v254
    v_xor_b32 v217, v217, v218
    v_lshlrev_b32 v216, 11, v216
    v_lshl_add_u32 v216, v217, 4, v216
    s_sub_u32 s63, s62, 3072
    v_add_u32 v211, s63, v216
    v_and_b32 v212, 7, v254
    v_lshlrev_b32 v212, 9, v212
    v_and_b32 v216, 8, v254
    v_lshl_add_u32 v212, v216, 4, v212
    v_add_u32 v214, 131072, v212
    s_mul_i32 s76, s76, 458752
    s_mul_i32 s77, s77, 458752
    s_mul_i32 s78, s78, 458752
    s_mul_i32 s79, s79, 458752
    s_mul_i32 s80, s80, 458752
    s_mul_i32 s81, s81, 458752
    s_mul_i32 s82, s82, 458752
    s_mul_i32 s83, s83, 458752
    s_branch L_ssEs
L_ssAs:
    v_lshrrev_b32 v226, 3, v254
    v_lshlrev_b32 v226, 2, v226
    s_mov_b32 s60, 2083038417
    v_lshrrev_b32 v226, v226, s60
    v_and_b32 v226, 15, v226
    v_and_b32 v224, 7, v254
    v_lshlrev_b32 v224, 4, v224
    v_lshl_add_u32 v224, v226, 7, v224
    v_lshrrev_b32 v226, 3, v254
    v_lshlrev_b32 v226, 2, v226
    s_mov_b32 s60, 2825359589
    v_lshrrev_b32 v226, v226, s60
    v_and_b32 v226, 15, v226
    v_and_b32 v225, 7, v254
    v_lshlrev_b32 v225, 4, v225
    v_lshl_add_u32 v225, v226, 7, v225
    s_cmp_eq_u32 s96, 0
    s_cselect_b64 vcc, -1, 0
    s_lshl_b32 s60, s96, 13
    v_cndmask_b32 v216, v225, v224, vcc
    v_cndmask_b32 v217, v224, v225, vcc
    v_add_u32 v216, s60, v216
    v_add_u32 v217, s60, v217
    v_add_u32 v208, 0, v216
    v_add_u32 v209, 1024, v217
    v_add_u32 v210, 2048, v217
    v_add_u32 v211, 3072, v216
    v_add_u32 v212, 0, v217
    v_add_u32 v213, 1024, v216
    v_add_u32 v214, 2048, v216
    v_add_u32 v215, 3072, v217
    s_lshl_b32 s60, s96, 16
    v_add_u32 v218, s60, v224
    v_add_u32 v219, s60, v225
    v_lshlrev_b32 v220, 4, v254
    s_lshl_b32 s60, s96, 15
    v_add_u32 v221, s60, v220
    v_add_u32 v220, s97, v220
    v_and_b32 v222, 7, v254
    v_lshlrev_b32 v222, 9, v222
    s_lshl_b32 s60, s96, 7
    v_mov_b32 v223, s60
    v_mov_b32 v224, 1
    v_mov_b32 v225, 0
    v_add_u32 v227, 131072, v223
    s_lshl_b32 s60, s56, 4
    s_add_u32 s76, s76, s60
    s_lshl_b32 s76, s76, 17
    s_add_u32 s77, s77, s60
    s_lshl_b32 s77, s77, 17
    s_add_u32 s78, s78, s60
    s_lshl_b32 s78, s78, 17
    s_add_u32 s79, s79, s60
    s_lshl_b32 s79, s79, 17
    s_add_u32 s80, s80, s60
    s_lshl_b32 s80, s80, 17
    s_add_u32 s81, s81, s60
    s_lshl_b32 s81, s81, 17
    s_add_u32 s82, s82, s60
    s_lshl_b32 s82, s82, 17
    s_add_u32 s83, s83, s60
    s_lshl_b32 s83, s83, 17
L_ssEs:
    s_barrier
    s_cmp_eq_u32 s66, 0
    s_cbranch_scc0 L_sv_nc0
    ds_read_b128 v[40:43], v6 offset:0
    ds_read_b128 v[44:47], v6 offset:896
    ds_read_b128 v[48:51], v6 offset:1792
    ds_read_b128 v[52:55], v6 offset:2688
    ds_read_b128 v[56:59], v150 offset:3584
    ds_read_b128 v[60:63], v150 offset:4480
    ds_read_b128 v[64:67], v150 offset:5376
    ds_read_b128 v[68:71], v150 offset:6272
    ds_read_b128 v[72:75], v6 offset:7168
    ds_read_b128 v[76:79], v6 offset:8064
    ds_read_b128 v[80:83], v6 offset:8960
    ds_read_b128 v[84:87], v6 offset:9856
    ds_read_b128 v[88:91], v150 offset:10752
    ds_read_b128 v[92:95], v150 offset:11648
    ds_read_b128 v[96:99], v150 offset:12544
    ds_read_b128 v[100:103], v150 offset:13440
    s_waitcnt lgkmcnt(0)
L_sv_nc0:
    s_barrier
    s_waitcnt vmcnt(0)
    s_cmp_eq_u32 s66, 1
    s_cbranch_scc0 L_sv_nc1
    ds_read_b128 v[40:43], v6 offset:0
    ds_read_b128 v[44:47], v6 offset:896
    ds_read_b128 v[48:51], v6 offset:1792
    ds_read_b128 v[52:55], v6 offset:2688
    ds_read_b128 v[56:59], v150 offset:3584
    ds_read_b128 v[60:63], v150 offset:4480
    ds_read_b128 v[64:67], v150 offset:5376
    ds_read_b128 v[68:71], v150 offset:6272
    ds_read_b128 v[72:75], v6 offset:7168
    ds_read_b128 v[76:79], v6 offset:8064
    ds_read_b128 v[80:83], v6 offset:8960
    ds_read_b128 v[84:87], v6 offset:9856
    ds_read_b128 v[88:91], v150 offset:10752
    ds_read_b128 v[92:95], v150 offset:11648
    ds_read_b128 v[96:99], v150 offset:12544
    ds_read_b128 v[100:103], v150 offset:13440
    s_waitcnt lgkmcnt(0)
L_sv_nc1:
    buffer_load_dwordx4 v[8:11], v2, s[20:23], s64 offen offset:0
    buffer_load_dwordx4 v[12:15], v2, s[20:23], s64 offen offset:256
    buffer_load_dwordx4 v[16:19], v2, s[20:23], s64 offen offset:512
    buffer_load_dwordx4 v[20:23], v2, s[20:23], s64 offen offset:768
    buffer_load_dwordx4 v[24:27], v2, s[20:23], s64 offen offset:1024
    buffer_load_dwordx4 v[28:31], v2, s[20:23], s64 offen offset:1280
    buffer_load_dwordx4 v[32:35], v2, s[20:23], s64 offen offset:1536
    buffer_load_dwordx4 v[36:39], v2, s[20:23], s64 offen offset:1792
    s_barrier
    s_cmp_eq_u32 s61, 0
    s_cbranch_scc0 L_sv_nf
    s_and_b32 s70, s2, 63
    s_lshl_b32 s70, s70, 2
    s_add_u32 s72, s16, s70
    s_addc_u32 s73, s17, 0
    s_mov_b32 s70, 1
    s_atomic_add s70, s[72:73], 0
L_sv_nf:
    v_lshlrev_b32 v104, 16, v40
    v_and_b32 v105, 0xffff0000, v40
    v_lshlrev_b32 v106, 16, v41
    v_and_b32 v107, 0xffff0000, v41
    v_lshlrev_b32 v108, 16, v42
    v_and_b32 v109, 0xffff0000, v42
    v_lshlrev_b32 v110, 16, v43
    v_and_b32 v111, 0xffff0000, v43
    v_lshlrev_b32 v128, 16, v44
    v_and_b32 v129, 0xffff0000, v44
    v_add_f32 v104, v104, v128
    v_add_f32 v105, v105, v129
    v_lshlrev_b32 v128, 16, v45
    v_and_b32 v129, 0xffff0000, v45
    v_add_f32 v106, v106, v128
    v_add_f32 v107, v107, v129
    v_lshlrev_b32 v128, 16, v46
    v_and_b32 v129, 0xffff0000, v46
    v_add_f32 v108, v108, v128
    v_add_f32 v109, v109, v129
    v_lshlrev_b32 v128, 16, v47
    v_and_b32 v129, 0xffff0000, v47
    v_add_f32 v110, v110, v128
    v_add_f32 v111, v111, v129
    v_lshlrev_b32 v128, 16, v48
    v_and_b32 v129, 0xffff0000, v48
    v_add_f32 v104, v104, v128
    v_add_f32 v105, v105, v129
    v_lshlrev_b32 v128, 16, v49
    v_and_b32 v129, 0xffff0000, v49
    v_add_f32 v106, v106, v128
    v_add_f32 v107, v107, v129
    v_lshlrev_b32 v128, 16, v50
    v_and_b32 v129, 0xffff0000, v50
    v_add_f32 v108, v108, v128
    v_add_f32 v109, v109, v129
    v_lshlrev_b32 v128, 16, v51
    v_and_b32 v129, 0xffff0000, v51
    v_add_f32 v110, v110, v128
    v_add_f32 v111, v111, v129
    v_lshlrev_b32 v128, 16, v52
    v_and_b32 v129, 0xffff0000, v52
    v_add_f32 v104, v104, v128
    v_add_f32 v105, v105, v129
    v_lshlrev_b32 v128, 16, v53
    v_and_b32 v129, 0xffff0000, v53
    v_add_f32 v106, v106, v128
    v_add_f32 v107, v107, v129
    v_lshlrev_b32 v128, 16, v54
    v_and_b32 v129, 0xffff0000, v54
    v_add_f32 v108, v108, v128
    v_add_f32 v109, v109, v129
    v_lshlrev_b32 v128, 16, v55
    v_and_b32 v129, 0xffff0000, v55
    v_add_f32 v110, v110, v128
    v_add_f32 v111, v111, v129
    v_lshlrev_b32 v128, 16, v56
    v_and_b32 v129, 0xffff0000, v56
    v_add_f32 v104, v104, v128
    v_add_f32 v105, v105, v129
    v_lshlrev_b32 v128, 16, v57
    v_and_b32 v129, 0xffff0000, v57
    v_add_f32 v106, v106, v128
    v_add_f32 v107, v107, v129
    v_lshlrev_b32 v128, 16, v58
    v_and_b32 v129, 0xffff0000, v58
    v_add_f32 v108, v108, v128
    v_add_f32 v109, v109, v129
    s_barrier
    v_lshlrev_b32 v128, 16, v59
    v_and_b32 v129, 0xffff0000, v59
    v_add_f32 v110, v110, v128
    v_add_f32 v111, v111, v129
    v_lshlrev_b32 v128, 16, v60
    v_and_b32 v129, 0xffff0000, v60
    v_add_f32 v104, v104, v128
    v_add_f32 v105, v105, v129
    v_lshlrev_b32 v128, 16, v61
    v_and_b32 v129, 0xffff0000, v61
    v_add_f32 v106, v106, v128
    v_add_f32 v107, v107, v129
    v_lshlrev_b32 v128, 16, v62
    v_and_b32 v129, 0xffff0000, v62
    v_add_f32 v108, v108, v128
    v_add_f32 v109, v109, v129
    v_lshlrev_b32 v128, 16, v63
    v_and_b32 v129, 0xffff0000, v63
    v_add_f32 v110, v110, v128
    v_add_f32 v111, v111, v129
    v_lshlrev_b32 v128, 16, v64
    v_and_b32 v129, 0xffff0000, v64
    v_add_f32 v104, v104, v128
    v_add_f32 v105, v105, v129
    v_lshlrev_b32 v128, 16, v65
    v_and_b32 v129, 0xffff0000, v65
    v_add_f32 v106, v106, v128
    v_add_f32 v107, v107, v129
    v_lshlrev_b32 v128, 16, v66
    v_and_b32 v129, 0xffff0000, v66
    v_add_f32 v108, v108, v128
    v_add_f32 v109, v109, v129
    v_lshlrev_b32 v128, 16, v67
    v_and_b32 v129, 0xffff0000, v67
    v_add_f32 v110, v110, v128
    v_add_f32 v111, v111, v129
    v_lshlrev_b32 v128, 16, v68
    v_and_b32 v129, 0xffff0000, v68
    v_add_f32 v104, v104, v128
    v_add_f32 v105, v105, v129
    v_lshlrev_b32 v128, 16, v69
    v_and_b32 v129, 0xffff0000, v69
    v_add_f32 v106, v106, v128
    v_add_f32 v107, v107, v129
    v_lshlrev_b32 v128, 16, v70
    v_and_b32 v129, 0xffff0000, v70
    v_add_f32 v108, v108, v128
    v_add_f32 v109, v109, v129
    v_lshlrev_b32 v128, 16, v71
    v_and_b32 v129, 0xffff0000, v71
    v_add_f32 v110, v110, v128
    v_add_f32 v111, v111, v129
    v_lshlrev_b32 v128, 16, v72
    v_and_b32 v129, 0xffff0000, v72
    v_add_f32 v104, v104, v128
    v_add_f32 v105, v105, v129
    v_lshlrev_b32 v128, 16, v73
    v_and_b32 v129, 0xffff0000, v73
    v_add_f32 v106, v106, v128
    v_add_f32 v107, v107, v129
    v_lshlrev_b32 v128, 16, v74
    v_and_b32 v129, 0xffff0000, v74
    v_add_f32 v108, v108, v128
    v_add_f32 v109, v109, v129
    v_lshlrev_b32 v128, 16, v75
    v_and_b32 v129, 0xffff0000, v75
    v_add_f32 v110, v110, v128
    v_add_f32 v111, v111, v129
    v_lshlrev_b32 v128, 16, v76
    v_and_b32 v129, 0xffff0000, v76
    v_add_f32 v104, v104, v128
    v_add_f32 v105, v105, v129
    v_lshlrev_b32 v128, 16, v77
    v_and_b32 v129, 0xffff0000, v77
    v_add_f32 v106, v106, v128
    s_barrier
    v_add_f32 v107, v107, v129
    v_lshlrev_b32 v128, 16, v78
    v_and_b32 v129, 0xffff0000, v78
    v_add_f32 v108, v108, v128
    v_add_f32 v109, v109, v129
    v_lshlrev_b32 v128, 16, v79
    v_and_b32 v129, 0xffff0000, v79
    v_add_f32 v110, v110, v128
    v_add_f32 v111, v111, v129
    v_lshlrev_b32 v128, 16, v80
    v_and_b32 v129, 0xffff0000, v80
    v_add_f32 v104, v104, v128
    v_add_f32 v105, v105, v129
    v_lshlrev_b32 v128, 16, v81
    v_and_b32 v129, 0xffff0000, v81
    v_add_f32 v106, v106, v128
    v_add_f32 v107, v107, v129
    v_lshlrev_b32 v128, 16, v82
    v_and_b32 v129, 0xffff0000, v82
    v_add_f32 v108, v108, v128
    v_add_f32 v109, v109, v129
    v_lshlrev_b32 v128, 16, v83
    v_and_b32 v129, 0xffff0000, v83
    v_add_f32 v110, v110, v128
    v_add_f32 v111, v111, v129
    v_lshlrev_b32 v128, 16, v84
    v_and_b32 v129, 0xffff0000, v84
    v_add_f32 v104, v104, v128
    v_add_f32 v105, v105, v129
    v_lshlrev_b32 v128, 16, v85
    v_and_b32 v129, 0xffff0000, v85
    v_add_f32 v106, v106, v128
    v_add_f32 v107, v107, v129
    v_lshlrev_b32 v128, 16, v86
    v_and_b32 v129, 0xffff0000, v86
    v_add_f32 v108, v108, v128
    v_add_f32 v109, v109, v129
    v_lshlrev_b32 v128, 16, v87
    v_and_b32 v129, 0xffff0000, v87
    v_add_f32 v110, v110, v128
    v_add_f32 v111, v111, v129
    v_lshlrev_b32 v128, 16, v88
    v_and_b32 v129, 0xffff0000, v88
    v_add_f32 v104, v104, v128
    v_add_f32 v105, v105, v129
    v_lshlrev_b32 v128, 16, v89
    v_and_b32 v129, 0xffff0000, v89
    v_add_f32 v106, v106, v128
    v_add_f32 v107, v107, v129
    v_lshlrev_b32 v128, 16, v90
    v_and_b32 v129, 0xffff0000, v90
    v_add_f32 v108, v108, v128
    v_add_f32 v109, v109, v129
    v_lshlrev_b32 v128, 16, v91
    v_and_b32 v129, 0xffff0000, v91
    v_add_f32 v110, v110, v128
    v_add_f32 v111, v111, v129
    v_lshlrev_b32 v128, 16, v92
    v_and_b32 v129, 0xffff0000, v92
    v_add_f32 v104, v104, v128
    v_add_f32 v105, v105, v129
    v_lshlrev_b32 v128, 16, v93
    v_and_b32 v129, 0xffff0000, v93
    v_add_f32 v106, v106, v128
    v_add_f32 v107, v107, v129
    v_lshlrev_b32 v128, 16, v94
    v_and_b32 v129, 0xffff0000, v94
    v_add_f32 v108, v108, v128
    v_add_f32 v109, v109, v129
    v_lshlrev_b32 v128, 16, v95
    v_and_b32 v129, 0xffff0000, v95
    v_add_f32 v110, v110, v128
    v_add_f32 v111, v111, v129
    v_lshlrev_b32 v128, 16, v96
    v_and_b32 v129, 0xffff0000, v96
    s_barrier
    v_add_f32 v104, v104, v128
    v_add_f32 v105, v105, v129
    v_lshlrev_b32 v128, 16, v97
    v_and_b32 v129, 0xffff0000, v97
    v_add_f32 v106, v106, v128
    v_add_f32 v107, v107, v129
    v_lshlrev_b32 v128, 16, v98
    v_and_b32 v129, 0xffff0000, v98
    v_add_f32 v108, v108, v128
    v_add_f32 v109, v109, v129
    v_lshlrev_b32 v128, 16, v99
    v_and_b32 v129, 0xffff0000, v99
    v_add_f32 v110, v110, v128
    v_add_f32 v111, v111, v129
    v_lshlrev_b32 v128, 16, v100
    v_and_b32 v129, 0xffff0000, v100
    v_add_f32 v104, v104, v128
    v_add_f32 v105, v105, v129
    v_lshlrev_b32 v128, 16, v101
    v_and_b32 v129, 0xffff0000, v101
    v_add_f32 v106, v106, v128
    v_add_f32 v107, v107, v129
    v_lshlrev_b32 v128, 16, v102
    v_and_b32 v129, 0xffff0000, v102
    v_add_f32 v108, v108, v128
    v_add_f32 v109, v109, v129
    v_lshlrev_b32 v128, 16, v103
    v_and_b32 v129, 0xffff0000, v103
    v_add_f32 v110, v110, v128
    v_add_f32 v111, v111, v129
    s_barrier
    v_mov_b32 v164, v104
    v_mov_b32 v165, v105
    v_mov_b32 v166, v106
    v_mov_b32 v167, v107
    v_mov_b32 v168, v108
    v_mov_b32 v169, v109
    v_mov_b32 v170, v110
    v_mov_b32 v171, v111
    v_permlane32_swap_b32 v164, v104
    v_permlane32_swap_b32 v165, v105
    v_permlane32_swap_b32 v166, v106
    v_permlane32_swap_b32 v167, v107
    v_permlane32_swap_b32 v168, v108
    v_permlane32_swap_b32 v169, v109
    v_permlane32_swap_b32 v170, v110
    v_permlane32_swap_b32 v171, v111
    s_nop 0
    v_add_f32 v104, v104, v164
    v_add_f32 v105, v105, v165
    v_add_f32 v106, v106, v166
    v_add_f32 v107, v107, v167
    v_add_f32 v108, v108, v168
    v_add_f32 v109, v109, v169
    v_add_f32 v110, v110, v170
    v_add_f32 v111, v111, v171
    v_cmp_lt_u32 vcc, 31, v254
    s_nop 1
    v_cndmask_b32 v132, v104, v108, vcc
    v_cndmask_b32 v133, v105, v109, vcc
    v_cndmask_b32 v134, v106, v110, vcc
    v_cndmask_b32 v135, v107, v111, vcc
    s_cmp_eq_u32 s61, 0
    s_cbranch_scc0 L_sv_nw
    ds_write_b128 v136, v[132:135]
    s_waitcnt lgkmcnt(0)
L_sv_nw:
    s_waitcnt vmcnt(0)
    v_lshlrev_b32 v118, 16, v8
    v_and_b32 v119, 0xffff0000, v8
    v_add_f32 v120, v118, v119
    v_mul_f32 v124, v118, v118
    v_fmac_f32 v124, v119, v119
    v_lshlrev_b32 v118, 16, v9
    v_and_b32 v119, 0xffff0000, v9
    v_add_f32 v121, v118, v119
    v_mul_f32 v125, v118, v118
    v_fmac_f32 v125, v119, v119
    v_lshlrev_b32 v118, 16, v10
    v_and_b32 v119, 0xffff0000, v10
    v_add_f32 v122, v118, v119
    v_mul_f32 v126, v118, v118
    v_fmac_f32 v126, v119, v119
    v_lshlrev_b32 v118, 16, v11
    v_and_b32 v119, 0xffff0000, v11
    v_add_f32 v123, v118, v119
    v_mul_f32 v127, v118, v118
    v_fmac_f32 v127, v119, v119
    v_lshlrev_b32 v118, 16, v12
    v_and_b32 v119, 0xffff0000, v12
    v_add_f32 v120, v120, v118
    s_barrier
    s_cmp_eq_u32 s61, 0
    s_cbranch_scc1 L_sv_p1
    ds_read_b128 v[140:143], v136
    s_waitcnt lgkmcnt(0)
    v_add_f32 v132, v132, v140
    v_add_f32 v133, v133, v141
    v_add_f32 v134, v134, v142
    v_add_f32 v135, v135, v143
    buffer_store_dwordx4 v[132:135], v7, s[40:43], s69 offen sc1
L_sv_p1:
    v_fmac_f32 v124, v118, v118
    v_add_f32 v120, v120, v119
    v_fmac_f32 v124, v119, v119
    v_lshlrev_b32 v118, 16, v13
    v_and_b32 v119, 0xffff0000, v13
    v_add_f32 v121, v121, v118
    v_fmac_f32 v125, v118, v118
    v_add_f32 v121, v121, v119
    v_fmac_f32 v125, v119, v119
    v_lshlrev_b32 v118, 16, v14
    v_and_b32 v119, 0xffff0000, v14
    v_add_f32 v122, v122, v118
    v_fmac_f32 v126, v118, v118
    v_add_f32 v122, v122, v119
    v_fmac_f32 v126, v119, v119
    v_lshlrev_b32 v118, 16, v15
    v_and_b32 v119, 0xffff0000, v15
    v_add_f32 v123, v123, v118
    v_fmac_f32 v127, v118, v118
    v_add_f32 v123, v123, v119
    v_fmac_f32 v127, v119, v119
    v_lshlrev_b32 v118, 16, v16
    v_and_b32 v119, 0xffff0000, v16
    v_add_f32 v120, v120, v118
    v_fmac_f32 v124, v118, v118
    v_add_f32 v120, v120, v119
    v_fmac_f32 v124, v119, v119
    v_lshlrev_b32 v118, 16, v17
    v_and_b32 v119, 0xffff0000, v17
    v_add_f32 v121, v121, v118
    v_fmac_f32 v125, v118, v118
    v_add_f32 v121, v121, v119
    v_fmac_f32 v125, v119, v119
    v_lshlrev_b32 v118, 16, v18
    v_and_b32 v119, 0xffff0000, v18
    v_add_f32 v122, v122, v118
    v_fmac_f32 v126, v118, v118
    v_add_f32 v122, v122, v119
    v_fmac_f32 v126, v119, v119
    v_lshlrev_b32 v118, 16, v19
    v_and_b32 v119, 0xffff0000, v19
    v_add_f32 v123, v123, v118
    v_fmac_f32 v127, v118, v118
    v_add_f32 v123, v123, v119
    v_fmac_f32 v127, v119, v119
    v_lshlrev_b32 v118, 16, v20
    s_barrier
    v_and_b32 v119, 0xffff0000, v20
    v_add_f32 v120, v120, v118
    v_fmac_f32 v124, v118, v118
    v_add_f32 v120, v120, v119
    v_fmac_f32 v124, v119, v119
    v_lshlrev_b32 v118, 16, v21
    v_and_b32 v119, 0xffff0000, v21
    v_add_f32 v121, v121, v118
    v_fmac_f32 v125, v118, v118
    v_add_f32 v121, v121, v119
    v_fmac_f32 v125, v119, v119
    v_lshlrev_b32 v118, 16, v22
    v_and_b32 v119, 0xffff0000, v22
    v_add_f32 v122, v122, v118
    v_fmac_f32 v126, v118, v118
    v_add_f32 v122, v122, v119
    v_fmac_f32 v126, v119, v119
    v_lshlrev_b32 v118, 16, v23
    v_and_b32 v119, 0xffff0000, v23
    v_add_f32 v123, v123, v118
    v_fmac_f32 v127, v118, v118
    v_add_f32 v123, v123, v119
    v_fmac_f32 v127, v119, v119
    v_lshlrev_b32 v118, 16, v24
    v_and_b32 v119, 0xffff0000, v24
    v_add_f32 v120, v120, v118
    v_fmac_f32 v124, v118, v118
    v_add_f32 v120, v120, v119
    v_fmac_f32 v124, v119, v119
    v_lshlrev_b32 v118, 16, v25
    v_and_b32 v119, 0xffff0000, v25
    v_add_f32 v121, v121, v118
    v_fmac_f32 v125, v118, v118
    v_add_f32 v121, v121, v119
    v_fmac_f32 v125, v119, v119
    v_lshlrev_b32 v118, 16, v26
    v_and_b32 v119, 0xffff0000, v26
    v_add_f32 v122, v122, v118
    v_fmac_f32 v126, v118, v118
    v_add_f32 v122, v122, v119
    v_fmac_f32 v126, v119, v119
    v_lshlrev_b32 v118, 16, v27
    v_and_b32 v119, 0xffff0000, v27
    v_add_f32 v123, v123, v118
    v_fmac_f32 v127, v118, v118
    v_add_f32 v123, v123, v119
    v_fmac_f32 v127, v119, v119
    v_lshlrev_b32 v118, 16, v28
    v_and_b32 v119, 0xffff0000, v28
    v_add_f32 v120, v120, v118
    v_fmac_f32 v124, v118, v118
    v_add_f32 v120, v120, v119
    v_fmac_f32 v124, v119, v119
    v_lshlrev_b32 v118, 16, v29
    v_and_b32 v119, 0xffff0000, v29
    v_add_f32 v121, v121, v118
    v_fmac_f32 v125, v118, v118
    v_add_f32 v121, v121, v119
    v_fmac_f32 v125, v119, v119
    v_lshlrev_b32 v118, 16, v30
    v_and_b32 v119, 0xffff0000, v30
    v_add_f32 v122, v122, v118
    v_fmac_f32 v126, v118, v118
    v_add_f32 v122, v122, v119
    v_fmac_f32 v126, v119, v119
    v_lshlrev_b32 v118, 16, v31
    v_and_b32 v119, 0xffff0000, v31
    v_add_f32 v123, v123, v118
    v_fmac_f32 v127, v118, v118
    v_add_f32 v123, v123, v119
    v_fmac_f32 v127, v119, v119
    v_lshlrev_b32 v118, 16, v32
    v_and_b32 v119, 0xffff0000, v32
    v_add_f32 v120, v120, v118
    v_fmac_f32 v124, v118, v118
    s_barrier
    v_add_f32 v120, v120, v119
    v_fmac_f32 v124, v119, v119
    v_lshlrev_b32 v118, 16, v33
    v_and_b32 v119, 0xffff0000, v33
    v_add_f32 v121, v121, v118
    v_fmac_f32 v125, v118, v118
    v_add_f32 v121, v121, v119
    v_fmac_f32 v125, v119, v119
    v_lshlrev_b32 v118, 16, v34
    v_and_b32 v119, 0xffff0000, v34
    v_add_f32 v122, v122, v118
    v_fmac_f32 v126, v118, v118
    v_add_f32 v122, v122, v119
    v_fmac_f32 v126, v119, v119
    v_lshlrev_b32 v118, 16, v35
    v_and_b32 v119, 0xffff0000, v35
    v_add_f32 v123, v123, v118
    v_fmac_f32 v127, v118, v118
    v_add_f32 v123, v123, v119
    v_fmac_f32 v127, v119, v119
    v_lshlrev_b32 v118, 16, v36
    v_and_b32 v119, 0xffff0000, v36
    v_add_f32 v120, v120, v118
    v_fmac_f32 v124, v118, v118
    v_add_f32 v120, v120, v119
    v_fmac_f32 v124, v119, v119
    v_lshlrev_b32 v118, 16, v37
    v_and_b32 v119, 0xffff0000, v37
    v_add_f32 v121, v121, v118
    v_fmac_f32 v125, v118, v118
    v_add_f32 v121, v121, v119
    v_fmac_f32 v125, v119, v119
    v_lshlrev_b32 v118, 16, v38
    v_and_b32 v119, 0xffff0000, v38
    v_add_f32 v122, v122, v118
    v_fmac_f32 v126, v118, v118
    v_add_f32 v122, v122, v119
    v_fmac_f32 v126, v119, v119
    v_lshlrev_b32 v118, 16, v39
    v_and_b32 v119, 0xffff0000, v39
    v_add_f32 v123, v123, v118
    v_fmac_f32 v127, v118, v118
    v_add_f32 v123, v123, v119
    v_fmac_f32 v127, v119, v119
    s_barrier
    v_add_f32 v120, v120, v121
    v_add_f32 v122, v122, v123
    v_add_f32 v124, v124, v125
    v_add_f32 v126, v126, v127
    v_add_f32 v120, v120, v122
    v_add_f32 v124, v124, v126
    s_nop 1
    v_add_f32_dpp v120, v120, v120 quad_perm:[1,0,3,2] row_mask:0xf bank_mask:0xf
    v_add_f32_dpp v124, v124, v124 quad_perm:[1,0,3,2] row_mask:0xf bank_mask:0xf
    s_nop 1
    v_add_f32_dpp v120, v120, v120 quad_perm:[2,3,0,1] row_mask:0xf bank_mask:0xf
    v_add_f32_dpp v124, v124, v124 quad_perm:[2,3,0,1] row_mask:0xf bank_mask:0xf
    s_nop 1
    v_add_f32_dpp v120, v120, v120 row_half_mirror row_mask:0xf bank_mask:0xf
    v_add_f32_dpp v124, v124, v124 row_half_mirror row_mask:0xf bank_mask:0xf
    s_nop 1
    v_add_f32_dpp v120, v120, v120 row_mirror row_mask:0xf bank_mask:0xf
    v_add_f32_dpp v124, v124, v124 row_mirror row_mask:0xf bank_mask:0xf
    v_mul_f32 v120, 0x3a800000, v120
    v_mul_f32 v124, 0x3a800000, v124
    v_fma_f32 v124, -v120, v120, v124
    v_max_f32 v124, 0, v124
    v_cvt_pk_bf16_f32 v120, v120, v120
    v_and_b32 v120, 0xffff0000, v120
    v_cvt_pk_bf16_f32 v124, v124, v124
    v_and_b32 v124, 0xffff0000, v124
    v_add_f32 v124, 0x3727c5ac, v124
    v_cvt_pk_bf16_f32 v124, v124, v124
    v_and_b32 v124, 0xffff0000, v124
    v_sqrt_f32 v124, v124
    s_nop 0
    v_cvt_pk_bf16_f32 v124, v124, v124
    v_and_b32 v124, 0xffff0000, v124
    v_rcp_f32 v130, v124
    s_nop 0
    v_mul_f32 v131, -v120, v130
    buffer_store_dwordx2 v[130:131], v3, s[40:43], s65 offen sc1
    s_barrier
    s_barrier
    s_cmp_eq_u32 s61, 0
    s_cbranch_scc0 L_sv_q1
    buffer_load_dword v138, v137, s[52:55], 0 offen sc1
L_sv_q1:
    s_barrier
    s_cmp_eq_u32 s61, 0
    s_cbranch_scc0 L_sv_c1
    s_mov_b32 s70, 0
L_sv_c0:
    s_waitcnt vmcnt(0)
    v_cmp_gt_u32 vcc, 4, v138
    s_add_u32 s70, s70, 1
    s_nop 1
    s_cbranch_vccz L_sv_c1
    s_cmp_ge_u32 s70, 131072
    s_cbranch_scc1 L_sv_c1
    s_sleep 2
    buffer_load_dword v138, v137, s[52:55], 0 offen sc1
    s_branch L_sv_c0
L_sv_c1:
    s_barrier
    s_cmp_eq_u32 s61, 0
    s_cbranch_scc1 L_sv_gs0
    buffer_load_dwordx4 v[40:43], v145, s[40:43], s68 offen offset:0 sc1
    buffer_load_dwordx4 v[44:47], v145, s[40:43], s68 offen offset:896 sc1
    buffer_load_dwordx4 v[48:51], v145, s[40:43], s68 offen offset:1792 sc1
    buffer_load_dwordx4 v[52:55], v145, s[40:43], s68 offen offset:2688 sc1
    buffer_load_dwordx4 v[56:59], v146, s[40:43], s68 offen offset:0 sc1
    buffer_load_dwordx4 v[60:63], v146, s[40:43], s68 offen offset:896 sc1
    buffer_load_dwordx4 v[64:67], v146, s[40:43], s68 offen offset:1792 sc1
    buffer_load_dwordx4 v[68:71], v146, s[40:43], s68 offen offset:2688 sc1
    buffer_load_dwordx4 v[72:75], v147, s[40:43], s68 offen offset:0 sc1
    buffer_load_dwordx4 v[76:79], v147, s[40:43], s68 offen offset:896 sc1
    buffer_load_dwordx4 v[80:83], v147, s[40:43], s68 offen offset:1792 sc1
    buffer_load_dwordx4 v[84:87], v147, s[40:43], s68 offen offset:2688 sc1
    buffer_load_dwordx4 v[88:91], v148, s[40:43], s68 offen offset:0 sc1
    buffer_load_dwordx4 v[92:95], v148, s[40:43], s68 offen offset:896 sc1
    buffer_load_dwordx4 v[96:99], v148, s[40:43], s68 offen offset:1792 sc1
    buffer_load_dwordx4 v[100:103], v148, s[40:43], s68 offen offset:2688 sc1
L_sv_gs0:
    s_cmp_eq_u32 s61, 0
    s_cbranch_scc0 L_sv_g1
    buffer_load_dwordx2 v[178:179], v189, s[48:51], s98 offen
    buffer_load_dwordx2 v[176:177], v161, s[44:47], s75 offen
    buffer_load_dwordx4 v[172:175], v160, s[40:43], s71 offen sc1
L_sv_g1:
    buffer_load_dword v185, v184, s[28:31], s74 offen
    buffer_load_dword v186, v184, s[28:31], s67 offen
    s_barrier
    s_cmp_eq_u32 s61, 0
    s_cbranch_scc1 L_sv_h1
    s_mov_b32 s70, 0
    s_waitcnt vmcnt(2)
    s_branch L_sv_h2b
L_sv_h2:
    s_waitcnt vmcnt(0)
L_sv_h2b:
    v_add_f32 v132, v40, v44
    v_add_f32 v133, v41, v45
    v_add_f32 v134, v42, v46
    v_add_f32 v135, v43, v47
    v_add_f32 v132, v132, v48
    v_add_f32 v133, v133, v49
    v_add_f32 v134, v134, v50
    v_add_f32 v135, v135, v51
    v_add_f32 v132, v132, v52
    v_add_f32 v133, v133, v53
    v_add_f32 v134, v134, v54
    v_add_f32 v135, v135, v55
    v_add_f32 v132, v132, v56
    v_add_f32 v133, v133, v57
    v_add_f32 v134, v134, v58
    v_add_f32 v135, v135, v59
    v_add_f32 v132, v132, v60
    v_add_f32 v133, v133, v61
    v_add_f32 v134, v134, v62
    v_add_f32 v135, v135, v63
    v_add_f32 v132, v132, v64
    v_add_f32 v133, v133, v65
    v_add_f32 v134, v134, v66
    v_add_f32 v135, v135, v67
    v_add_f32 v132, v132, v68
    v_add_f32 v133, v133, v69
    v_add_f32 v134, v134, v70
    v_add_f32 v135, v135, v71
    v_add_f32 v132, v132, v72
    v_add_f32 v133, v133, v73
    v_add_f32 v134, v134, v74
    v_add_f32 v135, v135, v75
    v_add_f32 v132, v132, v76
    v_add_f32 v133, v133, v77
    v_add_f32 v134, v134, v78
    v_add_f32 v135, v135, v79
    v_add_f32 v132, v132, v80
    v_add_f32 v133, v133, v81
    v_add_f32 v134, v134, v82
    v_add_f32 v135, v135, v83
    v_add_f32 v132, v132, v84
    v_add_f32 v133, v133, v85
    v_add_f32 v134, v134, v86
    v_add_f32 v135, v135, v87
    v_add_f32 v132, v132, v88
    v_add_f32 v133, v133, v89
    v_add_f32 v134, v134, v90
    v_add_f32 v135, v135, v91
    v_add_f32 v132, v132, v92
    v_add_f32 v133, v133, v93
    v_add_f32 v134, v134, v94
    v_add_f32 v135, v135, v95
    v_add_f32 v132, v132, v96
    v_add_f32 v133, v133, v97
    v_add_f32 v134, v134, v98
    v_add_f32 v135, v135, v99
    v_add_f32 v132, v132, v100
    v_add_f32 v133, v133, v101
    v_add_f32 v134, v134, v102
    v_add_f32 v135, v135, v103
    v_cmp_u_f32 vcc, v132, v133
    v_cmp_u_f32 s[72:73], v134, v135
    s_add_u32 s70, s70, 1
    s_nop 1
    s_or_b64 vcc, vcc, s[72:73]
    s_cbranch_scc0 L_sv_h3
    s_cmp_ge_u32 s70, 8192
    s_cbranch_scc1 L_sv_h3
    buffer_load_dwordx4 v[40:43], v145, s[40:43], s68 offen offset:0 sc1
    buffer_load_dwordx4 v[44:47], v145, s[40:43], s68 offen offset:896 sc1
    buffer_load_dwordx4 v[48:51], v145, s[40:43], s68 offen offset:1792 sc1
    buffer_load_dwordx4 v[52:55], v145, s[40:43], s68 offen offset:2688 sc1
    buffer_load_dwordx4 v[56:59], v146, s[40:43], s68 offen offset:0 sc1
    buffer_load_dwordx4 v[60:63], v146, s[40:43], s68 offen offset:896 sc1
    buffer_load_dwordx4 v[64:67], v146, s[40:43], s68 offen offset:1792 sc1
    buffer_load_dwordx4 v[68:71], v146, s[40:43], s68 offen offset:2688 sc1
    buffer_load_dwordx4 v[72:75], v147, s[40:43], s68 offen offset:0 sc1
    buffer_load_dwordx4 v[76:79], v147, s[40:43], s68 offen offset:896 sc1
    buffer_load_dwordx4 v[80:83], v147, s[40:43], s68 offen offset:1792 sc1
    buffer_load_dwordx4 v[84:87], v147, s[40:43], s68 offen offset:2688 sc1
    buffer_load_dwordx4 v[88:91], v148, s[40:43], s68 offen offset:0 sc1
    buffer_load_dwordx4 v[92:95], v148, s[40:43], s68 offen offset:896 sc1
    buffer_load_dwordx4 v[96:99], v148, s[40:43], s68 offen offset:1792 sc1
    buffer_load_dwordx4 v[100:103], v148, s[40:43], s68 offen offset:2688 sc1
    s_branch L_sv_h2
L_sv_h3:
    v_add_u32 v145, 155648, v145
    ds_write_b128 v145, v[132:135]
    s_waitcnt lgkmcnt(0)
L_sv_h1:
    s_cmp_eq_u32 s61, 0
    s_cbranch_scc0 L_sv_h5
    s_mov_b32 s70, 0
    s_waitcnt vmcnt(2)
    s_branch L_sv_h0b
L_sv_h0:
    s_waitcnt vmcnt(0)
L_sv_h0b:
    v_cmp_u_f32 vcc, v172, v173
    v_cmp_u_f32 s[72:73], v174, v175
    s_add_u32 s70, s70, 1
    s_nop 1
    s_or_b64 vcc, vcc, s[72:73]
    s_cbranch_scc0 L_sv_h4
    s_cmp_ge_u32 s70, 8192
    s_cbranch_scc1 L_sv_h4
    buffer_load_dwordx4 v[172:175], v160, s[40:43], s71 offen sc1
    s_branch L_sv_h0
L_sv_h4:
    v_add_u32 v160, 157440, v160
    ds_write_b128 v160, v[172:175]
    v_add_u32 v189, 158464, v189
    ds_write_b64 v189, v[178:179]
    v_lshlrev_b32 v180, 16, v176
    v_and_b32 v181, 0xffff0000, v176
    v_lshlrev_b32 v182, 16, v177
    v_and_b32 v183, 0xffff0000, v177
    v_lshlrev_b32 v161, 4, v144
    v_add_u32 v161, 156544, v161
    ds_write_b128 v161, v[180:183]
    s_waitcnt lgkmcnt(0)
L_sv_h5:
    s_cmp_eq_u32 s3, 6
    s_cbranch_scc1 L_streamA
L_streamB:
    s_barrier
    s_add_u32 s65, s76, 0
    s_add_u32 m0, s97, 57344
    s_nop 0
    buffer_load_dwordx4 v208, s[28:31], s65 offen offset:0 lds
    buffer_load_dwordx4 v209, s[28:31], s65 offen offset:1024 lds
    buffer_load_dwordx4 v210, s[28:31], s65 offen offset:2048 lds
    buffer_load_dwordx4 v211, s[28:31], s65 offen offset:3072 lds
    s_add_u32 s65, s76, 262144
    s_add_u32 m0, s97, 65536
    s_nop 0
    buffer_load_dwordx4 v208, s[28:31], s65 offen offset:0 lds
    buffer_load_dwordx4 v209, s[28:31], s65 offen offset:1024 lds
    buffer_load_dwordx4 v210, s[28:31], s65 offen offset:2048 lds
    buffer_load_dwordx4 v211, s[28:31], s65 offen offset:3072 lds
    s_add_u32 s65, s76, 65536
    s_add_u32 m0, s97, 73728
    s_nop 0
    buffer_load_dwordx4 v208, s[28:31], s65 offen offset:0 lds
    buffer_load_dwordx4 v209, s[28:31], s65 offen offset:1024 lds
    buffer_load_dwordx4 v210, s[28:31], s65 offen offset:2048 lds
    buffer_load_dwordx4 v211, s[28:31], s65 offen offset:3072 lds
    s_add_u32 s65, s76, 327680
    s_add_u32 m0, s97, 81920
    s_nop 0
    buffer_load_dwordx4 v208, s[28:31], s65 offen offset:0 lds
    buffer_load_dwordx4 v209, s[28:31], s65 offen offset:1024 lds
    buffer_load_dwordx4 v210, s[28:31], s65 offen offset:2048 lds
    buffer_load_dwordx4 v211, s[28:31], s65 offen offset:3072 lds
    s_add_u32 s65, s76, 131072
    s_add_u32 m0, s97, 90112
    s_nop 0
    buffer_load_dwordx4 v208, s[28:31], s65 offen offset:0 lds
    buffer_load_dwordx4 v209, s[28:31], s65 offen offset:1024 lds
    buffer_load_dwordx4 v210, s[28:31], s65 offen offset:2048 lds
    buffer_load_dwordx4 v211, s[28:31], s65 offen offset:3072 lds
    s_add_u32 s65, s76, 393216
    s_add_u32 m0, s97, 98304
    s_nop 0
    buffer_load_dwordx4 v208, s[28:31], s65 offen offset:0 lds
    buffer_load_dwordx4 v209, s[28:31], s65 offen offset:1024 lds
    buffer_load_dwordx4 v210, s[28:31], s65 offen offset:2048 lds
    buffer_load_dwordx4 v211, s[28:31], s65 offen offset:3072 lds
    s_add_u32 s65, s76, 196608
    s_add_u32 m0, s97, 106496
    s_nop 0
    buffer_load_dwordx4 v208, s[28:31], s65 offen offset:0 lds
    buffer_load_dwordx4 v209, s[28:31], s65 offen offset:1024 lds
    buffer_load_dwordx4 v210, s[28:31], s65 offen offset:2048 lds
    buffer_load_dwordx4 v211, s[28:31], s65 offen offset:3072 lds
    s_add_u32 s65, s77, 0
    s_add_u32 m0, s97, 114688
    s_nop 0
    buffer_load_dwordx4 v208, s[28:31], s65 offen offset:0 lds
    buffer_load_dwordx4 v209, s[28:31], s65 offen offset:1024 lds
    buffer_load_dwordx4 v210, s[28:31], s65 offen offset:2048 lds
    buffer_load_dwordx4 v211, s[28:31], s65 offen offset:3072 lds
    s_add_u32 s65, s77, 262144
    s_add_u32 m0, s97, 122880
    s_nop 0
    buffer_load_dwordx4 v208, s[28:31], s65 offen offset:0 lds
    buffer_load_dwordx4 v209, s[28:31], s65 offen offset:1024 lds
    buffer_load_dwordx4 v210, s[28:31], s65 offen offset:2048 lds
    buffer_load_dwordx4 v211, s[28:31], s65 offen offset:3072 lds
    s_add_u32 s65, s78, 0
    s_add_u32 m0, s97, 131072
    s_nop 0
    buffer_load_dwordx4 v208, s[28:31], s65 offen offset:0 lds
    buffer_load_dwordx4 v209, s[28:31], s65 offen offset:1024 lds
    buffer_load_dwordx4 v210, s[28:31], s65 offen offset:2048 lds
    buffer_load_dwordx4 v211, s[28:31], s65 offen offset:3072 lds
    s_add_u32 s65, s78, 262144
    s_add_u32 m0, s97, 139264
    s_nop 0
    buffer_load_dwordx4 v208, s[28:31], s65 offen offset:0 lds
    buffer_load_dwordx4 v209, s[28:31], s65 offen offset:1024 lds
    buffer_load_dwordx4 v210, s[28:31], s65 offen offset:2048 lds
    buffer_load_dwordx4 v211, s[28:31], s65 offen offset:3072 lds
    s_add_u32 s65, s79, 0
    s_add_u32 m0, s97, 147456
    s_nop 0
    buffer_load_dwordx4 v208, s[28:31], s65 offen offset:0 lds
    buffer_load_dwordx4 v209, s[28:31], s65 offen offset:1024 lds
    buffer_load_dwordx4 v210, s[28:31], s65 offen offset:2048 lds
    buffer_load_dwordx4 v211, s[28:31], s65 offen offset:3072 lds
    s_cmp_eq_u32 s96, 0
    s_cbranch_scc0 L_p1_t
    buffer_load_dword v215, v214, s[40:43], s100 offen sc1
L_p1_t:
    s_barrier
    s_barrier
    s_waitcnt vmcnt(40)
    s_barrier
    s_cmp_eq_u32 s96, 0
    s_cbranch_scc0 L_p1_n
    buffer_load_dword v213, v214, s[40:43], s100 offen sc1
L_p1_n:
    s_cmp_eq_u32 s96, 0
    s_cbranch_scc0 L_p1_go
    s_mov_b32 s63, 0
    v_mov_b32 v216, 0
L_p1:
    s_add_u32 s63, s63, 1
    s_waitcnt vmcnt(0)
    v_or_b32 v216, v216, v213
    v_cmp_ne_u32 vcc, 1, v216
    s_cmp_ge_u32 s63, 131072
    s_cbranch_scc1 L_p1_go
    s_nop 0
    s_cbranch_vccz L_p1_go
    s_and_b32 s60, s63, 7
    s_cmp_eq_u32 s60, 0
    s_cbranch_scc1 L_p1_far
    buffer_load_dword v213, v214, s[40:43], s100 offen sc1
    s_branch L_p1
L_p1_far:
    buffer_load_dword v213, v212, s[40:43], s100 offen sc1
    s_branch L_p1
L_p1_go:
    s_waitcnt vmcnt(32)
    s_barrier
    s_add_u32 s65, s79, 262144
    s_add_u32 m0, s97, 57344
    s_nop 0
    buffer_load_dwordx4 v208, s[28:31], s65 offen offset:0 lds
    buffer_load_dwordx4 v209, s[28:31], s65 offen offset:1024 lds
    buffer_load_dwordx4 v210, s[28:31], s65 offen offset:2048 lds
    buffer_load_dwordx4 v211, s[28:31], s65 offen offset:3072 lds
    s_add_u32 s65, s80, 0
    s_add_u32 m0, s97, 65536
    s_nop 0
    buffer_load_dwordx4 v208, s[28:31], s65 offen offset:0 lds
    buffer_load_dwordx4 v209, s[28:31], s65 offen offset:1024 lds
    buffer_load_dwordx4 v210, s[28:31], s65 offen offset:2048 lds
    s_waitcnt vmcnt(31)
    s_barrier
    buffer_load_dwordx4 v211, s[28:31], s65 offen offset:3072 lds
    s_add_u32 s65, s80, 262144
    s_add_u32 m0, s97, 73728
    s_nop 0
    buffer_load_dwordx4 v208, s[28:31], s65 offen offset:0 lds
    buffer_load_dwordx4 v209, s[28:31], s65 offen offset:1024 lds
    buffer_load_dwordx4 v210, s[28:31], s65 offen offset:2048 lds
    buffer_load_dwordx4 v211, s[28:31], s65 offen offset:3072 lds
    s_add_u32 s65, s81, 0
    s_add_u32 m0, s97, 81920
    s_nop 0
    buffer_load_dwordx4 v208, s[28:31], s65 offen offset:0 lds
    buffer_load_dwordx4 v209, s[28:31], s65 offen offset:1024 lds
    s_waitcnt vmcnt(30)
    s_barrier
    buffer_load_dwordx4 v210, s[28:31], s65 offen offset:2048 lds
    buffer_load_dwordx4 v211, s[28:31], s65 offen offset:3072 lds
    s_add_u32 s65, s81, 262144
    s_add_u32 m0, s97, 90112
    s_nop 0
    buffer_load_dwordx4 v208, s[28:31], s65 offen offset:0 lds
    buffer_load_dwordx4 v209, s[28:31], s65 offen offset:1024 lds
    buffer_load_dwordx4 v210, s[28:31], s65 offen offset:2048 lds
    buffer_load_dwordx4 v211, s[28:31], s65 offen offset:3072 lds
    s_add_u32 s65, s82, 0
    s_add_u32 m0, s97, 98304
    s_nop 0
    buffer_load_dwordx4 v208, s[28:31], s65 offen offset:0 lds
    s_waitcnt vmcnt(29)
    s_barrier
    buffer_load_dwordx4 v209, s[28:31], s65 offen offset:1024 lds
    buffer_load_dwordx4 v210, s[28:31], s65 offen offset:2048 lds
    buffer_load_dwordx4 v211, s[28:31], s65 offen offset:3072 lds
    s_add_u32 s65, s82, 262144
    s_add_u32 m0, s97, 106496
    s_nop 0
    buffer_load_dwordx4 v208, s[28:31], s65 offen offset:0 lds
    buffer_load_dwordx4 v209, s[28:31], s65 offen offset:1024 lds
    buffer_load_dwordx4 v210, s[28:31], s65 offen offset:2048 lds
    buffer_load_dwordx4 v211, s[28:31], s65 offen offset:3072 lds
    s_waitcnt vmcnt(28)
    s_barrier
    s_add_u32 s65, s83, 0
    s_add_u32 m0, s97, 114688
    s_nop 0
    buffer_load_dwordx4 v208, s[28:31], s65 offen offset:0 lds
    buffer_load_dwordx4 v209, s[28:31], s65 offen offset:1024 lds
    buffer_load_dwordx4 v210, s[28:31], s65 offen offset:2048 lds
    buffer_load_dwordx4 v211, s[28:31], s65 offen offset:3072 lds
    s_add_u32 s65, s83, 262144
    s_add_u32 m0, s97, 122880
    s_nop 0
    buffer_load_dwordx4 v208, s[28:31], s65 offen offset:0 lds
    buffer_load_dwordx4 v209, s[28:31], s65 offen offset:1024 lds
    buffer_load_dwordx4 v210, s[28:31], s65 offen offset:2048 lds
    s_waitcnt vmcnt(27)
    s_barrier
    buffer_load_dwordx4 v211, s[28:31], s65 offen offset:3072 lds
    s_add_u32 s65, s77, 65536
    s_add_u32 m0, s97, 131072
    s_nop 0
    buffer_load_dwordx4 v208, s[28:31], s65 offen offset:0 lds
    buffer_load_dwordx4 v209, s[28:31], s65 offen offset:1024 lds
    buffer_load_dwordx4 v210, s[28:31], s65 offen offset:2048 lds
    buffer_load_dwordx4 v211, s[28:31], s65 offen offset:3072 lds
    s_add_u32 s65, s77, 327680
    s_add_u32 m0, s97, 139264
    s_nop 0
    buffer_load_dwordx4 v208, s[28:31], s65 offen offset:0 lds
    buffer_load_dwordx4 v209, s[28:31], s65 offen offset:1024 lds
    s_waitcnt vmcnt(26)
    s_barrier
    buffer_load_dwordx4 v210, s[28:31], s65 offen offset:2048 lds
    buffer_load_dwordx4 v211, s[28:31], s65 offen offset:3072 lds
    s_add_u32 s65, s77, 196608
    s_add_u32 m0, s97, 147456
    s_nop 0
    buffer_load_dwordx4 v208, s[28:31], s65 offen offset:0 lds
    buffer_load_dwordx4 v209, s[28:31], s65 offen offset:1024 lds
    buffer_load_dwordx4 v210, s[28:31], s65 offen offset:2048 lds
    buffer_load_dwordx4 v211, s[28:31], s65 offen offset:3072 lds
    s_add_u32 s65, s77, 131072
    s_add_u32 m0, s97, 57344
    s_nop 0
    buffer_load_dwordx4 v208, s[28:31], s65 offen offset:0 lds
    s_waitcnt vmcnt(25)
    s_barrier
    buffer_load_dwordx4 v209, s[28:31], s65 offen offset:1024 lds
    buffer_load_dwordx4 v210, s[28:31], s65 offen offset:2048 lds
    buffer_load_dwordx4 v211, s[28:31], s65 offen offset:3072 lds
    s_add_u32 s65, s77, 393216
    s_add_u32 m0, s97, 65536
    s_nop 0
    buffer_load_dwordx4 v208, s[28:31], s65 offen offset:0 lds
    buffer_load_dwordx4 v209, s[28:31], s65 offen offset:1024 lds
    buffer_load_dwordx4 v210, s[28:31], s65 offen offset:2048 lds
    buffer_load_dwordx4 v211, s[28:31], s65 offen offset:3072 lds
    s_waitcnt vmcnt(24)
    s_barrier
    s_add_u32 s65, s78, 65536
    s_add_u32 m0, s97, 73728
    s_nop 0
    buffer_load_dwordx4 v208, s[28:31], s65 offen offset:0 lds
    buffer_load_dwordx4 v209, s[28:31], s65 offen offset:1024 lds
    buffer_load_dwordx4 v210, s[28:31], s65 offen offset:2048 lds
    buffer_load_dwordx4 v211, s[28:31], s65 offen offset:3072 lds
    s_add_u32 s65, s78, 327680
    s_add_u32 m0, s97, 81920
    s_nop 0
    buffer_load_dwordx4 v208, s[28:31], s65 offen offset:0 lds
    buffer_load_dwordx4 v209, s[28:31], s65 offen offset:1024 lds
    buffer_load_dwordx4 v210, s[28:31], s65 offen offset:2048 lds
    s_waitcnt vmcnt(23)
    s_barrier
    buffer_load_dwordx4 v211, s[28:31], s65 offen offset:3072 lds
    s_add_u32 s65, s78, 196608
    s_add_u32 m0, s97, 90112
    s_nop 0
    buffer_load_dwordx4 v208, s[28:31], s65 offen offset:0 lds
    buffer_load_dwordx4 v209, s[28:31], s65 offen offset:1024 lds
    buffer_load_dwordx4 v210, s[28:31], s65 offen offset:2048 lds
    buffer_load_dwordx4 v211, s[28:31], s65 offen offset:3072 lds
    s_add_u32 s65, s78, 131072
    s_add_u32 m0, s97, 98304
    s_nop 0
    buffer_load_dwordx4 v208, s[28:31], s65 offen offset:0 lds
    buffer_load_dwordx4 v209, s[28:31], s65 offen offset:1024 lds
    s_waitcnt vmcnt(22)
    s_barrier
    buffer_load_dwordx4 v210, s[28:31], s65 offen offset:2048 lds
    buffer_load_dwordx4 v211, s[28:31], s65 offen offset:3072 lds
    s_add_u32 s65, s78, 393216
    s_add_u32 m0, s97, 106496
    s_nop 0
    buffer_load_dwordx4 v208, s[28:31], s65 offen offset:0 lds
    buffer_load_dwordx4 v209, s[28:31], s65 offen offset:1024 lds
    buffer_load_dwordx4 v210, s[28:31], s65 offen offset:2048 lds
    buffer_load_dwordx4 v211, s[28:31], s65 offen offset:3072 lds
    s_add_u32 s65, s79, 65536
    s_add_u32 m0, s97, 114688
    s_nop 0
    buffer_load_dwordx4 v208, s[28:31], s65 offen offset:0 lds
    s_waitcnt vmcnt(21)
    s_barrier
    buffer_load_dwordx4 v209, s[28:31], s65 offen offset:1024 lds
    buffer_load_dwordx4 v210, s[28:31], s65 offen offset:2048 lds
    buffer_load_dwordx4 v211, s[28:31], s65 offen offset:3072 lds
    s_add_u32 s65, s79, 327680
    s_add_u32 m0, s97, 122880
    s_nop 0
    buffer_load_dwordx4 v208, s[28:31], s65 offen offset:0 lds
    buffer_load_dwordx4 v209, s[28:31], s65 offen offset:1024 lds
    buffer_load_dwordx4 v210, s[28:31], s65 offen offset:2048 lds
    buffer_load_dwordx4 v211, s[28:31], s65 offen offset:3072 lds
    s_waitcnt vmcnt(20)
    s_barrier
    s_add_u32 s65, s79, 196608
    s_add_u32 m0, s97, 131072
    s_nop 0
    buffer_load_dwordx4 v208, s[28:31], s65 offen offset:0 lds
    buffer_load_dwordx4 v209, s[28:31], s65 offen offset:1024 lds
    buffer_load_dwordx4 v210, s[28:31], s65 offen offset:2048 lds
    buffer_load_dwordx4 v211, s[28:31], s65 offen offset:3072 lds
    s_add_u32 s65, s79, 131072
    s_add_u32 m0, s97, 139264
    s_nop 0
    buffer_load_dwordx4 v208, s[28:31], s65 offen offset:0 lds
    buffer_load_dwordx4 v209, s[28:31], s65 offen offset:1024 lds
    buffer_load_dwordx4 v210, s[28:31], s65 offen offset:2048 lds
    s_waitcnt vmcnt(19)
    s_barrier
    buffer_load_dwordx4 v211, s[28:31], s65 offen offset:3072 lds
    s_add_u32 s65, s79, 393216
    s_add_u32 m0, s97, 147456
    s_nop 0
    buffer_load_dwordx4 v208, s[28:31], s65 offen offset:0 lds
    buffer_load_dwordx4 v209, s[28:31], s65 offen offset:1024 lds
    buffer_load_dwordx4 v210, s[28:31], s65 offen offset:2048 lds
    buffer_load_dwordx4 v211, s[28:31], s65 offen offset:3072 lds
    s_add_u32 s65, s80, 65536
    s_add_u32 m0, s97, 57344
    s_nop 0
    buffer_load_dwordx4 v208, s[28:31], s65 offen offset:0 lds
    buffer_load_dwordx4 v209, s[28:31], s65 offen offset:1024 lds
    s_waitcnt vmcnt(18)
    s_barrier
    buffer_load_dwordx4 v210, s[28:31], s65 offen offset:2048 lds
    buffer_load_dwordx4 v211, s[28:31], s65 offen offset:3072 lds
    s_add_u32 s65, s80, 327680
    s_add_u32 m0, s97, 65536
    s_nop 0
    buffer_load_dwordx4 v208, s[28:31], s65 offen offset:0 lds
    buffer_load_dwordx4 v209, s[28:31], s65 offen offset:1024 lds
    buffer_load_dwordx4 v210, s[28:31], s65 offen offset:2048 lds
    buffer_load_dwordx4 v211, s[28:31], s65 offen offset:3072 lds
    s_add_u32 s65, s80, 196608
    s_add_u32 m0, s97, 73728
    s_nop 0
    buffer_load_dwordx4 v208, s[28:31], s65 offen offset:0 lds
    s_waitcnt vmcnt(17)
    s_barrier
    buffer_load_dwordx4 v209, s[28:31], s65 offen offset:1024 lds
    buffer_load_dwordx4 v210, s[28:31], s65 offen offset:2048 lds
    buffer_load_dwordx4 v211, s[28:31], s65 offen offset:3072 lds
    s_add_u32 s65, s80, 131072
    s_add_u32 m0, s97, 81920
    s_nop 0
    buffer_load_dwordx4 v208, s[28:31], s65 offen offset:0 lds
    buffer_load_dwordx4 v209, s[28:31], s65 offen offset:1024 lds
    buffer_load_dwordx4 v210, s[28:31], s65 offen offset:2048 lds
    buffer_load_dwordx4 v211, s[28:31], s65 offen offset:3072 lds
    s_waitcnt vmcnt(16)
    s_barrier
    s_add_u32 s65, s80, 393216
    s_add_u32 m0, s97, 90112
    s_nop 0
    buffer_load_dwordx4 v208, s[28:31], s65 offen offset:0 lds
    buffer_load_dwordx4 v209, s[28:31], s65 offen offset:1024 lds
    buffer_load_dwordx4 v210, s[28:31], s65 offen offset:2048 lds
    buffer_load_dwordx4 v211, s[28:31], s65 offen offset:3072 lds
    s_add_u32 s65, s81, 65536
    s_add_u32 m0, s97, 98304
    s_nop 0
    buffer_load_dwordx4 v208, s[28:31], s65 offen offset:0 lds
    buffer_load_dwordx4 v209, s[28:31], s65 offen offset:1024 lds
    buffer_load_dwordx4 v210, s[28:31], s65 offen offset:2048 lds
    s_waitcnt vmcnt(15)
    s_barrier
    buffer_load_dwordx4 v211, s[28:31], s65 offen offset:3072 lds
    s_add_u32 s65, s81, 327680
    s_add_u32 m0, s97, 106496
    s_nop 0
    buffer_load_dwordx4 v208, s[28:31], s65 offen offset:0 lds
    buffer_load_dwordx4 v209, s[28:31], s65 offen offset:1024 lds
    buffer_load_dwordx4 v210, s[28:31], s65 offen offset:2048 lds
    buffer_load_dwordx4 v211, s[28:31], s65 offen offset:3072 lds
    s_add_u32 s65, s81, 196608
    s_add_u32 m0, s97, 114688
    s_nop 0
    buffer_load_dwordx4 v208, s[28:31], s65 offen offset:0 lds
    buffer_load_dwordx4 v209, s[28:31], s65 offen offset:1024 lds
    s_waitcnt vmcnt(14)
    s_barrier
    buffer_load_dwordx4 v210, s[28:31], s65 offen offset:2048 lds
    buffer_load_dwordx4 v211, s[28:31], s65 offen offset:3072 lds
    s_add_u32 s65, s81, 131072
    s_add_u32 m0, s97, 122880
    s_nop 0
    buffer_load_dwordx4 v208, s[28:31], s65 offen offset:0 lds
    buffer_load_dwordx4 v209, s[28:31], s65 offen offset:1024 lds
    buffer_load_dwordx4 v210, s[28:31], s65 offen offset:2048 lds
    buffer_load_dwordx4 v211, s[28:31], s65 offen offset:3072 lds
    s_add_u32 s65, s81, 393216
    s_add_u32 m0, s97, 131072
    s_nop 0
    buffer_load_dwordx4 v208, s[28:31], s65 offen offset:0 lds
    s_waitcnt vmcnt(13)
    s_barrier
    buffer_load_dwordx4 v209, s[28:31], s65 offen offset:1024 lds
    buffer_load_dwordx4 v210, s[28:31], s65 offen offset:2048 lds
    buffer_load_dwordx4 v211, s[28:31], s65 offen offset:3072 lds
    s_add_u32 s65, s82, 65536
    s_add_u32 m0, s97, 139264
    s_nop 0
    buffer_load_dwordx4 v208, s[28:31], s65 offen offset:0 lds
    buffer_load_dwordx4 v209, s[28:31], s65 offen offset:1024 lds
    buffer_load_dwordx4 v210, s[28:31], s65 offen offset:2048 lds
    buffer_load_dwordx4 v211, s[28:31], s65 offen offset:3072 lds
    s_waitcnt vmcnt(12)
    s_barrier
    s_add_u32 s65, s82, 327680
    s_add_u32 m0, s97, 147456
    s_nop 0
    buffer_load_dwordx4 v208, s[28:31], s65 offen offset:0 lds
    buffer_load_dwordx4 v209, s[28:31], s65 offen offset:1024 lds
    buffer_load_dwordx4 v210, s[28:31], s65 offen offset:2048 lds
    buffer_load_dwordx4 v211, s[28:31], s65 offen offset:3072 lds
    s_add_u32 s65, s82, 196608
    s_add_u32 m0, s97, 57344
    s_nop 0
    buffer_load_dwordx4 v208, s[28:31], s65 offen offset:0 lds
    buffer_load_dwordx4 v209, s[28:31], s65 offen offset:1024 lds
    buffer_load_dwordx4 v210, s[28:31], s65 offen offset:2048 lds
    s_waitcnt vmcnt(11)
    s_barrier
    buffer_load_dwordx4 v211, s[28:31], s65 offen offset:3072 lds
    s_add_u32 s65, s82, 131072
    s_add_u32 m0, s97, 65536
    s_nop 0
    buffer_load_dwordx4 v208, s[28:31], s65 offen offset:0 lds
    buffer_load_dwordx4 v209, s[28:31], s65 offen offset:1024 lds
    buffer_load_dwordx4 v210, s[28:31], s65 offen offset:2048 lds
    buffer_load_dwordx4 v211, s[28:31], s65 offen offset:3072 lds
    s_add_u32 s65, s82, 393216
    s_add_u32 m0, s97, 73728
    s_nop 0
    buffer_load_dwordx4 v208, s[28:31], s65 offen offset:0 lds
    buffer_load_dwordx4 v209, s[28:31], s65 offen offset:1024 lds
    s_waitcnt vmcnt(10)
    s_barrier
    buffer_load_dwordx4 v210, s[28:31], s65 offen offset:2048 lds
    buffer_load_dwordx4 v211, s[28:31], s65 offen offset:3072 lds
    s_add_u32 s65, s83, 65536
    s_add_u32 m0, s97, 81920
    s_nop 0
    buffer_load_dwordx4 v208, s[28:31], s65 offen offset:0 lds
    buffer_load_dwordx4 v209, s[28:31], s65 offen offset:1024 lds
    buffer_load_dwordx4 v210, s[28:31], s65 offen offset:2048 lds
    buffer_load_dwordx4 v211, s[28:31], s65 offen offset:3072 lds
    s_add_u32 s65, s83, 327680
    s_add_u32 m0, s97, 90112
    s_nop 0
    buffer_load_dwordx4 v208, s[28:31], s65 offen offset:0 lds
    s_waitcnt vmcnt(9)
    s_barrier
    buffer_load_dwordx4 v209, s[28:31], s65 offen offset:1024 lds
    buffer_load_dwordx4 v210, s[28:31], s65 offen offset:2048 lds
    buffer_load_dwordx4 v211, s[28:31], s65 offen offset:3072 lds
    s_add_u32 s65, s83, 196608
    s_add_u32 m0, s97, 98304
    s_nop 0
    buffer_load_dwordx4 v208, s[28:31], s65 offen offset:0 lds
    buffer_load_dwordx4 v209, s[28:31], s65 offen offset:1024 lds
    buffer_load_dwordx4 v210, s[28:31], s65 offen offset:2048 lds
    buffer_load_dwordx4 v211, s[28:31], s65 offen offset:3072 lds
    s_waitcnt vmcnt(8)
    s_barrier
    s_add_u32 s65, s83, 131072
    s_add_u32 m0, s97, 106496
    s_nop 0
    buffer_load_dwordx4 v208, s[28:31], s65 offen offset:0 lds
    buffer_load_dwordx4 v209, s[28:31], s65 offen offset:1024 lds
    buffer_load_dwordx4 v210, s[28:31], s65 offen offset:2048 lds
    buffer_load_dwordx4 v211, s[28:31], s65 offen offset:3072 lds
    s_add_u32 s65, s83, 393216
    s_add_u32 m0, s97, 114688
    s_nop 0
    buffer_load_dwordx4 v208, s[28:31], s65 offen offset:0 lds
    buffer_load_dwordx4 v209, s[28:31], s65 offen offset:1024 lds
    buffer_load_dwordx4 v210, s[28:31], s65 offen offset:2048 lds
    buffer_load_dwordx4 v211, s[28:31], s65 offen offset:3072 lds
    s_waitcnt vmcnt(8)
    s_barrier
    s_waitcnt vmcnt(0)
    s_barrier
    s_endpgm
L_streamA:
    s_barrier
    s_waitcnt lgkmcnt(0)
    s_barrier
    ds_read_b128 v[16:19], v221 offset:0
    ds_read_b128 v[20:23], v221 offset:1024
    ds_read_b128 v[24:27], v221 offset:4096
    ds_read_b128 v[28:31], v221 offset:5120
    ds_read_b128 v[32:35], v221 offset:2048
    ds_read_b128 v[36:39], v221 offset:3072
    ds_read_b128 v[40:43], v221 offset:6144
    ds_read_b128 v[44:47], v221 offset:7168
    s_add_u32 s64, s76, 0
    s_waitcnt lgkmcnt(6)
    buffer_store_dwordx4 v[16:19], v218, s[32:35], s64 offen offset:0 sc1
    buffer_store_dwordx4 v[20:23], v219, s[32:35], s64 offen offset:2048 sc1
    s_add_u32 s64, s76, 8192
    s_waitcnt lgkmcnt(4)
    buffer_store_dwordx4 v[24:27], v219, s[32:35], s64 offen offset:0 sc1
    buffer_store_dwordx4 v[28:31], v218, s[32:35], s64 offen offset:2048 sc1
    s_add_u32 s64, s76, 4096
    s_waitcnt lgkmcnt(2)
    buffer_store_dwordx4 v[32:35], v219, s[32:35], s64 offen offset:0 sc1
    buffer_store_dwordx4 v[36:39], v218, s[32:35], s64 offen offset:2048 sc1
    s_add_u32 s64, s76, 12288
    s_waitcnt lgkmcnt(0)
    buffer_store_dwordx4 v[40:43], v218, s[32:35], s64 offen offset:0 sc1
    buffer_store_dwordx4 v[44:47], v219, s[32:35], s64 offen offset:2048 sc1
    s_barrier
    s_waitcnt vmcnt(0)
    buffer_store_dword v224, v227, s[40:43], s101 offen
    buffer_store_dword v224, v223, s[40:43], s101 offen sc1
    ds_read_b128 v[16:19], v221 offset:8192
    ds_read_b128 v[20:23], v221 offset:9216
    ds_read_b128 v[24:27], v221 offset:12288
    ds_read_b128 v[28:31], v221 offset:13312
    ds_read_b128 v[32:35], v221 offset:10240
    ds_read_b128 v[36:39], v221 offset:11264
    ds_read_b128 v[40:43], v221 offset:14336
    ds_read_b128 v[44:47], v221 offset:15360
    s_add_u32 s64, s76, 16384
    s_waitcnt lgkmcnt(6)
    buffer_store_dwordx4 v[16:19], v219, s[32:35], s64 offen offset:0 sc1
    buffer_store_dwordx4 v[20:23], v218, s[32:35], s64 offen offset:2048 sc1
    s_add_u32 s64, s76, 24576
    s_waitcnt lgkmcnt(4)
    buffer_store_dwordx4 v[24:27], v218, s[32:35], s64 offen offset:0 sc1
    buffer_store_dwordx4 v[28:31], v219, s[32:35], s64 offen offset:2048 sc1
    s_add_u32 s64, s76, 20480
    s_waitcnt lgkmcnt(2)
    buffer_store_dwordx4 v[32:35], v218, s[32:35], s64 offen offset:0 sc1
    buffer_store_dwordx4 v[36:39], v219, s[32:35], s64 offen offset:2048 sc1
    s_add_u32 s64, s76, 28672
    s_waitcnt lgkmcnt(0)
    buffer_store_dwordx4 v[40:43], v219, s[32:35], s64 offen offset:0 sc1
    buffer_store_dwordx4 v[44:47], v218, s[32:35], s64 offen offset:2048 sc1
    s_barrier
    ds_read_b128 v[16:19], v221 offset:16384
    ds_read_b128 v[20:23], v221 offset:17408
    ds_read_b128 v[24:27], v221 offset:20480
    ds_read_b128 v[28:31], v221 offset:21504
    ds_read_b128 v[32:35], v221 offset:18432
    ds_read_b128 v[36:39], v221 offset:19456
    ds_read_b128 v[40:43], v221 offset:22528
    ds_read_b128 v[44:47], v221 offset:23552
    s_add_u32 s64, s76, 32768
    s_waitcnt lgkmcnt(6)
    buffer_store_dwordx4 v[16:19], v218, s[32:35], s64 offen offset:0 sc1
    buffer_store_dwordx4 v[20:23], v219, s[32:35], s64 offen offset:2048 sc1
    s_add_u32 s64, s76, 40960
    s_waitcnt lgkmcnt(4)
    buffer_store_dwordx4 v[24:27], v219, s[32:35], s64 offen offset:0 sc1
    buffer_store_dwordx4 v[28:31], v218, s[32:35], s64 offen offset:2048 sc1
    s_add_u32 s64, s76, 36864
    s_waitcnt lgkmcnt(2)
    buffer_store_dwordx4 v[32:35], v219, s[32:35], s64 offen offset:0 sc1
    buffer_store_dwordx4 v[36:39], v218, s[32:35], s64 offen offset:2048 sc1
    s_add_u32 s64, s76, 45056
    s_waitcnt lgkmcnt(0)
    buffer_store_dwordx4 v[40:43], v218, s[32:35], s64 offen offset:0 sc1
    buffer_store_dwordx4 v[44:47], v219, s[32:35], s64 offen offset:2048 sc1
    s_barrier
    s_add_u32 s65, s77, 0
    s_add_u32 m0, s97, 155648
    s_nop 0
    buffer_load_dwordx4 v208, s[32:35], s65 offen offset:0 lds
    buffer_load_dwordx4 v209, s[32:35], s65 offen offset:1024 lds
    buffer_load_dwordx4 v210, s[32:35], s65 offen offset:2048 lds
    buffer_load_dwordx4 v211, s[32:35], s65 offen offset:3072 lds
    ds_read_b128 v[16:19], v220 offset:24576
    ds_read_b128 v[20:23], v220 offset:25600
    ds_read_b128 v[24:27], v220 offset:26624
    ds_read_b128 v[28:31], v220 offset:27648
    s_add_u32 s64, s76, 49152
    s_waitcnt lgkmcnt(2)
    buffer_store_dwordx4 v[16:19], v217, s[32:35], s64 offen offset:0 sc1
    buffer_store_dwordx4 v[20:23], v216, s[32:35], s64 offen offset:2048 sc1
    s_add_u32 s64, s76, 53248
    s_waitcnt lgkmcnt(0)
    buffer_store_dwordx4 v[24:27], v216, s[32:35], s64 offen offset:0 sc1
    buffer_store_dwordx4 v[28:31], v217, s[32:35], s64 offen offset:2048 sc1
    s_add_u32 s65, s77, 65536
    s_add_u32 m0, s97, 0
    s_nop 0
    buffer_load_dwordx4 v208, s[32:35], s65 offen offset:0 lds
    buffer_load_dwordx4 v209, s[32:35], s65 offen offset:1024 lds
    buffer_load_dwordx4 v210, s[32:35], s65 offen offset:2048 lds
    buffer_load_dwordx4 v211, s[32:35], s65 offen offset:3072 lds
    s_add_u32 s65, s78, 0
    s_add_u32 m0, s97, 32768
    s_nop 0
    buffer_load_dwordx4 v208, s[32:35], s65 offen offset:0 lds
    buffer_load_dwordx4 v209, s[32:35], s65 offen offset:1024 lds
    buffer_load_dwordx4 v210, s[32:35], s65 offen offset:2048 lds
    buffer_load_dwordx4 v211, s[32:35], s65 offen offset:3072 lds
    s_barrier
    s_add_u32 s65, s78, 65536
    s_add_u32 m0, s97, 8192
    s_nop 0
    buffer_load_dwordx4 v208, s[32:35], s65 offen offset:0 lds
    buffer_load_dwordx4 v209, s[32:35], s65 offen offset:1024 lds
    buffer_load_dwordx4 v210, s[32:35], s65 offen offset:2048 lds
    buffer_load_dwordx4 v211, s[32:35], s65 offen offset:3072 lds
    s_add_u32 s65, s79, 0
    s_add_u32 m0, s97, 40960
    s_nop 0
    buffer_load_dwordx4 v208, s[32:35], s65 offen offset:0 lds
    buffer_load_dwordx4 v209, s[32:35], s65 offen offset:1024 lds
    buffer_load_dwordx4 v210, s[32:35], s65 offen offset:2048 lds
    buffer_load_dwordx4 v211, s[32:35], s65 offen offset:3072 lds
    s_waitcnt vmcnt(20)
    s_barrier
    s_add_u32 s65, s79, 65536
    s_add_u32 m0, s97, 16384
    s_nop 0
    buffer_load_dwordx4 v208, s[32:35], s65 offen offset:0 lds
    buffer_load_dwordx4 v209, s[32:35], s65 offen offset:1024 lds
    buffer_load_dwordx4 v210, s[32:35], s65 offen offset:2048 lds
    buffer_load_dwordx4 v211, s[32:35], s65 offen offset:3072 lds
    s_add_u32 s65, s80, 0
    s_add_u32 m0, s97, 49152
    s_nop 0
    buffer_load_dwordx4 v208, s[32:35], s65 offen offset:0 lds
    buffer_load_dwordx4 v209, s[32:35], s65 offen offset:1024 lds
    buffer_load_dwordx4 v210, s[32:35], s65 offen offset:2048 lds
    buffer_load_dwordx4 v211, s[32:35], s65 offen offset:3072 lds
    s_waitcnt vmcnt(16)
    s_barrier
    s_cmp_eq_u32 s96, 0
    s_cbranch_scc0 L_f2
    buffer_store_dword v224, v225, s[40:43], s101 offen offset:256 sc1
L_f2:
    s_add_u32 s65, s80, 65536
    s_add_u32 m0, s97, 24576
    s_nop 0
    buffer_load_dwordx4 v208, s[32:35], s65 offen offset:0 lds
    buffer_load_dwordx4 v209, s[32:35], s65 offen offset:1024 lds
    buffer_load_dwordx4 v210, s[32:35], s65 offen offset:2048 lds
    buffer_load_dwordx4 v211, s[32:35], s65 offen offset:3072 lds
    s_add_u32 s65, s81, 0
    s_add_u32 m0, s97, 155648
    s_nop 0
    buffer_load_dwordx4 v208, s[32:35], s65 offen offset:0 lds
    buffer_load_dwordx4 v209, s[32:35], s65 offen offset:1024 lds
    buffer_load_dwordx4 v210, s[32:35], s65 offen offset:2048 lds
    buffer_load_dwordx4 v211, s[32:35], s65 offen offset:3072 lds
    s_waitcnt vmcnt(16)
    s_barrier
    s_add_u32 s65, s81, 65536
    s_add_u32 m0, s97, 0
    s_nop 0
    buffer_load_dwordx4 v208, s[32:35], s65 offen offset:0 lds
    buffer_load_dwordx4 v209, s[32:35], s65 offen offset:1024 lds
    buffer_load_dwordx4 v210, s[32:35], s65 offen offset:2048 lds
    buffer_load_dwordx4 v211, s[32:35], s65 offen offset:3072 lds
    s_add_u32 s65, s82, 0
    s_add_u32 m0, s97, 32768
    s_nop 0
    buffer_load_dwordx4 v208, s[32:35], s65 offen offset:0 lds
    buffer_load_dwordx4 v209, s[32:35], s65 offen offset:1024 lds
    buffer_load_dwordx4 v210, s[32:35], s65 offen offset:2048 lds
    buffer_load_dwordx4 v211, s[32:35], s65 offen offset:3072 lds
    s_waitcnt vmcnt(16)
    s_barrier
    buffer_load_dword v226, v222, s[40:43], s100 offen offset:256 sc1
    s_add_u32 s65, s82, 65536
    s_add_u32 m0, s97, 8192
    s_nop 0
    buffer_load_dwordx4 v208, s[32:35], s65 offen offset:0 lds
    buffer_load_dwordx4 v209, s[32:35], s65 offen offset:1024 lds
    buffer_load_dwordx4 v210, s[32:35], s65 offen offset:2048 lds
    buffer_load_dwordx4 v211, s[32:35], s65 offen offset:3072 lds
    s_add_u32 s65, s83, 0
    s_add_u32 m0, s97, 40960
    s_nop 0
    buffer_load_dwordx4 v208, s[32:35], s65 offen offset:0 lds
    buffer_load_dwordx4 v209, s[32:35], s65 offen offset:1024 lds
    buffer_load_dwordx4 v210, s[32:35], s65 offen offset:2048 lds
    buffer_load_dwordx4 v211, s[32:35], s65 offen offset:3072 lds
    s_waitcnt vmcnt(17)
    s_barrier
    s_waitcnt vmcnt(8)
    v_cmp_ne_u32 vcc, 1, v226
    s_nop 1
    s_cbranch_vccz L_p2_go
    s_mov_b32 s63, 0
L_p2:
    s_sleep 2
    buffer_load_dword v226, v222, s[40:43], s100 offen offset:256 sc1
L_p2_chk:
    s_add_u32 s63, s63, 1
    s_waitcnt vmcnt(0)
    v_cmp_ne_u32 vcc, 1, v226
    s_cmp_ge_u32 s63, 131072
    s_cbranch_scc1 L_p2_go
    s_nop 0
    s_cbranch_vccnz L_p2
L_p2_go:
    s_add_u32 s65, s83, 65536
    s_add_u32 m0, s97, 16384
    s_nop 0
    buffer_load_dwordx4 v208, s[32:35], s65 offen offset:0 lds
    buffer_load_dwordx4 v209, s[32:35], s65 offen offset:1024 lds
    buffer_load_dwordx4 v210, s[32:35], s65 offen offset:2048 lds
    buffer_load_dwordx4 v211, s[32:35], s65 offen offset:3072 lds
    s_add_u32 s65, s77, 16384
    s_add_u32 m0, s97, 49152
    s_nop 0
    buffer_load_dwordx4 v212, s[32:35], s65 offen offset:0 lds
    buffer_load_dwordx4 v213, s[32:35], s65 offen offset:1024 lds
    buffer_load_dwordx4 v214, s[32:35], s65 offen offset:2048 lds
    buffer_load_dwordx4 v215, s[32:35], s65 offen offset:3072 lds
    s_waitcnt vmcnt(17)
    s_barrier
    s_add_u32 s65, s77, 81920
    s_add_u32 m0, s97, 24576
    s_nop 0
    buffer_load_dwordx4 v212, s[32:35], s65 offen offset:0 lds
    buffer_load_dwordx4 v213, s[32:35], s65 offen offset:1024 lds
    buffer_load_dwordx4 v214, s[32:35], s65 offen offset:2048 lds
    buffer_load_dwordx4 v215, s[32:35], s65 offen offset:3072 lds
    s_add_u32 s65, s77, 49152
    s_add_u32 m0, s97, 155648
    s_nop 0
    buffer_load_dwordx4 v212, s[32:35], s65 offen offset:0 lds
    buffer_load_dwordx4 v213, s[32:35], s65 offen offset:1024 lds
    buffer_load_dwordx4 v214, s[32:35], s65 offen offset:2048 lds
    buffer_load_dwordx4 v215, s[32:35], s65 offen offset:3072 lds
    s_waitcnt vmcnt(16)
    s_barrier
    s_add_u32 s65, s77, 32768
    s_add_u32 m0, s97, 0
    s_nop 0
    buffer_load_dwordx4 v208, s[32:35], s65 offen offset:0 lds
    buffer_load_dwordx4 v209, s[32:35], s65 offen offset:1024 lds
    buffer_load_dwordx4 v210, s[32:35], s65 offen offset:2048 lds
    buffer_load_dwordx4 v211, s[32:35], s65 offen offset:3072 lds
    s_add_u32 s65, s77, 98304
    s_add_u32 m0, s97, 32768
    s_nop 0
    buffer_load_dwordx4 v208, s[32:35], s65 offen offset:0 lds
    buffer_load_dwordx4 v209, s[32:35], s65 offen offset:1024 lds
    buffer_load_dwordx4 v210, s[32:35], s65 offen offset:2048 lds
    s_waitcnt vmcnt(15)
    s_barrier
    buffer_load_dwordx4 v211, s[32:35], s65 offen offset:3072 lds
    s_add_u32 s65, s78, 16384
    s_add_u32 m0, s97, 8192
    s_nop 0
    buffer_load_dwordx4 v212, s[32:35], s65 offen offset:0 lds
    buffer_load_dwordx4 v213, s[32:35], s65 offen offset:1024 lds
    buffer_load_dwordx4 v214, s[32:35], s65 offen offset:2048 lds
    buffer_load_dwordx4 v215, s[32:35], s65 offen offset:3072 lds
    s_add_u32 s65, s78, 81920
    s_add_u32 m0, s97, 40960
    s_nop 0
    buffer_load_dwordx4 v212, s[32:35], s65 offen offset:0 lds
    buffer_load_dwordx4 v213, s[32:35], s65 offen offset:1024 lds
    buffer_load_dwordx4 v214, s[32:35], s65 offen offset:2048 lds
    s_waitcnt vmcnt(15)
    s_barrier
    buffer_load_dwordx4 v215, s[32:35], s65 offen offset:3072 lds
    s_add_u32 s65, s78, 49152
    s_add_u32 m0, s97, 16384
    s_nop 0
    buffer_load_dwordx4 v212, s[32:35], s65 offen offset:0 lds
    buffer_load_dwordx4 v213, s[32:35], s65 offen offset:1024 lds
    buffer_load_dwordx4 v214, s[32:35], s65 offen offset:2048 lds
    buffer_load_dwordx4 v215, s[32:35], s65 offen offset:3072 lds
    s_add_u32 s65, s78, 32768
    s_add_u32 m0, s97, 49152
    s_nop 0
    buffer_load_dwordx4 v208, s[32:35], s65 offen offset:0 lds
    buffer_load_dwordx4 v209, s[32:35], s65 offen offset:1024 lds
    s_waitcnt vmcnt(14)
    s_barrier
    buffer_load_dwordx4 v210, s[32:35], s65 offen offset:2048 lds
    buffer_load_dwordx4 v211, s[32:35], s65 offen offset:3072 lds
    s_add_u32 s65, s78, 98304
    s_add_u32 m0, s97, 24576
    s_nop 0
    buffer_load_dwordx4 v208, s[32:35], s65 offen offset:0 lds
    buffer_load_dwordx4 v209, s[32:35], s65 offen offset:1024 lds
    buffer_load_dwordx4 v210, s[32:35], s65 offen offset:2048 lds
    buffer_load_dwordx4 v211, s[32:35], s65 offen offset:3072 lds
    s_add_u32 s65, s79, 16384
    s_add_u32 m0, s97, 155648
    s_nop 0
    buffer_load_dwordx4 v212, s[32:35], s65 offen offset:0 lds
    buffer_load_dwordx4 v213, s[32:35], s65 offen offset:1024 lds
    s_waitcnt vmcnt(14)
    s_barrier
    buffer_load_dwordx4 v214, s[32:35], s65 offen offset:2048 lds
    buffer_load_dwordx4 v215, s[32:35], s65 offen offset:3072 lds
    s_add_u32 s65, s79, 81920
    s_add_u32 m0, s97, 0
    s_nop 0
    buffer_load_dwordx4 v212, s[32:35], s65 offen offset:0 lds
    buffer_load_dwordx4 v213, s[32:35], s65 offen offset:1024 lds
    buffer_load_dwordx4 v214, s[32:35], s65 offen offset:2048 lds
    buffer_load_dwordx4 v215, s[32:35], s65 offen offset:3072 lds
    s_add_u32 s65, s79, 49152
    s_add_u32 m0, s97, 32768
    s_nop 0
    buffer_load_dwordx4 v212, s[32:35], s65 offen offset:0 lds
    s_waitcnt vmcnt(13)
    s_barrier
    buffer_load_dwordx4 v213, s[32:35], s65 offen offset:1024 lds
    buffer_load_dwordx4 v214, s[32:35], s65 offen offset:2048 lds
    buffer_load_dwordx4 v215, s[32:35], s65 offen offset:3072 lds
    s_add_u32 s65, s79, 32768
    s_add_u32 m0, s97, 8192
    s_nop 0
    buffer_load_dwordx4 v208, s[32:35], s65 offen offset:0 lds
    buffer_load_dwordx4 v209, s[32:35], s65 offen offset:1024 lds
    buffer_load_dwordx4 v210, s[32:35], s65 offen offset:2048 lds
    buffer_load_dwordx4 v211, s[32:35], s65 offen offset:3072 lds
    s_add_u32 s65, s79, 98304
    s_add_u32 m0, s97, 40960
    s_nop 0
    buffer_load_dwordx4 v208, s[32:35], s65 offen offset:0 lds
    s_waitcnt vmcnt(13)
    s_barrier
    buffer_load_dwordx4 v209, s[32:35], s65 offen offset:1024 lds
    buffer_load_dwordx4 v210, s[32:35], s65 offen offset:2048 lds
    buffer_load_dwordx4 v211, s[32:35], s65 offen offset:3072 lds
    s_add_u32 s65, s80, 16384
    s_add_u32 m0, s97, 16384
    s_nop 0
    buffer_load_dwordx4 v212, s[32:35], s65 offen offset:0 lds
    buffer_load_dwordx4 v213, s[32:35], s65 offen offset:1024 lds
    buffer_load_dwordx4 v214, s[32:35], s65 offen offset:2048 lds
    buffer_load_dwordx4 v215, s[32:35], s65 offen offset:3072 lds
    s_waitcnt vmcnt(12)
    s_barrier
    s_add_u32 s65, s80, 81920
    s_add_u32 m0, s97, 49152
    s_nop 0
    buffer_load_dwordx4 v212, s[32:35], s65 offen offset:0 lds
    buffer_load_dwordx4 v213, s[32:35], s65 offen offset:1024 lds
    buffer_load_dwordx4 v214, s[32:35], s65 offen offset:2048 lds
    buffer_load_dwordx4 v215, s[32:35], s65 offen offset:3072 lds
    s_add_u32 s65, s80, 49152
    s_add_u32 m0, s97, 24576
    s_nop 0
    buffer_load_dwordx4 v212, s[32:35], s65 offen offset:0 lds
    buffer_load_dwordx4 v213, s[32:35], s65 offen offset:1024 lds
    buffer_load_dwordx4 v214, s[32:35], s65 offen offset:2048 lds
    buffer_load_dwordx4 v215, s[32:35], s65 offen offset:3072 lds
    s_waitcnt vmcnt(12)
    s_barrier
    s_add_u32 s65, s80, 32768
    s_add_u32 m0, s97, 155648
    s_nop 0
    buffer_load_dwordx4 v208, s[32:35], s65 offen offset:0 lds
    buffer_load_dwordx4 v209, s[32:35], s65 offen offset:1024 lds
    buffer_load_dwordx4 v210, s[32:35], s65 offen offset:2048 lds
    buffer_load_dwordx4 v211, s[32:35], s65 offen offset:3072 lds
    s_add_u32 s65, s80, 98304
    s_add_u32 m0, s97, 0
    s_nop 0
    buffer_load_dwordx4 v208, s[32:35], s65 offen offset:0 lds
    buffer_load_dwordx4 v209, s[32:35], s65 offen offset:1024 lds
    buffer_load_dwordx4 v210, s[32:35], s65 offen offset:2048 lds
    s_waitcnt vmcnt(11)
    s_barrier
    buffer_load_dwordx4 v211, s[32:35], s65 offen offset:3072 lds
    s_add_u32 s65, s81, 16384
    s_add_u32 m0, s97, 32768
    s_nop 0
    buffer_load_dwordx4 v212, s[32:35], s65 offen offset:0 lds
    buffer_load_dwordx4 v213, s[32:35], s65 offen offset:1024 lds
    buffer_load_dwordx4 v214, s[32:35], s65 offen offset:2048 lds
    buffer_load_dwordx4 v215, s[32:35], s65 offen offset:3072 lds
    s_add_u32 s65, s81, 81920
    s_add_u32 m0, s97, 8192
    s_nop 0
    buffer_load_dwordx4 v212, s[32:35], s65 offen offset:0 lds
    buffer_load_dwordx4 v213, s[32:35], s65 offen offset:1024 lds
    buffer_load_dwordx4 v214, s[32:35], s65 offen offset:2048 lds
    s_waitcnt vmcnt(11)
    s_barrier
    buffer_load_dwordx4 v215, s[32:35], s65 offen offset:3072 lds
    s_add_u32 s65, s81, 49152
    s_add_u32 m0, s97, 40960
    s_nop 0
    buffer_load_dwordx4 v212, s[32:35], s65 offen offset:0 lds
    buffer_load_dwordx4 v213, s[32:35], s65 offen offset:1024 lds
    buffer_load_dwordx4 v214, s[32:35], s65 offen offset:2048 lds
    buffer_load_dwordx4 v215, s[32:35], s65 offen offset:3072 lds
    s_add_u32 s65, s81, 32768
    s_add_u32 m0, s97, 16384
    s_nop 0
    buffer_load_dwordx4 v208, s[32:35], s65 offen offset:0 lds
    buffer_load_dwordx4 v209, s[32:35], s65 offen offset:1024 lds
    s_waitcnt vmcnt(10)
    s_barrier
    buffer_load_dwordx4 v210, s[32:35], s65 offen offset:2048 lds
    buffer_load_dwordx4 v211, s[32:35], s65 offen offset:3072 lds
    s_add_u32 s65, s81, 98304
    s_add_u32 m0, s97, 49152
    s_nop 0
    buffer_load_dwordx4 v208, s[32:35], s65 offen offset:0 lds
    buffer_load_dwordx4 v209, s[32:35], s65 offen offset:1024 lds
    buffer_load_dwordx4 v210, s[32:35], s65 offen offset:2048 lds
    buffer_load_dwordx4 v211, s[32:35], s65 offen offset:3072 lds
    s_add_u32 s65, s82, 16384
    s_add_u32 m0, s97, 24576
    s_nop 0
    buffer_load_dwordx4 v212, s[32:35], s65 offen offset:0 lds
    buffer_load_dwordx4 v213, s[32:35], s65 offen offset:1024 lds
    s_waitcnt vmcnt(10)
    s_barrier
    buffer_load_dwordx4 v214, s[32:35], s65 offen offset:2048 lds
    buffer_load_dwordx4 v215, s[32:35], s65 offen offset:3072 lds
    s_add_u32 s65, s82, 81920
    s_add_u32 m0, s97, 155648
    s_nop 0
    buffer_load_dwordx4 v212, s[32:35], s65 offen offset:0 lds
    buffer_load_dwordx4 v213, s[32:35], s65 offen offset:1024 lds
    buffer_load_dwordx4 v214, s[32:35], s65 offen offset:2048 lds
    buffer_load_dwordx4 v215, s[32:35], s65 offen offset:3072 lds
    s_add_u32 s65, s82, 49152
    s_add_u32 m0, s97, 0
    s_nop 0
    buffer_load_dwordx4 v212, s[32:35], s65 offen offset:0 lds
    s_waitcnt vmcnt(9)
    s_barrier
    buffer_load_dwordx4 v213, s[32:35], s65 offen offset:1024 lds
    buffer_load_dwordx4 v214, s[32:35], s65 offen offset:2048 lds
    buffer_load_dwordx4 v215, s[32:35], s65 offen offset:3072 lds
    s_add_u32 s65, s82, 32768
    s_add_u32 m0, s97, 32768
    s_nop 0
    buffer_load_dwordx4 v208, s[32:35], s65 offen offset:0 lds
    buffer_load_dwordx4 v209, s[32:35], s65 offen offset:1024 lds
    buffer_load_dwordx4 v210, s[32:35], s65 offen offset:2048 lds
    buffer_load_dwordx4 v211, s[32:35], s65 offen offset:3072 lds
    s_add_u32 s65, s82, 98304
    s_add_u32 m0, s97, 8192
    s_nop 0
    buffer_load_dwordx4 v208, s[32:35], s65 offen offset:0 lds
    s_waitcnt vmcnt(9)
    s_barrier
    buffer_load_dwordx4 v209, s[32:35], s65 offen offset:1024 lds
    buffer_load_dwordx4 v210, s[32:35], s65 offen offset:2048 lds
    buffer_load_dwordx4 v211, s[32:35], s65 offen offset:3072 lds
    s_add_u32 s65, s83, 16384
    s_add_u32 m0, s97, 40960
    s_nop 0
    buffer_load_dwordx4 v212, s[32:35], s65 offen offset:0 lds
    buffer_load_dwordx4 v213, s[32:35], s65 offen offset:1024 lds
    buffer_load_dwordx4 v214, s[32:35], s65 offen offset:2048 lds
    buffer_load_dwordx4 v215, s[32:35], s65 offen offset:3072 lds
    s_waitcnt vmcnt(8)
    s_barrier
    s_add_u32 s65, s83, 81920
    s_add_u32 m0, s97, 16384
    s_nop 0
    buffer_load_dwordx4 v212, s[32:35], s65 offen offset:0 lds
    buffer_load_dwordx4 v213, s[32:35], s65 offen offset:1024 lds
    buffer_load_dwordx4 v214, s[32:35], s65 offen offset:2048 lds
    buffer_load_dwordx4 v215, s[32:35], s65 offen offset:3072 lds
    s_add_u32 s65, s83, 49152
    s_add_u32 m0, s97, 49152
    s_nop 0
    buffer_load_dwordx4 v212, s[32:35], s65 offen offset:0 lds
    buffer_load_dwordx4 v213, s[32:35], s65 offen offset:1024 lds
    buffer_load_dwordx4 v214, s[32:35], s65 offen offset:2048 lds
    buffer_load_dwordx4 v215, s[32:35], s65 offen offset:3072 lds
    s_waitcnt vmcnt(8)
    s_barrier
    s_add_u32 s65, s83, 32768
    s_add_u32 m0, s97, 24576
    s_nop 0
    buffer_load_dwordx4 v208, s[32:35], s65 offen offset:0 lds
    buffer_load_dwordx4 v209, s[32:35], s65 offen offset:1024 lds
    buffer_load_dwordx4 v210, s[32:35], s65 offen offset:2048 lds
    buffer_load_dwordx4 v211, s[32:35], s65 offen offset:3072 lds
    s_add_u32 s65, s83, 98304
    s_add_u32 m0, s97, 155648
    s_nop 0
    buffer_load_dwordx4 v208, s[32:35], s65 offen offset:0 lds
    buffer_load_dwordx4 v209, s[32:35], s65 offen offset:1024 lds
    buffer_load_dwordx4 v210, s[32:35], s65 offen offset:2048 lds
    buffer_load_dwordx4 v211, s[32:35], s65 offen offset:3072 lds
    s_waitcnt vmcnt(8)
    s_barrier
    s_waitcnt vmcnt(0)
    s_barrier
    s_endpgm
.p2align 12
L_compute:
    s_lshr_b32 s61, s3, 1
    s_and_b32 s62, s3, 1
    s_getpc_b64 s[68:69]
L_pc:
    s_sub_u32 s68, s68, L_pc-standalone__mixer_channel_mlp__prompt_kernel
    s_subb_u32 s69, s69, 0
    s_mov_b32 s70, L_codeend-standalone__mixer_channel_mlp__prompt_kernel
    s_mov_b32 s71, 0x20000
    s_lshr_b32 s64, s2, 3
    s_lshl_b32 s64, s64, 2
    s_add_u32 s64, s64, s3
    s_lshl_b32 s64, s64, 9
    v_and_b32 v4, 3, v254
    v_lshlrev_b32 v4, 7, v4
    buffer_load_dword v255, v4, s[68:71], s64 offen
    v_and_b32 v1, 15, v254
    v_lshrrev_b32 v2, 4, v254
    s_lshl_b32 s63, s61, 13
    v_lshlrev_b32 v3, 7, v1
    v_add_u32 v3, s63, v3
    v_and_b32 v4, 7, v1
    v_xor_b32 v4, v4, v2
    v_lshl_add_u32 v208, v4, 4, v3
    v_xor_b32 v209, 64, v208
    v_lshrrev_b32 v3, 2, v1
    v_lshl_add_u32 v3, v2, 3, v3
    v_mul_u32_u24 v3, 448, v3
    v_and_b32 v4, 3, v1
    v_lshl_add_u32 v3, v4, 3, v3
    v_and_b32 v4, 1, v2
    s_add_u32 s63, s62, 6
    v_xor_b32 v5, s63, v4
    v_lshl_add_u32 v212, v5, 5, v3
    s_lshl_b32 s63, s62, 8
    v_add_u32 v3, s63, v3
    v_lshlrev_b32 v4, 5, v4
    v_add_u32 v210, v3, v4
    v_sub_u32 v211, v3, v4
    v_add_u32 v213, 45056, v208
    v_add_u32 v214, 45056, v209
    v_add_u32 v215, 45056, v210
    v_add_u32 v216, 45056, v211
    v_add_u32 v217, 45056, v212
    v_add_u32 v218, 90112, v208
    v_add_u32 v219, 90112, v209
    v_add_u32 v220, 90112, v210
    v_add_u32 v221, 90112, v211
    v_add_u32 v222, 90112, v212
    s_lshl_b32 s63, s61, 12
    v_lshlrev_b32 v232, 4, v254
    v_add_u32 v232, s63, v232
    v_lshlrev_b32 v233, 3, v254
    v_add_u32 v233, s63, v233
    s_lshl_b32 s63, s62, 9
    v_add_u32 v227, s63, v233
    s_lshl_b32 s63, s62, 15
    v_add_u32 v226, s63, v232
    v_mov_b32 v228, 0xc0135761
    v_mov_b32 v229, 0xbdd2d3e8
    v_lshrrev_b32 v3, 2, v1
    v_lshl_add_u32 v3, v2, 2, v3
    v_and_b32 v4, 7, v3
    v_lshlrev_b32 v3, 8, v3
    v_and_b32 v5, 3, v1
    v_lshl_add_u32 v3, v5, 3, v3
    s_lshl_b32 s63, s62, 2
    s_lshl_b32 s64, s58, 1
    s_add_u32 s63, s63, s64
    s_xor_b32 s64, s63, 0
    v_xor_b32 v5, s64, v4
    v_lshl_add_u32 v234, v5, 5, v3
    s_xor_b32 s64, s63, 1
    v_xor_b32 v5, s64, v4
    v_lshl_add_u32 v235, v5, 5, v3
    s_xor_b32 s64, s63, 2
    v_xor_b32 v5, s64, v4
    v_lshl_add_u32 v236, v5, 5, v3
    s_xor_b32 s64, s63, 3
    v_xor_b32 v5, s64, v4
    v_lshl_add_u32 v237, v5, 5, v3
    v_add_u32 v238, 65536, v232
    v_add_u32 v239, 65536, v233
    v_add_u32 v240, 65536, v234
    v_add_u32 v241, 65536, v235
    v_add_u32 v242, 65536, v236
    v_add_u32 v243, 65536, v237
    v_add_u32 v244, 131072, v232
    v_add_u32 v245, 131072, v233
    v_add_u32 v246, 131072, v234
    v_add_u32 v247, 131072, v235
    v_add_u32 v248, 131072, v236
    v_add_u32 v249, 131072, v237
    s_lshl_b32 s64, s57, 8
    s_lshl_b32 s65, s63, 5
    s_add_u32 s74, s64, s65
    v_lshlrev_b32 v3, 11, v1
    v_and_b32 v4, 1, v2
    v_lshl_add_u32 v3, v4, 5, v3
    v_lshrrev_b32 v4, 1, v2
    v_lshl_add_u32 v230, v4, 4, v3
    s_lshl_b32 s64, s56, 18
    s_lshl_b32 s65, s61, 17
    s_add_u32 s64, s64, s65
    s_add_u32 s75, s64, s74
    s_add_u32 s76, s75, 32768
    s_add_u32 s77, s75, 65536
    s_add_u32 s78, s75, 98304
    s_lshl_b32 s64, s3, 12
    v_lshlrev_b32 v3, 4, v254
    v_add_u32 v231, s64, v3
    s_lshl_b32 s64, s62, 9
    s_add_u32 s64, s64, 155648
    v_lshlrev_b32 v3, 4, v2
    v_add_u32 v223, s64, v3
    s_lshl_b32 s64, s62, 6
    s_add_u32 s64, s64, 156032
    v_add_u32 v224, s64, v3
    s_lshl_b32 s64, s61, 9
    s_add_u32 s64, s64, 157440
    v_lshlrev_b32 v3, 3, v1
    v_add_u32 v225, s64, v3
    s_lshl_b32 s79, s99, 14
    s_xor_b32 s64, s99, 8
    s_lshl_b32 s80, s64, 14
    s_lshl_b32 s81, s99, 9
    s_lshl_b32 s82, s64, 9
    s_lshl_b32 s64, s3, 7
    s_add_u32 s64, s64, 9175040
    s_add_u32 s81, s81, s64
    s_add_u32 s82, s82, s64
    v_lshlrev_b32 v250, 3, v2
    s_lshl_b32 s64, s63, 5
    s_add_u32 s64, s64, 158464
    v_add_u32 v250, s64, v250
    s_mov_b32 s83, 0xffff0000
    s_waitcnt lgkmcnt(0)
    s_add_u32 s40, s18, 16777216
    s_addc_u32 s41, s19, 0
    s_mov_b32 s42, 18874368
    s_mov_b32 s43, 0x20000
    s_mov_b32 s36, s14
    s_mov_b32 s37, s15
    s_mov_b32 s38, 4194304
    s_mov_b32 s39, 0x20000
    s_barrier
    s_waitcnt vmcnt(0)
    v_mov_b32 v255, 1
    v_mov_b32 v251, 0
    s_mov_b64 vcc, -1
    s_cmp_eq_u32 s3, 0
    s_cbranch_scc1 L_wp0
    s_cmp_eq_u32 s3, 1
    s_cbranch_scc1 L_wp1
    s_cmp_eq_u32 s3, 2
    s_cbranch_scc1 L_wp2
    s_branch L_wp3
L_warm_done:
    s_mov_b64 vcc, 0
    s_setprio 1
    s_barrier
    s_nop 0
    ds_read_b64_tr_b16 v[176:177], v210 offset:16384
    ds_read_b64_tr_b16 v[178:179], v210 offset:18176
    ds_read_b64_tr_b16 v[180:181], v210 offset:30720
    ds_read_b64_tr_b16 v[182:183], v210 offset:32512
    ds_read_b128 v[112:115], v208 offset:0
    ds_read_b128 v[128:131], v209 offset:0
    ds_read_b128 v[116:119], v208 offset:2048
    ds_read_b128 v[132:135], v209 offset:2048
    ds_read_b128 v[120:123], v208 offset:4096
    ds_read_b128 v[136:139], v209 offset:4096
    ds_read_b128 v[124:127], v208 offset:6144
    ds_read_b128 v[140:143], v209 offset:6144
    ds_read_b64_tr_b16 v[184:185], v211 offset:16416
    ds_read_b64_tr_b16 v[186:187], v211 offset:18208
    ds_read_b64_tr_b16 v[188:189], v211 offset:30752
    ds_read_b64_tr_b16 v[190:191], v211 offset:32544
    ds_read_b64_tr_b16 v[192:193], v210 offset:16448
    ds_read_b64_tr_b16 v[194:195], v210 offset:18240
    ds_read_b64_tr_b16 v[196:197], v210 offset:30784
    ds_read_b64_tr_b16 v[198:199], v210 offset:32576
    s_waitcnt lgkmcnt(14)
    s_nop 0
    v_mfma_f32_16x16x32_bf16 v[0:3], v[176:179], v[112:115], 0
    ds_read_b64_tr_b16 v[200:201], v211 offset:16480
    v_mfma_f32_16x16x32_bf16 v[0:3], v[180:183], v[128:131], v[0:3]
    ds_read_b64_tr_b16 v[202:203], v211 offset:18272
    s_waitcnt lgkmcnt(14)
    s_nop 0
    v_mfma_f32_16x16x32_bf16 v[28:31], v[180:183], v[132:135], 0
    ds_read_b64_tr_b16 v[204:205], v211 offset:30816
    v_mfma_f32_16x16x32_bf16 v[28:31], v[176:179], v[116:119], v[28:31]
    ds_read_b64_tr_b16 v[206:207], v211 offset:32608
    s_waitcnt lgkmcnt(14)
    s_nop 0
    v_mfma_f32_16x16x32_bf16 v[56:59], v[176:179], v[120:123], 0
    v_mfma_f32_16x16x32_bf16 v[56:59], v[180:183], v[136:139], v[56:59]
    s_waitcnt lgkmcnt(12)
    s_nop 0
    v_mfma_f32_16x16x32_bf16 v[84:87], v[180:183], v[140:143], 0
    v_mfma_f32_16x16x32_bf16 v[84:87], v[176:179], v[124:127], v[84:87]
    s_waitcnt lgkmcnt(4)
    s_nop 0
    v_mfma_f32_16x16x32_bf16 v[88:91], v[184:187], v[124:127], 0
    ds_read_b64_tr_b16 v[176:177], v210 offset:16512
    v_mfma_f32_16x16x32_bf16 v[88:91], v[188:191], v[140:143], v[88:91]
    ds_read_b64_tr_b16 v[178:179], v210 offset:18304
    v_mfma_f32_16x16x32_bf16 v[60:63], v[188:191], v[136:139], 0
    ds_read_b64_tr_b16 v[180:181], v210 offset:30848
    v_mfma_f32_16x16x32_bf16 v[60:63], v[184:187], v[120:123], v[60:63]
    ds_read_b64_tr_b16 v[182:183], v210 offset:32640
    v_mfma_f32_16x16x32_bf16 v[32:35], v[184:187], v[116:119], 0
    v_mfma_f32_16x16x32_bf16 v[32:35], v[188:191], v[132:135], v[32:35]
    v_mfma_f32_16x16x32_bf16 v[4:7], v[188:191], v[128:131], 0
    v_mfma_f32_16x16x32_bf16 v[4:7], v[184:187], v[112:115], v[4:7]
    v_mfma_f32_16x16x32_bf16 v[8:11], v[192:195], v[112:115], 0
    ds_read_b64_tr_b16 v[184:185], v211 offset:16544
    v_mfma_f32_16x16x32_bf16 v[8:11], v[196:199], v[128:131], v[8:11]
    ds_read_b64_tr_b16 v[186:187], v211 offset:18336
    v_mfma_f32_16x16x32_bf16 v[36:39], v[196:199], v[132:135], 0
    ds_read_b64_tr_b16 v[188:189], v211 offset:30880
    v_mfma_f32_16x16x32_bf16 v[36:39], v[192:195], v[116:119], v[36:39]
    ds_read_b64_tr_b16 v[190:191], v211 offset:32672
    v_mfma_f32_16x16x32_bf16 v[64:67], v[192:195], v[120:123], 0
    v_mfma_f32_16x16x32_bf16 v[64:67], v[196:199], v[136:139], v[64:67]
    v_mfma_f32_16x16x32_bf16 v[92:95], v[196:199], v[140:143], 0
    v_mfma_f32_16x16x32_bf16 v[92:95], v[192:195], v[124:127], v[92:95]
    s_waitcnt lgkmcnt(4)
    s_nop 0
    v_mfma_f32_16x16x32_bf16 v[96:99], v[200:203], v[124:127], 0
    ds_read_b64_tr_b16 v[192:193], v212 offset:16384
    v_mfma_f32_16x16x32_bf16 v[96:99], v[204:207], v[140:143], v[96:99]
    ds_read_b64_tr_b16 v[194:195], v212 offset:18176
    v_mfma_f32_16x16x32_bf16 v[68:71], v[204:207], v[136:139], 0
    ds_read_b64_tr_b16 v[196:197], v212 offset:30720
    v_mfma_f32_16x16x32_bf16 v[68:71], v[200:203], v[120:123], v[68:71]
    ds_read_b64_tr_b16 v[198:199], v212 offset:32512
    v_mfma_f32_16x16x32_bf16 v[40:43], v[200:203], v[116:119], 0
    v_mfma_f32_16x16x32_bf16 v[40:43], v[204:207], v[132:135], v[40:43]
    v_mfma_f32_16x16x32_bf16 v[12:15], v[204:207], v[128:131], 0
    v_mfma_f32_16x16x32_bf16 v[12:15], v[200:203], v[112:115], v[12:15]
    v_mfma_f32_16x16x32_bf16 v[16:19], v[176:179], v[112:115], 0
    v_mfma_f32_16x16x32_bf16 v[16:19], v[180:183], v[128:131], v[16:19]
    s_waitcnt lgkmcnt(0)
    s_barrier
    v_mfma_f32_16x16x32_bf16 v[44:47], v[180:183], v[132:135], 0
    ds_read_b64_tr_b16 v[200:201], v215 offset:16384
    v_mfma_f32_16x16x32_bf16 v[44:47], v[176:179], v[116:119], v[44:47]
    ds_read_b64_tr_b16 v[202:203], v215 offset:18176
    v_mfma_f32_16x16x32_bf16 v[72:75], v[176:179], v[120:123], 0
    ds_read_b64_tr_b16 v[204:205], v215 offset:30720
    v_mfma_f32_16x16x32_bf16 v[72:75], v[180:183], v[136:139], v[72:75]
    ds_read_b64_tr_b16 v[206:207], v215 offset:32512
    v_mfma_f32_16x16x32_bf16 v[100:103], v[180:183], v[140:143], 0
    ds_read_b128 v[144:147], v213 offset:0
    v_mfma_f32_16x16x32_bf16 v[100:103], v[176:179], v[124:127], v[100:103]
    ds_read_b128 v[160:163], v214 offset:0
    v_mfma_f32_16x16x32_bf16 v[104:107], v[184:187], v[124:127], 0
    ds_read_b128 v[148:151], v213 offset:2048
    v_mfma_f32_16x16x32_bf16 v[104:107], v[188:191], v[140:143], v[104:107]
    ds_read_b128 v[164:167], v214 offset:2048
    v_mfma_f32_16x16x32_bf16 v[76:79], v[188:191], v[136:139], 0
    ds_read_b128 v[152:155], v213 offset:4096
    v_mfma_f32_16x16x32_bf16 v[76:79], v[184:187], v[120:123], v[76:79]
    ds_read_b128 v[168:171], v214 offset:4096
    v_mfma_f32_16x16x32_bf16 v[48:51], v[184:187], v[116:119], 0
    ds_read_b128 v[156:159], v213 offset:6144
    v_mfma_f32_16x16x32_bf16 v[48:51], v[188:191], v[132:135], v[48:51]
    ds_read_b128 v[172:175], v214 offset:6144
    v_mfma_f32_16x16x32_bf16 v[20:23], v[188:191], v[128:131], 0
    ds_read_b64_tr_b16 v[176:177], v216 offset:16416
    v_mfma_f32_16x16x32_bf16 v[20:23], v[184:187], v[112:115], v[20:23]
    ds_read_b64_tr_b16 v[178:179], v216 offset:18208
    v_mfma_f32_16x16x32_bf16 v[24:27], v[192:195], v[112:115], 0
    ds_read_b64_tr_b16 v[180:181], v216 offset:30752
    v_mfma_f32_16x16x32_bf16 v[24:27], v[196:199], v[128:131], v[24:27]
    ds_read_b64_tr_b16 v[182:183], v216 offset:32544
    v_mfma_f32_16x16x32_bf16 v[52:55], v[196:199], v[132:135], 0
    ds_read_b64_tr_b16 v[184:185], v215 offset:16448
    v_mfma_f32_16x16x32_bf16 v[52:55], v[192:195], v[116:119], v[52:55]
    ds_read_b64_tr_b16 v[186:187], v215 offset:18240
    v_mfma_f32_16x16x32_bf16 v[80:83], v[192:195], v[120:123], 0
    ds_read_b64_tr_b16 v[188:189], v215 offset:30784
    v_mfma_f32_16x16x32_bf16 v[80:83], v[196:199], v[136:139], v[80:83]
    ds_read_b64_tr_b16 v[190:191], v215 offset:32576
    v_mfma_f32_16x16x32_bf16 v[108:111], v[196:199], v[140:143], 0
    v_mfma_f32_16x16x32_bf16 v[108:111], v[192:195], v[124:127], v[108:111]
    s_waitcnt lgkmcnt(8)
    s_nop 0
    v_mfma_f32_16x16x32_bf16 v[0:3], v[200:203], v[144:147], v[0:3]
    ds_read_b64_tr_b16 v[192:193], v216 offset:16480
    v_mfma_f32_16x16x32_bf16 v[0:3], v[204:207], v[160:163], v[0:3]
    ds_read_b64_tr_b16 v[194:195], v216 offset:18272
    v_mfma_f32_16x16x32_bf16 v[28:31], v[204:207], v[164:167], v[28:31]
    ds_read_b64_tr_b16 v[196:197], v216 offset:30816
    v_mfma_f32_16x16x32_bf16 v[28:31], v[200:203], v[148:151], v[28:31]
    ds_read_b64_tr_b16 v[198:199], v216 offset:32608
    v_mfma_f32_16x16x32_bf16 v[56:59], v[200:203], v[152:155], v[56:59]
    v_mfma_f32_16x16x32_bf16 v[56:59], v[204:207], v[168:171], v[56:59]
    v_mfma_f32_16x16x32_bf16 v[84:87], v[204:207], v[172:175], v[84:87]
    v_mfma_f32_16x16x32_bf16 v[84:87], v[200:203], v[156:159], v[84:87]
    s_waitcnt lgkmcnt(4)
    s_nop 0
    v_mfma_f32_16x16x32_bf16 v[88:91], v[176:179], v[156:159], v[88:91]
    ds_read_b64_tr_b16 v[200:201], v215 offset:16512
    v_mfma_f32_16x16x32_bf16 v[88:91], v[180:183], v[172:175], v[88:91]
    ds_read_b64_tr_b16 v[202:203], v215 offset:18304
    v_mfma_f32_16x16x32_bf16 v[60:63], v[180:183], v[168:171], v[60:63]
    ds_read_b64_tr_b16 v[204:205], v215 offset:30848
    v_mfma_f32_16x16x32_bf16 v[60:63], v[176:179], v[152:155], v[60:63]
    ds_read_b64_tr_b16 v[206:207], v215 offset:32640
    v_mfma_f32_16x16x32_bf16 v[32:35], v[176:179], v[148:151], v[32:35]
    v_mfma_f32_16x16x32_bf16 v[32:35], v[180:183], v[164:167], v[32:35]
    v_mfma_f32_16x16x32_bf16 v[4:7], v[180:183], v[160:163], v[4:7]
    v_mfma_f32_16x16x32_bf16 v[4:7], v[176:179], v[144:147], v[4:7]
    v_mfma_f32_16x16x32_bf16 v[8:11], v[184:187], v[144:147], v[8:11]
    ds_read_b64_tr_b16 v[176:177], v216 offset:16544
    v_mfma_f32_16x16x32_bf16 v[8:11], v[188:191], v[160:163], v[8:11]
    ds_read_b64_tr_b16 v[178:179], v216 offset:18336
    v_mfma_f32_16x16x32_bf16 v[36:39], v[188:191], v[164:167], v[36:39]
    ds_read_b64_tr_b16 v[180:181], v216 offset:30880
    v_mfma_f32_16x16x32_bf16 v[36:39], v[184:187], v[148:151], v[36:39]
    ds_read_b64_tr_b16 v[182:183], v216 offset:32672
    v_mfma_f32_16x16x32_bf16 v[64:67], v[184:187], v[152:155], v[64:67]
    v_mfma_f32_16x16x32_bf16 v[64:67], v[188:191], v[168:171], v[64:67]
    v_mfma_f32_16x16x32_bf16 v[92:95], v[188:191], v[172:175], v[92:95]
    v_mfma_f32_16x16x32_bf16 v[92:95], v[184:187], v[156:159], v[92:95]
    s_waitcnt lgkmcnt(4)
    s_nop 0
    v_mfma_f32_16x16x32_bf16 v[96:99], v[192:195], v[156:159], v[96:99]
    ds_read_b64_tr_b16 v[184:185], v217 offset:16384
    v_mfma_f32_16x16x32_bf16 v[96:99], v[196:199], v[172:175], v[96:99]
    ds_read_b64_tr_b16 v[186:187], v217 offset:18176
    v_mfma_f32_16x16x32_bf16 v[68:71], v[196:199], v[168:171], v[68:71]
    ds_read_b64_tr_b16 v[188:189], v217 offset:30720
    v_mfma_f32_16x16x32_bf16 v[68:71], v[192:195], v[152:155], v[68:71]
    ds_read_b64_tr_b16 v[190:191], v217 offset:32512
    v_mfma_f32_16x16x32_bf16 v[40:43], v[192:195], v[148:151], v[40:43]
    v_mfma_f32_16x16x32_bf16 v[40:43], v[196:199], v[164:167], v[40:43]
    v_mfma_f32_16x16x32_bf16 v[12:15], v[196:199], v[160:163], v[12:15]
    v_mfma_f32_16x16x32_bf16 v[12:15], v[192:195], v[144:147], v[12:15]
    v_mfma_f32_16x16x32_bf16 v[16:19], v[200:203], v[144:147], v[16:19]
    v_mfma_f32_16x16x32_bf16 v[16:19], v[204:207], v[160:163], v[16:19]
    s_waitcnt lgkmcnt(0)
    s_barrier
    v_mfma_f32_16x16x32_bf16 v[44:47], v[204:207], v[164:167], v[44:47]
    ds_read_b64_tr_b16 v[192:193], v220 offset:16384
    v_mfma_f32_16x16x32_bf16 v[44:47], v[200:203], v[148:151], v[44:47]
    ds_read_b64_tr_b16 v[194:195], v220 offset:18176
    v_mfma_f32_16x16x32_bf16 v[72:75], v[200:203], v[152:155], v[72:75]
    ds_read_b64_tr_b16 v[196:197], v220 offset:30720
    v_mfma_f32_16x16x32_bf16 v[72:75], v[204:207], v[168:171], v[72:75]
    ds_read_b64_tr_b16 v[198:199], v220 offset:32512
    v_mfma_f32_16x16x32_bf16 v[100:103], v[204:207], v[172:175], v[100:103]
    ds_read_b128 v[112:115], v218 offset:0
    v_mfma_f32_16x16x32_bf16 v[100:103], v[200:203], v[156:159], v[100:103]
    ds_read_b128 v[128:131], v219 offset:0
    v_mfma_f32_16x16x32_bf16 v[104:107], v[176:179], v[156:159], v[104:107]
    ds_read_b128 v[116:119], v218 offset:2048
    v_mfma_f32_16x16x32_bf16 v[104:107], v[180:183], v[172:175], v[104:107]
    ds_read_b128 v[132:135], v219 offset:2048
    v_mfma_f32_16x16x32_bf16 v[76:79], v[180:183], v[168:171], v[76:79]
    ds_read_b128 v[120:123], v218 offset:4096
    v_mfma_f32_16x16x32_bf16 v[76:79], v[176:179], v[152:155], v[76:79]
    ds_read_b128 v[136:139], v219 offset:4096
    v_mfma_f32_16x16x32_bf16 v[48:51], v[176:179], v[148:151], v[48:51]
    ds_read_b128 v[124:127], v218 offset:6144
    v_mfma_f32_16x16x32_bf16 v[48:51], v[180:183], v[164:167], v[48:51]
    ds_read_b128 v[140:143], v219 offset:6144
    v_mfma_f32_16x16x32_bf16 v[20:23], v[180:183], v[160:163], v[20:23]
    ds_read_b64_tr_b16 v[200:201], v221 offset:16416
    v_mfma_f32_16x16x32_bf16 v[20:23], v[176:179], v[144:147], v[20:23]
    ds_read_b64_tr_b16 v[202:203], v221 offset:18208
    v_mfma_f32_16x16x32_bf16 v[24:27], v[184:187], v[144:147], v[24:27]
    ds_read_b64_tr_b16 v[204:205], v221 offset:30752
    v_mfma_f32_16x16x32_bf16 v[24:27], v[188:191], v[160:163], v[24:27]
    ds_read_b64_tr_b16 v[206:207], v221 offset:32544
    v_mfma_f32_16x16x32_bf16 v[52:55], v[188:191], v[164:167], v[52:55]
    ds_read_b64_tr_b16 v[176:177], v220 offset:16448
    v_mfma_f32_16x16x32_bf16 v[52:55], v[184:187], v[148:151], v[52:55]
    ds_read_b64_tr_b16 v[178:179], v220 offset:18240
    v_mfma_f32_16x16x32_bf16 v[80:83], v[184:187], v[152:155], v[80:83]
    ds_read_b64_tr_b16 v[180:181], v220 offset:30784
    v_mfma_f32_16x16x32_bf16 v[80:83], v[188:191], v[168:171], v[80:83]
    ds_read_b64_tr_b16 v[182:183], v220 offset:32576
    v_mfma_f32_16x16x32_bf16 v[108:111], v[188:191], v[172:175], v[108:111]
    v_mfma_f32_16x16x32_bf16 v[108:111], v[184:187], v[156:159], v[108:111]
    s_waitcnt lgkmcnt(8)
    s_nop 0
    v_mfma_f32_16x16x32_bf16 v[0:3], v[192:195], v[112:115], v[0:3]
    ds_read_b64_tr_b16 v[184:185], v221 offset:16480
    v_mfma_f32_16x16x32_bf16 v[0:3], v[196:199], v[128:131], v[0:3]
    ds_read_b64_tr_b16 v[186:187], v221 offset:18272
    v_mfma_f32_16x16x32_bf16 v[28:31], v[196:199], v[132:135], v[28:31]
    ds_read_b64_tr_b16 v[188:189], v221 offset:30816
    v_mfma_f32_16x16x32_bf16 v[28:31], v[192:195], v[116:119], v[28:31]
    ds_read_b64_tr_b16 v[190:191], v221 offset:32608
    v_mfma_f32_16x16x32_bf16 v[56:59], v[192:195], v[120:123], v[56:59]
    v_mfma_f32_16x16x32_bf16 v[56:59], v[196:199], v[136:139], v[56:59]
    v_mfma_f32_16x16x32_bf16 v[84:87], v[196:199], v[140:143], v[84:87]
    v_mfma_f32_16x16x32_bf16 v[84:87], v[192:195], v[124:127], v[84:87]
    s_waitcnt lgkmcnt(4)
    s_nop 0
    v_mfma_f32_16x16x32_bf16 v[88:91], v[200:203], v[124:127], v[88:91]
    ds_read_b64_tr_b16 v[192:193], v220 offset:16512
    v_mfma_f32_16x16x32_bf16 v[88:91], v[204:207], v[140:143], v[88:91]
    ds_read_b64_tr_b16 v[194:195], v220 offset:18304
    v_mfma_f32_16x16x32_bf16 v[60:63], v[204:207], v[136:139], v[60:63]
    ds_read_b64_tr_b16 v[196:197], v220 offset:30848
    v_mfma_f32_16x16x32_bf16 v[60:63], v[200:203], v[120:123], v[60:63]
    ds_read_b64_tr_b16 v[198:199], v220 offset:32640
    v_mfma_f32_16x16x32_bf16 v[32:35], v[200:203], v[116:119], v[32:35]
    v_mfma_f32_16x16x32_bf16 v[32:35], v[204:207], v[132:135], v[32:35]
    v_mfma_f32_16x16x32_bf16 v[4:7], v[204:207], v[128:131], v[4:7]
    v_mfma_f32_16x16x32_bf16 v[4:7], v[200:203], v[112:115], v[4:7]
    v_mfma_f32_16x16x32_bf16 v[8:11], v[176:179], v[112:115], v[8:11]
    ds_read_b64_tr_b16 v[200:201], v221 offset:16544
    v_mfma_f32_16x16x32_bf16 v[8:11], v[180:183], v[128:131], v[8:11]
    ds_read_b64_tr_b16 v[202:203], v221 offset:18336
    v_mfma_f32_16x16x32_bf16 v[36:39], v[180:183], v[132:135], v[36:39]
    ds_read_b64_tr_b16 v[204:205], v221 offset:30880
    v_mfma_f32_16x16x32_bf16 v[36:39], v[176:179], v[116:119], v[36:39]
    ds_read_b64_tr_b16 v[206:207], v221 offset:32672
    v_mfma_f32_16x16x32_bf16 v[64:67], v[176:179], v[120:123], v[64:67]
    v_mfma_f32_16x16x32_bf16 v[64:67], v[180:183], v[136:139], v[64:67]
    v_mfma_f32_16x16x32_bf16 v[92:95], v[180:183], v[140:143], v[92:95]
    v_mfma_f32_16x16x32_bf16 v[92:95], v[176:179], v[124:127], v[92:95]
    s_waitcnt lgkmcnt(4)
    s_nop 0
    v_mfma_f32_16x16x32_bf16 v[96:99], v[184:187], v[124:127], v[96:99]
    ds_read_b64_tr_b16 v[176:177], v222 offset:16384
    v_mfma_f32_16x16x32_bf16 v[96:99], v[188:191], v[140:143], v[96:99]
    ds_read_b64_tr_b16 v[178:179], v222 offset:18176
    v_mfma_f32_16x16x32_bf16 v[68:71], v[188:191], v[136:139], v[68:71]
    ds_read_b64_tr_b16 v[180:181], v222 offset:30720
    v_mfma_f32_16x16x32_bf16 v[68:71], v[184:187], v[120:123], v[68:71]
    ds_read_b64_tr_b16 v[182:183], v222 offset:32512
    v_mfma_f32_16x16x32_bf16 v[40:43], v[184:187], v[116:119], v[40:43]
    v_mfma_f32_16x16x32_bf16 v[40:43], v[188:191], v[132:135], v[40:43]
    v_mfma_f32_16x16x32_bf16 v[12:15], v[188:191], v[128:131], v[12:15]
    v_mfma_f32_16x16x32_bf16 v[12:15], v[184:187], v[112:115], v[12:15]
    v_mfma_f32_16x16x32_bf16 v[16:19], v[192:195], v[112:115], v[16:19]
    v_mfma_f32_16x16x32_bf16 v[16:19], v[196:199], v[128:131], v[16:19]
    s_waitcnt lgkmcnt(0)
    s_barrier
    v_mfma_f32_16x16x32_bf16 v[44:47], v[196:199], v[132:135], v[44:47]
    ds_read_b64_tr_b16 v[184:185], v210 offset:16384
    v_mfma_f32_16x16x32_bf16 v[44:47], v[192:195], v[116:119], v[44:47]
    ds_read_b64_tr_b16 v[186:187], v210 offset:18176
    v_mfma_f32_16x16x32_bf16 v[72:75], v[192:195], v[120:123], v[72:75]
    ds_read_b64_tr_b16 v[188:189], v210 offset:30720
    v_mfma_f32_16x16x32_bf16 v[72:75], v[196:199], v[136:139], v[72:75]
    ds_read_b64_tr_b16 v[190:191], v210 offset:32512
    v_mfma_f32_16x16x32_bf16 v[100:103], v[196:199], v[140:143], v[100:103]
    ds_read_b128 v[144:147], v208 offset:0
    v_mfma_f32_16x16x32_bf16 v[100:103], v[192:195], v[124:127], v[100:103]
    ds_read_b128 v[160:163], v209 offset:0
    v_mfma_f32_16x16x32_bf16 v[104:107], v[200:203], v[124:127], v[104:107]
    ds_read_b128 v[148:151], v208 offset:2048
    v_mfma_f32_16x16x32_bf16 v[104:107], v[204:207], v[140:143], v[104:107]
    ds_read_b128 v[164:167], v209 offset:2048
    v_mfma_f32_16x16x32_bf16 v[76:79], v[204:207], v[136:139], v[76:79]
    ds_read_b128 v[152:155], v208 offset:4096
    v_mfma_f32_16x16x32_bf16 v[76:79], v[200:203], v[120:123], v[76:79]
    ds_read_b128 v[168:171], v209 offset:4096
    v_mfma_f32_16x16x32_bf16 v[48:51], v[200:203], v[116:119], v[48:51]
    ds_read_b128 v[156:159], v208 offset:6144
    v_mfma_f32_16x16x32_bf16 v[48:51], v[204:207], v[132:135], v[48:51]
    ds_read_b128 v[172:175], v209 offset:6144
    v_mfma_f32_16x16x32_bf16 v[20:23], v[204:207], v[128:131], v[20:23]
    ds_read_b64_tr_b16 v[192:193], v211 offset:16416
    v_mfma_f32_16x16x32_bf16 v[20:23], v[200:203], v[112:115], v[20:23]
    ds_read_b64_tr_b16 v[194:195], v211 offset:18208
    v_mfma_f32_16x16x32_bf16 v[24:27], v[176:179], v[112:115], v[24:27]
    ds_read_b64_tr_b16 v[196:197], v211 offset:30752
    v_mfma_f32_16x16x32_bf16 v[24:27], v[180:183], v[128:131], v[24:27]
    ds_read_b64_tr_b16 v[198:199], v211 offset:32544
    v_mfma_f32_16x16x32_bf16 v[52:55], v[180:183], v[132:135], v[52:55]
    ds_read_b64_tr_b16 v[200:201], v210 offset:16448
    v_mfma_f32_16x16x32_bf16 v[52:55], v[176:179], v[116:119], v[52:55]
    ds_read_b64_tr_b16 v[202:203], v210 offset:18240
    v_mfma_f32_16x16x32_bf16 v[80:83], v[176:179], v[120:123], v[80:83]
    ds_read_b64_tr_b16 v[204:205], v210 offset:30784
    v_mfma_f32_16x16x32_bf16 v[80:83], v[180:183], v[136:139], v[80:83]
    ds_read_b64_tr_b16 v[206:207], v210 offset:32576
    v_mfma_f32_16x16x32_bf16 v[108:111], v[180:183], v[140:143], v[108:111]
    v_mfma_f32_16x16x32_bf16 v[108:111], v[176:179], v[124:127], v[108:111]
    s_waitcnt lgkmcnt(8)
    s_nop 0
    v_mfma_f32_16x16x32_bf16 v[0:3], v[184:187], v[144:147], v[0:3]
    ds_read_b64_tr_b16 v[176:177], v211 offset:16480
    v_mfma_f32_16x16x32_bf16 v[0:3], v[188:191], v[160:163], v[0:3]
    ds_read_b64_tr_b16 v[178:179], v211 offset:18272
    v_mfma_f32_16x16x32_bf16 v[28:31], v[188:191], v[164:167], v[28:31]
    ds_read_b64_tr_b16 v[180:181], v211 offset:30816
    v_mfma_f32_16x16x32_bf16 v[28:31], v[184:187], v[148:151], v[28:31]
    ds_read_b64_tr_b16 v[182:183], v211 offset:32608
    v_mfma_f32_16x16x32_bf16 v[56:59], v[184:187], v[152:155], v[56:59]
    v_mfma_f32_16x16x32_bf16 v[56:59], v[188:191], v[168:171], v[56:59]
    v_mfma_f32_16x16x32_bf16 v[84:87], v[188:191], v[172:175], v[84:87]
    v_mfma_f32_16x16x32_bf16 v[84:87], v[184:187], v[156:159], v[84:87]
    s_waitcnt lgkmcnt(4)
    s_nop 0
    v_mfma_f32_16x16x32_bf16 v[88:91], v[192:195], v[156:159], v[88:91]
    ds_read_b64_tr_b16 v[184:185], v210 offset:16512
    v_mfma_f32_16x16x32_bf16 v[88:91], v[196:199], v[172:175], v[88:91]
    ds_read_b64_tr_b16 v[186:187], v210 offset:18304
    v_mfma_f32_16x16x32_bf16 v[60:63], v[196:199], v[168:171], v[60:63]
    ds_read_b64_tr_b16 v[188:189], v210 offset:30848
    v_mfma_f32_16x16x32_bf16 v[60:63], v[192:195], v[152:155], v[60:63]
    ds_read_b64_tr_b16 v[190:191], v210 offset:32640
    v_mfma_f32_16x16x32_bf16 v[32:35], v[192:195], v[148:151], v[32:35]
    v_mfma_f32_16x16x32_bf16 v[32:35], v[196:199], v[164:167], v[32:35]
    v_mfma_f32_16x16x32_bf16 v[4:7], v[196:199], v[160:163], v[4:7]
    v_mfma_f32_16x16x32_bf16 v[4:7], v[192:195], v[144:147], v[4:7]
    v_mfma_f32_16x16x32_bf16 v[8:11], v[200:203], v[144:147], v[8:11]
    ds_read_b64_tr_b16 v[192:193], v211 offset:16544
    v_mfma_f32_16x16x32_bf16 v[8:11], v[204:207], v[160:163], v[8:11]
    ds_read_b64_tr_b16 v[194:195], v211 offset:18336
    v_mfma_f32_16x16x32_bf16 v[36:39], v[204:207], v[164:167], v[36:39]
    ds_read_b64_tr_b16 v[196:197], v211 offset:30880
    v_mfma_f32_16x16x32_bf16 v[36:39], v[200:203], v[148:151], v[36:39]
    ds_read_b64_tr_b16 v[198:199], v211 offset:32672
    v_mfma_f32_16x16x32_bf16 v[64:67], v[200:203], v[152:155], v[64:67]
    v_mfma_f32_16x16x32_bf16 v[64:67], v[204:207], v[168:171], v[64:67]
    v_mfma_f32_16x16x32_bf16 v[92:95], v[204:207], v[172:175], v[92:95]
    v_mfma_f32_16x16x32_bf16 v[92:95], v[200:203], v[156:159], v[92:95]
    s_waitcnt lgkmcnt(4)
    s_nop 0
    v_mfma_f32_16x16x32_bf16 v[96:99], v[176:179], v[156:159], v[96:99]
    ds_read_b64_tr_b16 v[200:201], v212 offset:16384
    v_mfma_f32_16x16x32_bf16 v[96:99], v[180:183], v[172:175], v[96:99]
    ds_read_b64_tr_b16 v[202:203], v212 offset:18176
    v_mfma_f32_16x16x32_bf16 v[68:71], v[180:183], v[168:171], v[68:71]
    ds_read_b64_tr_b16 v[204:205], v212 offset:30720
    v_mfma_f32_16x16x32_bf16 v[68:71], v[176:179], v[152:155], v[68:71]
    ds_read_b64_tr_b16 v[206:207], v212 offset:32512
    v_mfma_f32_16x16x32_bf16 v[40:43], v[176:179], v[148:151], v[40:43]
    v_mfma_f32_16x16x32_bf16 v[40:43], v[180:183], v[164:167], v[40:43]
    v_mfma_f32_16x16x32_bf16 v[12:15], v[180:183], v[160:163], v[12:15]
    v_mfma_f32_16x16x32_bf16 v[12:15], v[176:179], v[144:147], v[12:15]
    v_mfma_f32_16x16x32_bf16 v[16:19], v[184:187], v[144:147], v[16:19]
    v_mfma_f32_16x16x32_bf16 v[16:19], v[188:191], v[160:163], v[16:19]
    s_waitcnt lgkmcnt(0)
    s_barrier
    v_mfma_f32_16x16x32_bf16 v[44:47], v[188:191], v[164:167], v[44:47]
    ds_read_b64_tr_b16 v[176:177], v215 offset:16384
    v_mfma_f32_16x16x32_bf16 v[44:47], v[184:187], v[148:151], v[44:47]
    ds_read_b64_tr_b16 v[178:179], v215 offset:18176
    v_mfma_f32_16x16x32_bf16 v[72:75], v[184:187], v[152:155], v[72:75]
    ds_read_b64_tr_b16 v[180:181], v215 offset:30720
    v_mfma_f32_16x16x32_bf16 v[72:75], v[188:191], v[168:171], v[72:75]
    ds_read_b64_tr_b16 v[182:183], v215 offset:32512
    v_mfma_f32_16x16x32_bf16 v[100:103], v[188:191], v[172:175], v[100:103]
    ds_read_b128 v[112:115], v213 offset:0
    v_mfma_f32_16x16x32_bf16 v[100:103], v[184:187], v[156:159], v[100:103]
    ds_read_b128 v[128:131], v214 offset:0
    v_mfma_f32_16x16x32_bf16 v[104:107], v[192:195], v[156:159], v[104:107]
    ds_read_b128 v[116:119], v213 offset:2048
    v_mfma_f32_16x16x32_bf16 v[104:107], v[196:199], v[172:175], v[104:107]
    ds_read_b128 v[132:135], v214 offset:2048
    v_mfma_f32_16x16x32_bf16 v[76:79], v[196:199], v[168:171], v[76:79]
    ds_read_b128 v[120:123], v213 offset:4096
    v_mfma_f32_16x16x32_bf16 v[76:79], v[192:195], v[152:155], v[76:79]
    ds_read_b128 v[136:139], v214 offset:4096
    v_mfma_f32_16x16x32_bf16 v[48:51], v[192:195], v[148:151], v[48:51]
    ds_read_b128 v[124:127], v213 offset:6144
    v_mfma_f32_16x16x32_bf16 v[48:51], v[196:199], v[164:167], v[48:51]
    ds_read_b128 v[140:143], v214 offset:6144
    v_mfma_f32_16x16x32_bf16 v[20:23], v[196:199], v[160:163], v[20:23]
    ds_read_b64_tr_b16 v[184:185], v216 offset:16416
    v_mfma_f32_16x16x32_bf16 v[20:23], v[192:195], v[144:147], v[20:23]
    ds_read_b64_tr_b16 v[186:187], v216 offset:18208
    v_mfma_f32_16x16x32_bf16 v[24:27], v[200:203], v[144:147], v[24:27]
    ds_read_b64_tr_b16 v[188:189], v216 offset:30752
    v_mfma_f32_16x16x32_bf16 v[24:27], v[204:207], v[160:163], v[24:27]
    ds_read_b64_tr_b16 v[190:191], v216 offset:32544
    v_mfma_f32_16x16x32_bf16 v[52:55], v[204:207], v[164:167], v[52:55]
    ds_read_b64_tr_b16 v[192:193], v215 offset:16448
    v_mfma_f32_16x16x32_bf16 v[52:55], v[200:203], v[148:151], v[52:55]
    ds_read_b64_tr_b16 v[194:195], v215 offset:18240
    v_mfma_f32_16x16x32_bf16 v[80:83], v[200:203], v[152:155], v[80:83]
    ds_read_b64_tr_b16 v[196:197], v215 offset:30784
    v_mfma_f32_16x16x32_bf16 v[80:83], v[204:207], v[168:171], v[80:83]
    ds_read_b64_tr_b16 v[198:199], v215 offset:32576
L_wp0:
    s_cbranch_vccnz L_wp4
    s_nop 0
    v_mfma_f32_16x16x32_bf16 v[108:111], v[204:207], v[172:175], v[108:111]
    v_mfma_f32_16x16x32_bf16 v[108:111], v[200:203], v[156:159], v[108:111]
    s_waitcnt lgkmcnt(8)
    s_nop 0
    v_mfma_f32_16x16x32_bf16 v[0:3], v[176:179], v[112:115], v[0:3]
    ds_read_b64_tr_b16 v[200:201], v216 offset:16480
    v_mfma_f32_16x16x32_bf16 v[0:3], v[180:183], v[128:131], v[0:3]
    ds_read_b64_tr_b16 v[202:203], v216 offset:18272
    v_mfma_f32_16x16x32_bf16 v[28:31], v[180:183], v[132:135], v[28:31]
    ds_read_b64_tr_b16 v[204:205], v216 offset:30816
    v_mfma_f32_16x16x32_bf16 v[28:31], v[176:179], v[116:119], v[28:31]
    ds_read_b64_tr_b16 v[206:207], v216 offset:32608
    v_mfma_f32_16x16x32_bf16 v[56:59], v[176:179], v[120:123], v[56:59]
    v_mfma_f32_16x16x32_bf16 v[56:59], v[180:183], v[136:139], v[56:59]
    v_mfma_f32_16x16x32_bf16 v[84:87], v[180:183], v[140:143], v[84:87]
    v_mfma_f32_16x16x32_bf16 v[84:87], v[176:179], v[124:127], v[84:87]
    s_waitcnt lgkmcnt(4)
    s_nop 0
    v_mfma_f32_16x16x32_bf16 v[88:91], v[184:187], v[124:127], v[88:91]
    ds_read_b64_tr_b16 v[176:177], v215 offset:16512
    v_mfma_f32_16x16x32_bf16 v[88:91], v[188:191], v[140:143], v[88:91]
    ds_read_b64_tr_b16 v[178:179], v215 offset:18304
    v_mfma_f32_16x16x32_bf16 v[60:63], v[188:191], v[136:139], v[60:63]
    ds_read_b64_tr_b16 v[180:181], v215 offset:30848
    v_mfma_f32_16x16x32_bf16 v[60:63], v[184:187], v[120:123], v[60:63]
    ds_read_b64_tr_b16 v[182:183], v215 offset:32640
    v_mfma_f32_16x16x32_bf16 v[32:35], v[184:187], v[116:119], v[32:35]
    v_mfma_f32_16x16x32_bf16 v[32:35], v[188:191], v[132:135], v[32:35]
    v_mfma_f32_16x16x32_bf16 v[4:7], v[188:191], v[128:131], v[4:7]
    v_mfma_f32_16x16x32_bf16 v[4:7], v[184:187], v[112:115], v[4:7]
    v_mfma_f32_16x16x32_bf16 v[8:11], v[192:195], v[112:115], v[8:11]
    ds_read_b64_tr_b16 v[184:185], v216 offset:16544
    v_mfma_f32_16x16x32_bf16 v[8:11], v[196:199], v[128:131], v[8:11]
    ds_read_b64_tr_b16 v[186:187], v216 offset:18336
    v_mfma_f32_16x16x32_bf16 v[36:39], v[196:199], v[132:135], v[36:39]
    ds_read_b64_tr_b16 v[188:189], v216 offset:30880
    v_mfma_f32_16x16x32_bf16 v[36:39], v[192:195], v[116:119], v[36:39]
    ds_read_b64_tr_b16 v[190:191], v216 offset:32672
    v_mfma_f32_16x16x32_bf16 v[64:67], v[192:195], v[120:123], v[64:67]
    v_mfma_f32_16x16x32_bf16 v[64:67], v[196:199], v[136:139], v[64:67]
    v_mfma_f32_16x16x32_bf16 v[92:95], v[196:199], v[140:143], v[92:95]
    v_mfma_f32_16x16x32_bf16 v[92:95], v[192:195], v[124:127], v[92:95]
    s_waitcnt lgkmcnt(4)
    s_nop 0
    v_mfma_f32_16x16x32_bf16 v[96:99], v[200:203], v[124:127], v[96:99]
    ds_read_b64_tr_b16 v[192:193], v217 offset:16384
    v_mfma_f32_16x16x32_bf16 v[96:99], v[204:207], v[140:143], v[96:99]
    ds_read_b64_tr_b16 v[194:195], v217 offset:18176
    v_mfma_f32_16x16x32_bf16 v[68:71], v[204:207], v[136:139], v[68:71]
    ds_read_b64_tr_b16 v[196:197], v217 offset:30720
    v_mfma_f32_16x16x32_bf16 v[68:71], v[200:203], v[120:123], v[68:71]
    ds_read_b64_tr_b16 v[198:199], v217 offset:32512
    v_mfma_f32_16x16x32_bf16 v[40:43], v[200:203], v[116:119], v[40:43]
    v_mfma_f32_16x16x32_bf16 v[40:43], v[204:207], v[132:135], v[40:43]
    v_mfma_f32_16x16x32_bf16 v[12:15], v[204:207], v[128:131], v[12:15]
    v_mfma_f32_16x16x32_bf16 v[12:15], v[200:203], v[112:115], v[12:15]
    v_mfma_f32_16x16x32_bf16 v[16:19], v[176:179], v[112:115], v[16:19]
    v_mfma_f32_16x16x32_bf16 v[16:19], v[180:183], v[128:131], v[16:19]
    s_waitcnt lgkmcnt(0)
    s_barrier
    v_mfma_f32_16x16x32_bf16 v[44:47], v[180:183], v[132:135], v[44:47]
    ds_read_b64_tr_b16 v[200:201], v220 offset:16384
    v_mfma_f32_16x16x32_bf16 v[44:47], v[176:179], v[116:119], v[44:47]
    ds_read_b64_tr_b16 v[202:203], v220 offset:18176
    v_mfma_f32_16x16x32_bf16 v[72:75], v[176:179], v[120:123], v[72:75]
    ds_read_b64_tr_b16 v[204:205], v220 offset:30720
    v_mfma_f32_16x16x32_bf16 v[72:75], v[180:183], v[136:139], v[72:75]
    ds_read_b64_tr_b16 v[206:207], v220 offset:32512
    v_mfma_f32_16x16x32_bf16 v[100:103], v[180:183], v[140:143], v[100:103]
    ds_read_b128 v[144:147], v218 offset:0
    v_mfma_f32_16x16x32_bf16 v[100:103], v[176:179], v[124:127], v[100:103]
    ds_read_b128 v[160:163], v219 offset:0
    v_mfma_f32_16x16x32_bf16 v[104:107], v[184:187], v[124:127], v[104:107]
    ds_read_b128 v[148:151], v218 offset:2048
    v_mfma_f32_16x16x32_bf16 v[104:107], v[188:191], v[140:143], v[104:107]
    ds_read_b128 v[164:167], v219 offset:2048
    v_mfma_f32_16x16x32_bf16 v[76:79], v[188:191], v[136:139], v[76:79]
    ds_read_b128 v[152:155], v218 offset:4096
    v_mfma_f32_16x16x32_bf16 v[76:79], v[184:187], v[120:123], v[76:79]
    ds_read_b128 v[168:171], v219 offset:4096
    v_mfma_f32_16x16x32_bf16 v[48:51], v[184:187], v[116:119], v[48:51]
    ds_read_b128 v[156:159], v218 offset:6144
    v_mfma_f32_16x16x32_bf16 v[48:51], v[188:191], v[132:135], v[48:51]
    ds_read_b128 v[172:175], v219 offset:6144
    v_mfma_f32_16x16x32_bf16 v[20:23], v[188:191], v[128:131], v[20:23]
    ds_read_b64_tr_b16 v[176:177], v221 offset:16416
    v_mfma_f32_16x16x32_bf16 v[20:23], v[184:187], v[112:115], v[20:23]
    ds_read_b64_tr_b16 v[178:179], v221 offset:18208
    v_mfma_f32_16x16x32_bf16 v[24:27], v[192:195], v[112:115], v[24:27]
    ds_read_b64_tr_b16 v[180:181], v221 offset:30752
    v_mfma_f32_16x16x32_bf16 v[24:27], v[196:199], v[128:131], v[24:27]
    ds_read_b64_tr_b16 v[182:183], v221 offset:32544
    v_mfma_f32_16x16x32_bf16 v[52:55], v[196:199], v[132:135], v[52:55]
    ds_read_b64_tr_b16 v[184:185], v220 offset:16448
    v_mfma_f32_16x16x32_bf16 v[52:55], v[192:195], v[116:119], v[52:55]
    ds_read_b64_tr_b16 v[186:187], v220 offset:18240
    v_mfma_f32_16x16x32_bf16 v[80:83], v[192:195], v[120:123], v[80:83]
    ds_read_b64_tr_b16 v[188:189], v220 offset:30784
    v_mfma_f32_16x16x32_bf16 v[80:83], v[196:199], v[136:139], v[80:83]
    ds_read_b64_tr_b16 v[190:191], v220 offset:32576
    v_mfma_f32_16x16x32_bf16 v[108:111], v[196:199], v[140:143], v[108:111]
    v_mfma_f32_16x16x32_bf16 v[108:111], v[192:195], v[124:127], v[108:111]
    s_waitcnt lgkmcnt(8)
    s_nop 0
    v_mfma_f32_16x16x32_bf16 v[0:3], v[200:203], v[144:147], v[0:3]
    ds_read_b64_tr_b16 v[192:193], v221 offset:16480
    v_mfma_f32_16x16x32_bf16 v[0:3], v[204:207], v[160:163], v[0:3]
    ds_read_b64_tr_b16 v[194:195], v221 offset:18272
    v_mfma_f32_16x16x32_bf16 v[28:31], v[204:207], v[164:167], v[28:31]
    ds_read_b64_tr_b16 v[196:197], v221 offset:30816
    v_mfma_f32_16x16x32_bf16 v[28:31], v[200:203], v[148:151], v[28:31]
    ds_read_b64_tr_b16 v[198:199], v221 offset:32608
    v_mfma_f32_16x16x32_bf16 v[56:59], v[200:203], v[152:155], v[56:59]
    v_mfma_f32_16x16x32_bf16 v[56:59], v[204:207], v[168:171], v[56:59]
    v_mfma_f32_16x16x32_bf16 v[84:87], v[204:207], v[172:175], v[84:87]
    v_mfma_f32_16x16x32_bf16 v[84:87], v[200:203], v[156:159], v[84:87]
    s_waitcnt lgkmcnt(4)
    s_nop 0
    v_mfma_f32_16x16x32_bf16 v[88:91], v[176:179], v[156:159], v[88:91]
    ds_read_b64_tr_b16 v[200:201], v220 offset:16512
    v_mfma_f32_16x16x32_bf16 v[88:91], v[180:183], v[172:175], v[88:91]
    ds_read_b64_tr_b16 v[202:203], v220 offset:18304
    v_mfma_f32_16x16x32_bf16 v[60:63], v[180:183], v[168:171], v[60:63]
    ds_read_b64_tr_b16 v[204:205], v220 offset:30848
    v_mfma_f32_16x16x32_bf16 v[60:63], v[176:179], v[152:155], v[60:63]
    ds_read_b64_tr_b16 v[206:207], v220 offset:32640
    v_mfma_f32_16x16x32_bf16 v[32:35], v[176:179], v[148:151], v[32:35]
    v_mfma_f32_16x16x32_bf16 v[32:35], v[180:183], v[164:167], v[32:35]
    v_mfma_f32_16x16x32_bf16 v[4:7], v[180:183], v[160:163], v[4:7]
    v_mfma_f32_16x16x32_bf16 v[4:7], v[176:179], v[144:147], v[4:7]
    v_mfma_f32_16x16x32_bf16 v[8:11], v[184:187], v[144:147], v[8:11]
    ds_read_b64_tr_b16 v[176:177], v221 offset:16544
    v_mfma_f32_16x16x32_bf16 v[8:11], v[188:191], v[160:163], v[8:11]
    ds_read_b64_tr_b16 v[178:179], v221 offset:18336
    v_mfma_f32_16x16x32_bf16 v[36:39], v[188:191], v[164:167], v[36:39]
    ds_read_b64_tr_b16 v[180:181], v221 offset:30880
    v_mfma_f32_16x16x32_bf16 v[36:39], v[184:187], v[148:151], v[36:39]
    ds_read_b64_tr_b16 v[182:183], v221 offset:32672
    v_mfma_f32_16x16x32_bf16 v[64:67], v[184:187], v[152:155], v[64:67]
    v_mfma_f32_16x16x32_bf16 v[64:67], v[188:191], v[168:171], v[64:67]
    v_mfma_f32_16x16x32_bf16 v[92:95], v[188:191], v[172:175], v[92:95]
    v_mfma_f32_16x16x32_bf16 v[92:95], v[184:187], v[156:159], v[92:95]
    s_waitcnt lgkmcnt(4)
    s_nop 0
    v_mfma_f32_16x16x32_bf16 v[96:99], v[192:195], v[156:159], v[96:99]
    ds_read_b64_tr_b16 v[184:185], v222 offset:16384
    v_mfma_f32_16x16x32_bf16 v[96:99], v[196:199], v[172:175], v[96:99]
    ds_read_b64_tr_b16 v[186:187], v222 offset:18176
    v_mfma_f32_16x16x32_bf16 v[68:71], v[196:199], v[168:171], v[68:71]
    ds_read_b64_tr_b16 v[188:189], v222 offset:30720
    v_mfma_f32_16x16x32_bf16 v[68:71], v[192:195], v[152:155], v[68:71]
    ds_read_b64_tr_b16 v[190:191], v222 offset:32512
    v_mfma_f32_16x16x32_bf16 v[40:43], v[192:195], v[148:151], v[40:43]
    v_mfma_f32_16x16x32_bf16 v[40:43], v[196:199], v[164:167], v[40:43]
    v_mfma_f32_16x16x32_bf16 v[12:15], v[196:199], v[160:163], v[12:15]
    v_mfma_f32_16x16x32_bf16 v[12:15], v[192:195], v[144:147], v[12:15]
    v_mfma_f32_16x16x32_bf16 v[16:19], v[200:203], v[144:147], v[16:19]
    v_mfma_f32_16x16x32_bf16 v[16:19], v[204:207], v[160:163], v[16:19]
    s_waitcnt lgkmcnt(0)
    s_barrier
    v_mfma_f32_16x16x32_bf16 v[44:47], v[204:207], v[164:167], v[44:47]
    ds_read_b64_tr_b16 v[192:193], v210 offset:16384
    v_mfma_f32_16x16x32_bf16 v[44:47], v[200:203], v[148:151], v[44:47]
    ds_read_b64_tr_b16 v[194:195], v210 offset:18176
    v_mfma_f32_16x16x32_bf16 v[72:75], v[200:203], v[152:155], v[72:75]
    ds_read_b64_tr_b16 v[196:197], v210 offset:30720
    v_mfma_f32_16x16x32_bf16 v[72:75], v[204:207], v[168:171], v[72:75]
    ds_read_b64_tr_b16 v[198:199], v210 offset:32512
    v_mfma_f32_16x16x32_bf16 v[100:103], v[204:207], v[172:175], v[100:103]
    ds_read_b128 v[112:115], v208 offset:0
    v_mfma_f32_16x16x32_bf16 v[100:103], v[200:203], v[156:159], v[100:103]
    ds_read_b128 v[128:131], v209 offset:0
    v_mfma_f32_16x16x32_bf16 v[104:107], v[176:179], v[156:159], v[104:107]
    ds_read_b128 v[116:119], v208 offset:2048
    v_mfma_f32_16x16x32_bf16 v[104:107], v[180:183], v[172:175], v[104:107]
    ds_read_b128 v[132:135], v209 offset:2048
    v_mfma_f32_16x16x32_bf16 v[76:79], v[180:183], v[168:171], v[76:79]
    ds_read_b128 v[120:123], v208 offset:4096
    v_mfma_f32_16x16x32_bf16 v[76:79], v[176:179], v[152:155], v[76:79]
    ds_read_b128 v[136:139], v209 offset:4096
    v_mfma_f32_16x16x32_bf16 v[48:51], v[176:179], v[148:151], v[48:51]
    ds_read_b128 v[124:127], v208 offset:6144
    v_mfma_f32_16x16x32_bf16 v[48:51], v[180:183], v[164:167], v[48:51]
    ds_read_b128 v[140:143], v209 offset:6144
    v_mfma_f32_16x16x32_bf16 v[20:23], v[180:183], v[160:163], v[20:23]
    ds_read_b64_tr_b16 v[200:201], v211 offset:16416
    v_mfma_f32_16x16x32_bf16 v[20:23], v[176:179], v[144:147], v[20:23]
    ds_read_b64_tr_b16 v[202:203], v211 offset:18208
    v_mfma_f32_16x16x32_bf16 v[24:27], v[184:187], v[144:147], v[24:27]
    ds_read_b64_tr_b16 v[204:205], v211 offset:30752
    v_mfma_f32_16x16x32_bf16 v[24:27], v[188:191], v[160:163], v[24:27]
    ds_read_b64_tr_b16 v[206:207], v211 offset:32544
    v_mfma_f32_16x16x32_bf16 v[52:55], v[188:191], v[164:167], v[52:55]
    ds_read_b64_tr_b16 v[176:177], v210 offset:16448
    v_mfma_f32_16x16x32_bf16 v[52:55], v[184:187], v[148:151], v[52:55]
    ds_read_b64_tr_b16 v[178:179], v210 offset:18240
    v_mfma_f32_16x16x32_bf16 v[80:83], v[184:187], v[152:155], v[80:83]
    ds_read_b64_tr_b16 v[180:181], v210 offset:30784
    v_mfma_f32_16x16x32_bf16 v[80:83], v[188:191], v[168:171], v[80:83]
    ds_read_b64_tr_b16 v[182:183], v210 offset:32576
    v_mfma_f32_16x16x32_bf16 v[108:111], v[188:191], v[172:175], v[108:111]
    v_mfma_f32_16x16x32_bf16 v[108:111], v[184:187], v[156:159], v[108:111]
    s_waitcnt lgkmcnt(8)
    s_nop 0
    v_mfma_f32_16x16x32_bf16 v[0:3], v[192:195], v[112:115], v[0:3]
    ds_read_b64_tr_b16 v[184:185], v211 offset:16480
    v_mfma_f32_16x16x32_bf16 v[0:3], v[196:199], v[128:131], v[0:3]
    ds_read_b64_tr_b16 v[186:187], v211 offset:18272
    v_mfma_f32_16x16x32_bf16 v[28:31], v[196:199], v[132:135], v[28:31]
    ds_read_b64_tr_b16 v[188:189], v211 offset:30816
    v_mfma_f32_16x16x32_bf16 v[28:31], v[192:195], v[116:119], v[28:31]
    ds_read_b64_tr_b16 v[190:191], v211 offset:32608
    v_mfma_f32_16x16x32_bf16 v[56:59], v[192:195], v[120:123], v[56:59]
    v_mfma_f32_16x16x32_bf16 v[56:59], v[196:199], v[136:139], v[56:59]
    v_mfma_f32_16x16x32_bf16 v[84:87], v[196:199], v[140:143], v[84:87]
    v_mfma_f32_16x16x32_bf16 v[84:87], v[192:195], v[124:127], v[84:87]
    s_waitcnt lgkmcnt(4)
    s_nop 0
    v_mfma_f32_16x16x32_bf16 v[88:91], v[200:203], v[124:127], v[88:91]
    ds_read_b64_tr_b16 v[192:193], v210 offset:16512
    v_mfma_f32_16x16x32_bf16 v[88:91], v[204:207], v[140:143], v[88:91]
    ds_read_b64_tr_b16 v[194:195], v210 offset:18304
    v_mfma_f32_16x16x32_bf16 v[60:63], v[204:207], v[136:139], v[60:63]
    ds_read_b64_tr_b16 v[196:197], v210 offset:30848
    v_mfma_f32_16x16x32_bf16 v[60:63], v[200:203], v[120:123], v[60:63]
    ds_read_b64_tr_b16 v[198:199], v210 offset:32640
    v_mfma_f32_16x16x32_bf16 v[32:35], v[200:203], v[116:119], v[32:35]
    v_mfma_f32_16x16x32_bf16 v[32:35], v[204:207], v[132:135], v[32:35]
    v_mfma_f32_16x16x32_bf16 v[4:7], v[204:207], v[128:131], v[4:7]
    v_mfma_f32_16x16x32_bf16 v[4:7], v[200:203], v[112:115], v[4:7]
    v_mfma_f32_16x16x32_bf16 v[8:11], v[176:179], v[112:115], v[8:11]
    ds_read_b64_tr_b16 v[200:201], v211 offset:16544
    v_mfma_f32_16x16x32_bf16 v[8:11], v[180:183], v[128:131], v[8:11]
    ds_read_b64_tr_b16 v[202:203], v211 offset:18336
    v_mfma_f32_16x16x32_bf16 v[36:39], v[180:183], v[132:135], v[36:39]
    ds_read_b64_tr_b16 v[204:205], v211 offset:30880
    v_mfma_f32_16x16x32_bf16 v[36:39], v[176:179], v[116:119], v[36:39]
    ds_read_b64_tr_b16 v[206:207], v211 offset:32672
    v_mfma_f32_16x16x32_bf16 v[64:67], v[176:179], v[120:123], v[64:67]
    v_mfma_f32_16x16x32_bf16 v[64:67], v[180:183], v[136:139], v[64:67]
    v_mfma_f32_16x16x32_bf16 v[92:95], v[180:183], v[140:143], v[92:95]
    v_mfma_f32_16x16x32_bf16 v[92:95], v[176:179], v[124:127], v[92:95]
    s_waitcnt lgkmcnt(4)
    s_nop 0
    v_mfma_f32_16x16x32_bf16 v[96:99], v[184:187], v[124:127], v[96:99]
    ds_read_b64_tr_b16 v[176:177], v212 offset:16384
    v_mfma_f32_16x16x32_bf16 v[96:99], v[188:191], v[140:143], v[96:99]
    ds_read_b64_tr_b16 v[178:179], v212 offset:18176
    v_mfma_f32_16x16x32_bf16 v[68:71], v[188:191], v[136:139], v[68:71]
    ds_read_b64_tr_b16 v[180:181], v212 offset:30720
    v_mfma_f32_16x16x32_bf16 v[68:71], v[184:187], v[120:123], v[68:71]
    ds_read_b64_tr_b16 v[182:183], v212 offset:32512
    v_mfma_f32_16x16x32_bf16 v[40:43], v[184:187], v[116:119], v[40:43]
    v_mfma_f32_16x16x32_bf16 v[40:43], v[188:191], v[132:135], v[40:43]
    v_mfma_f32_16x16x32_bf16 v[12:15], v[188:191], v[128:131], v[12:15]
    v_mfma_f32_16x16x32_bf16 v[12:15], v[184:187], v[112:115], v[12:15]
    v_mfma_f32_16x16x32_bf16 v[16:19], v[192:195], v[112:115], v[16:19]
    v_mfma_f32_16x16x32_bf16 v[16:19], v[196:199], v[128:131], v[16:19]
    s_waitcnt lgkmcnt(0)
    s_barrier
    v_mfma_f32_16x16x32_bf16 v[44:47], v[196:199], v[132:135], v[44:47]
    ds_read_b64_tr_b16 v[184:185], v215 offset:16384
    v_mfma_f32_16x16x32_bf16 v[44:47], v[192:195], v[116:119], v[44:47]
    ds_read_b64_tr_b16 v[186:187], v215 offset:18176
    v_mfma_f32_16x16x32_bf16 v[72:75], v[192:195], v[120:123], v[72:75]
    ds_read_b64_tr_b16 v[188:189], v215 offset:30720
    v_mfma_f32_16x16x32_bf16 v[72:75], v[196:199], v[136:139], v[72:75]
    ds_read_b64_tr_b16 v[190:191], v215 offset:32512
    v_mfma_f32_16x16x32_bf16 v[100:103], v[196:199], v[140:143], v[100:103]
    ds_read_b128 v[144:147], v213 offset:0
    v_mfma_f32_16x16x32_bf16 v[100:103], v[192:195], v[124:127], v[100:103]
    ds_read_b128 v[160:163], v214 offset:0
    v_mfma_f32_16x16x32_bf16 v[104:107], v[200:203], v[124:127], v[104:107]
    ds_read_b128 v[148:151], v213 offset:2048
    v_mfma_f32_16x16x32_bf16 v[104:107], v[204:207], v[140:143], v[104:107]
    ds_read_b128 v[164:167], v214 offset:2048
    v_mfma_f32_16x16x32_bf16 v[76:79], v[204:207], v[136:139], v[76:79]
    ds_read_b128 v[152:155], v213 offset:4096
    v_mfma_f32_16x16x32_bf16 v[76:79], v[200:203], v[120:123], v[76:79]
    ds_read_b128 v[168:171], v214 offset:4096
    v_mfma_f32_16x16x32_bf16 v[48:51], v[200:203], v[116:119], v[48:51]
    ds_read_b128 v[156:159], v213 offset:6144
    v_mfma_f32_16x16x32_bf16 v[48:51], v[204:207], v[132:135], v[48:51]
    ds_read_b128 v[172:175], v214 offset:6144
    v_mfma_f32_16x16x32_bf16 v[20:23], v[204:207], v[128:131], v[20:23]
    ds_read_b64_tr_b16 v[192:193], v216 offset:16416
    v_mfma_f32_16x16x32_bf16 v[20:23], v[200:203], v[112:115], v[20:23]
    ds_read_b64_tr_b16 v[194:195], v216 offset:18208
    v_mfma_f32_16x16x32_bf16 v[24:27], v[176:179], v[112:115], v[24:27]
    ds_read_b64_tr_b16 v[196:197], v216 offset:30752
    v_mfma_f32_16x16x32_bf16 v[24:27], v[180:183], v[128:131], v[24:27]
    ds_read_b64_tr_b16 v[198:199], v216 offset:32544
    v_mfma_f32_16x16x32_bf16 v[52:55], v[180:183], v[132:135], v[52:55]
    ds_read_b64_tr_b16 v[200:201], v215 offset:16448
    v_mfma_f32_16x16x32_bf16 v[52:55], v[176:179], v[116:119], v[52:55]
    ds_read_b64_tr_b16 v[202:203], v215 offset:18240
    v_mfma_f32_16x16x32_bf16 v[80:83], v[176:179], v[120:123], v[80:83]
    ds_read_b64_tr_b16 v[204:205], v215 offset:30784
    v_mfma_f32_16x16x32_bf16 v[80:83], v[180:183], v[136:139], v[80:83]
    ds_read_b64_tr_b16 v[206:207], v215 offset:32576
    v_mfma_f32_16x16x32_bf16 v[108:111], v[180:183], v[140:143], v[108:111]
    v_mfma_f32_16x16x32_bf16 v[108:111], v[176:179], v[124:127], v[108:111]
    s_waitcnt lgkmcnt(8)
    s_nop 0
    v_mfma_f32_16x16x32_bf16 v[0:3], v[184:187], v[144:147], v[0:3]
    ds_read_b64_tr_b16 v[176:177], v216 offset:16480
    v_mfma_f32_16x16x32_bf16 v[0:3], v[188:191], v[160:163], v[0:3]
    ds_read_b64_tr_b16 v[178:179], v216 offset:18272
    v_mfma_f32_16x16x32_bf16 v[28:31], v[188:191], v[164:167], v[28:31]
    ds_read_b64_tr_b16 v[180:181], v216 offset:30816
    v_mfma_f32_16x16x32_bf16 v[28:31], v[184:187], v[148:151], v[28:31]
    ds_read_b64_tr_b16 v[182:183], v216 offset:32608
    v_mfma_f32_16x16x32_bf16 v[56:59], v[184:187], v[152:155], v[56:59]
    v_mfma_f32_16x16x32_bf16 v[56:59], v[188:191], v[168:171], v[56:59]
    v_mfma_f32_16x16x32_bf16 v[84:87], v[188:191], v[172:175], v[84:87]
    v_mfma_f32_16x16x32_bf16 v[84:87], v[184:187], v[156:159], v[84:87]
    s_waitcnt lgkmcnt(4)
    s_nop 0
    v_mfma_f32_16x16x32_bf16 v[88:91], v[192:195], v[156:159], v[88:91]
    ds_read_b64_tr_b16 v[184:185], v215 offset:16512
    v_mfma_f32_16x16x32_bf16 v[88:91], v[196:199], v[172:175], v[88:91]
    ds_read_b64_tr_b16 v[186:187], v215 offset:18304
    v_mfma_f32_16x16x32_bf16 v[60:63], v[196:199], v[168:171], v[60:63]
    ds_read_b64_tr_b16 v[188:189], v215 offset:30848
    v_mfma_f32_16x16x32_bf16 v[60:63], v[192:195], v[152:155], v[60:63]
    ds_read_b64_tr_b16 v[190:191], v215 offset:32640
    v_mfma_f32_16x16x32_bf16 v[32:35], v[192:195], v[148:151], v[32:35]
    v_mfma_f32_16x16x32_bf16 v[32:35], v[196:199], v[164:167], v[32:35]
    v_mfma_f32_16x16x32_bf16 v[4:7], v[196:199], v[160:163], v[4:7]
    v_mfma_f32_16x16x32_bf16 v[4:7], v[192:195], v[144:147], v[4:7]
    v_mfma_f32_16x16x32_bf16 v[8:11], v[200:203], v[144:147], v[8:11]
    ds_read_b64_tr_b16 v[192:193], v216 offset:16544
    v_mfma_f32_16x16x32_bf16 v[8:11], v[204:207], v[160:163], v[8:11]
    ds_read_b64_tr_b16 v[194:195], v216 offset:18336
    v_mfma_f32_16x16x32_bf16 v[36:39], v[204:207], v[164:167], v[36:39]
    ds_read_b64_tr_b16 v[196:197], v216 offset:30880
    v_mfma_f32_16x16x32_bf16 v[36:39], v[200:203], v[148:151], v[36:39]
    ds_read_b64_tr_b16 v[198:199], v216 offset:32672
    v_mfma_f32_16x16x32_bf16 v[64:67], v[200:203], v[152:155], v[64:67]
    v_mfma_f32_16x16x32_bf16 v[64:67], v[204:207], v[168:171], v[64:67]
    v_mfma_f32_16x16x32_bf16 v[92:95], v[204:207], v[172:175], v[92:95]
    v_mfma_f32_16x16x32_bf16 v[92:95], v[200:203], v[156:159], v[92:95]
    s_waitcnt lgkmcnt(4)
    s_nop 0
    v_mfma_f32_16x16x32_bf16 v[96:99], v[176:179], v[156:159], v[96:99]
    ds_read_b64_tr_b16 v[200:201], v217 offset:16384
    v_mfma_f32_16x16x32_bf16 v[96:99], v[180:183], v[172:175], v[96:99]
    ds_read_b64_tr_b16 v[202:203], v217 offset:18176
    v_mfma_f32_16x16x32_bf16 v[68:71], v[180:183], v[168:171], v[68:71]
    ds_read_b64_tr_b16 v[204:205], v217 offset:30720
    v_mfma_f32_16x16x32_bf16 v[68:71], v[176:179], v[152:155], v[68:71]
    ds_read_b64_tr_b16 v[206:207], v217 offset:32512
    v_mfma_f32_16x16x32_bf16 v[40:43], v[176:179], v[148:151], v[40:43]
    v_mfma_f32_16x16x32_bf16 v[40:43], v[180:183], v[164:167], v[40:43]
    v_mfma_f32_16x16x32_bf16 v[12:15], v[180:183], v[160:163], v[12:15]
    v_mfma_f32_16x16x32_bf16 v[12:15], v[176:179], v[144:147], v[12:15]
    v_mfma_f32_16x16x32_bf16 v[16:19], v[184:187], v[144:147], v[16:19]
    v_mfma_f32_16x16x32_bf16 v[16:19], v[188:191], v[160:163], v[16:19]
    s_waitcnt lgkmcnt(0)
    s_barrier
    v_mfma_f32_16x16x32_bf16 v[44:47], v[188:191], v[164:167], v[44:47]
    ds_read_b64_tr_b16 v[176:177], v220 offset:16384
    v_mfma_f32_16x16x32_bf16 v[44:47], v[184:187], v[148:151], v[44:47]
    ds_read_b64_tr_b16 v[178:179], v220 offset:18176
    v_mfma_f32_16x16x32_bf16 v[72:75], v[184:187], v[152:155], v[72:75]
    ds_read_b64_tr_b16 v[180:181], v220 offset:30720
    v_mfma_f32_16x16x32_bf16 v[72:75], v[188:191], v[168:171], v[72:75]
    ds_read_b64_tr_b16 v[182:183], v220 offset:32512
    v_mfma_f32_16x16x32_bf16 v[100:103], v[188:191], v[172:175], v[100:103]
    ds_read_b128 v[112:115], v218 offset:0
    v_mfma_f32_16x16x32_bf16 v[100:103], v[184:187], v[156:159], v[100:103]
    ds_read_b128 v[128:131], v219 offset:0
    v_mfma_f32_16x16x32_bf16 v[104:107], v[192:195], v[156:159], v[104:107]
    ds_read_b128 v[116:119], v218 offset:2048
    v_mfma_f32_16x16x32_bf16 v[104:107], v[196:199], v[172:175], v[104:107]
    ds_read_b128 v[132:135], v219 offset:2048
    v_mfma_f32_16x16x32_bf16 v[76:79], v[196:199], v[168:171], v[76:79]
    ds_read_b128 v[120:123], v218 offset:4096
    v_mfma_f32_16x16x32_bf16 v[76:79], v[192:195], v[152:155], v[76:79]
    ds_read_b128 v[136:139], v219 offset:4096
    v_mfma_f32_16x16x32_bf16 v[48:51], v[192:195], v[148:151], v[48:51]
    ds_read_b128 v[124:127], v218 offset:6144
    v_mfma_f32_16x16x32_bf16 v[48:51], v[196:199], v[164:167], v[48:51]
    ds_read_b128 v[140:143], v219 offset:6144
    v_mfma_f32_16x16x32_bf16 v[20:23], v[196:199], v[160:163], v[20:23]
    ds_read_b64_tr_b16 v[184:185], v221 offset:16416
    v_mfma_f32_16x16x32_bf16 v[20:23], v[192:195], v[144:147], v[20:23]
    ds_read_b64_tr_b16 v[186:187], v221 offset:18208
    v_mfma_f32_16x16x32_bf16 v[24:27], v[200:203], v[144:147], v[24:27]
    ds_read_b64_tr_b16 v[188:189], v221 offset:30752
    v_mfma_f32_16x16x32_bf16 v[24:27], v[204:207], v[160:163], v[24:27]
    ds_read_b64_tr_b16 v[190:191], v221 offset:32544
    v_mfma_f32_16x16x32_bf16 v[52:55], v[204:207], v[164:167], v[52:55]
    ds_read_b64_tr_b16 v[192:193], v220 offset:16448
    v_mfma_f32_16x16x32_bf16 v[52:55], v[200:203], v[148:151], v[52:55]
    ds_read_b64_tr_b16 v[194:195], v220 offset:18240
    v_mfma_f32_16x16x32_bf16 v[80:83], v[200:203], v[152:155], v[80:83]
    ds_read_b64_tr_b16 v[196:197], v220 offset:30784
    v_mfma_f32_16x16x32_bf16 v[80:83], v[204:207], v[168:171], v[80:83]
    ds_read_b64_tr_b16 v[198:199], v220 offset:32576
    v_mfma_f32_16x16x32_bf16 v[108:111], v[204:207], v[172:175], v[108:111]
    v_mfma_f32_16x16x32_bf16 v[108:111], v[200:203], v[156:159], v[108:111]
    s_waitcnt lgkmcnt(8)
    s_nop 0
    v_mfma_f32_16x16x32_bf16 v[0:3], v[176:179], v[112:115], v[0:3]
    ds_read_b64_tr_b16 v[200:201], v221 offset:16480
    v_mfma_f32_16x16x32_bf16 v[0:3], v[180:183], v[128:131], v[0:3]
    ds_read_b64_tr_b16 v[202:203], v221 offset:18272
    v_mfma_f32_16x16x32_bf16 v[28:31], v[180:183], v[132:135], v[28:31]
    ds_read_b64_tr_b16 v[204:205], v221 offset:30816
    v_mfma_f32_16x16x32_bf16 v[28:31], v[176:179], v[116:119], v[28:31]
    ds_read_b64_tr_b16 v[206:207], v221 offset:32608
    v_mfma_f32_16x16x32_bf16 v[56:59], v[176:179], v[120:123], v[56:59]
    v_mfma_f32_16x16x32_bf16 v[56:59], v[180:183], v[136:139], v[56:59]
    v_mfma_f32_16x16x32_bf16 v[84:87], v[180:183], v[140:143], v[84:87]
    v_mfma_f32_16x16x32_bf16 v[84:87], v[176:179], v[124:127], v[84:87]
    s_waitcnt lgkmcnt(4)
    s_nop 0
    v_mfma_f32_16x16x32_bf16 v[88:91], v[184:187], v[124:127], v[88:91]
    ds_read_b64_tr_b16 v[176:177], v220 offset:16512
    v_mfma_f32_16x16x32_bf16 v[88:91], v[188:191], v[140:143], v[88:91]
    ds_read_b64_tr_b16 v[178:179], v220 offset:18304
    v_mfma_f32_16x16x32_bf16 v[60:63], v[188:191], v[136:139], v[60:63]
    ds_read_b64_tr_b16 v[180:181], v220 offset:30848
    v_mfma_f32_16x16x32_bf16 v[60:63], v[184:187], v[120:123], v[60:63]
    ds_read_b64_tr_b16 v[182:183], v220 offset:32640
    v_mfma_f32_16x16x32_bf16 v[32:35], v[184:187], v[116:119], v[32:35]
    v_mfma_f32_16x16x32_bf16 v[32:35], v[188:191], v[132:135], v[32:35]
    v_mfma_f32_16x16x32_bf16 v[4:7], v[188:191], v[128:131], v[4:7]
    v_mfma_f32_16x16x32_bf16 v[4:7], v[184:187], v[112:115], v[4:7]
    v_mfma_f32_16x16x32_bf16 v[8:11], v[192:195], v[112:115], v[8:11]
    ds_read_b64_tr_b16 v[184:185], v221 offset:16544
    v_mfma_f32_16x16x32_bf16 v[8:11], v[196:199], v[128:131], v[8:11]
    ds_read_b64_tr_b16 v[186:187], v221 offset:18336
    v_mfma_f32_16x16x32_bf16 v[36:39], v[196:199], v[132:135], v[36:39]
    ds_read_b64_tr_b16 v[188:189], v221 offset:30880
    v_mfma_f32_16x16x32_bf16 v[36:39], v[192:195], v[116:119], v[36:39]
    ds_read_b64_tr_b16 v[190:191], v221 offset:32672
    v_mfma_f32_16x16x32_bf16 v[64:67], v[192:195], v[120:123], v[64:67]
    v_mfma_f32_16x16x32_bf16 v[64:67], v[196:199], v[136:139], v[64:67]
    v_mfma_f32_16x16x32_bf16 v[92:95], v[196:199], v[140:143], v[92:95]
    v_mfma_f32_16x16x32_bf16 v[92:95], v[192:195], v[124:127], v[92:95]
    s_waitcnt lgkmcnt(4)
    s_nop 0
    v_mfma_f32_16x16x32_bf16 v[96:99], v[200:203], v[124:127], v[96:99]
    ds_read_b64_tr_b16 v[192:193], v222 offset:16384
    v_mfma_f32_16x16x32_bf16 v[96:99], v[204:207], v[140:143], v[96:99]
    ds_read_b64_tr_b16 v[194:195], v222 offset:18176
    v_mfma_f32_16x16x32_bf16 v[68:71], v[204:207], v[136:139], v[68:71]
    ds_read_b64_tr_b16 v[196:197], v222 offset:30720
    v_mfma_f32_16x16x32_bf16 v[68:71], v[200:203], v[120:123], v[68:71]
    ds_read_b64_tr_b16 v[198:199], v222 offset:32512
    v_mfma_f32_16x16x32_bf16 v[40:43], v[200:203], v[116:119], v[40:43]
    v_mfma_f32_16x16x32_bf16 v[40:43], v[204:207], v[132:135], v[40:43]
    v_mfma_f32_16x16x32_bf16 v[12:15], v[204:207], v[128:131], v[12:15]
    v_mfma_f32_16x16x32_bf16 v[12:15], v[200:203], v[112:115], v[12:15]
    v_mfma_f32_16x16x32_bf16 v[16:19], v[176:179], v[112:115], v[16:19]
    v_mfma_f32_16x16x32_bf16 v[16:19], v[180:183], v[128:131], v[16:19]
    s_waitcnt lgkmcnt(0)
    s_barrier
    v_mfma_f32_16x16x32_bf16 v[44:47], v[180:183], v[132:135], v[44:47]
    ds_read_b64_tr_b16 v[200:201], v210 offset:16384
    v_mfma_f32_16x16x32_bf16 v[44:47], v[176:179], v[116:119], v[44:47]
    ds_read_b64_tr_b16 v[202:203], v210 offset:18176
    v_mfma_f32_16x16x32_bf16 v[72:75], v[176:179], v[120:123], v[72:75]
    ds_read_b64_tr_b16 v[204:205], v210 offset:30720
    v_mfma_f32_16x16x32_bf16 v[72:75], v[180:183], v[136:139], v[72:75]
    ds_read_b64_tr_b16 v[206:207], v210 offset:32512
    v_mfma_f32_16x16x32_bf16 v[100:103], v[180:183], v[140:143], v[100:103]
    ds_read_b128 v[144:147], v208 offset:0
    v_mfma_f32_16x16x32_bf16 v[100:103], v[176:179], v[124:127], v[100:103]
    ds_read_b128 v[160:163], v209 offset:0
    v_mfma_f32_16x16x32_bf16 v[104:107], v[184:187], v[124:127], v[104:107]
    ds_read_b128 v[148:151], v208 offset:2048
    v_mfma_f32_16x16x32_bf16 v[104:107], v[188:191], v[140:143], v[104:107]
    ds_read_b128 v[164:167], v209 offset:2048
    v_mfma_f32_16x16x32_bf16 v[76:79], v[188:191], v[136:139], v[76:79]
    ds_read_b128 v[152:155], v208 offset:4096
    v_mfma_f32_16x16x32_bf16 v[76:79], v[184:187], v[120:123], v[76:79]
    ds_read_b128 v[168:171], v209 offset:4096
    v_mfma_f32_16x16x32_bf16 v[48:51], v[184:187], v[116:119], v[48:51]
    ds_read_b128 v[156:159], v208 offset:6144
    v_mfma_f32_16x16x32_bf16 v[48:51], v[188:191], v[132:135], v[48:51]
    ds_read_b128 v[172:175], v209 offset:6144
    v_mfma_f32_16x16x32_bf16 v[20:23], v[188:191], v[128:131], v[20:23]
    ds_read_b64_tr_b16 v[176:177], v211 offset:16416
    v_mfma_f32_16x16x32_bf16 v[20:23], v[184:187], v[112:115], v[20:23]
    ds_read_b64_tr_b16 v[178:179], v211 offset:18208
    v_mfma_f32_16x16x32_bf16 v[24:27], v[192:195], v[112:115], v[24:27]
    ds_read_b64_tr_b16 v[180:181], v211 offset:30752
    v_mfma_f32_16x16x32_bf16 v[24:27], v[196:199], v[128:131], v[24:27]
    ds_read_b64_tr_b16 v[182:183], v211 offset:32544
    v_mfma_f32_16x16x32_bf16 v[52:55], v[196:199], v[132:135], v[52:55]
    ds_read_b64_tr_b16 v[184:185], v210 offset:16448
    v_mfma_f32_16x16x32_bf16 v[52:55], v[192:195], v[116:119], v[52:55]
    ds_read_b64_tr_b16 v[186:187], v210 offset:18240
    v_mfma_f32_16x16x32_bf16 v[80:83], v[192:195], v[120:123], v[80:83]
    ds_read_b64_tr_b16 v[188:189], v210 offset:30784
    v_mfma_f32_16x16x32_bf16 v[80:83], v[196:199], v[136:139], v[80:83]
    ds_read_b64_tr_b16 v[190:191], v210 offset:32576
    v_mfma_f32_16x16x32_bf16 v[108:111], v[196:199], v[140:143], v[108:111]
    v_mfma_f32_16x16x32_bf16 v[108:111], v[192:195], v[124:127], v[108:111]
    s_waitcnt lgkmcnt(8)
    s_nop 0
    v_mfma_f32_16x16x32_bf16 v[0:3], v[200:203], v[144:147], v[0:3]
    ds_read_b64_tr_b16 v[192:193], v211 offset:16480
    v_mfma_f32_16x16x32_bf16 v[0:3], v[204:207], v[160:163], v[0:3]
    ds_read_b64_tr_b16 v[194:195], v211 offset:18272
    v_mfma_f32_16x16x32_bf16 v[28:31], v[204:207], v[164:167], v[28:31]
    ds_read_b64_tr_b16 v[196:197], v211 offset:30816
    v_mfma_f32_16x16x32_bf16 v[28:31], v[200:203], v[148:151], v[28:31]
    ds_read_b64_tr_b16 v[198:199], v211 offset:32608
    v_mfma_f32_16x16x32_bf16 v[56:59], v[200:203], v[152:155], v[56:59]
    v_mfma_f32_16x16x32_bf16 v[56:59], v[204:207], v[168:171], v[56:59]
    v_mfma_f32_16x16x32_bf16 v[84:87], v[204:207], v[172:175], v[84:87]
    v_mfma_f32_16x16x32_bf16 v[84:87], v[200:203], v[156:159], v[84:87]
    s_waitcnt lgkmcnt(4)
    s_nop 0
    v_mfma_f32_16x16x32_bf16 v[88:91], v[176:179], v[156:159], v[88:91]
    ds_read_b64_tr_b16 v[200:201], v210 offset:16512
    v_mfma_f32_16x16x32_bf16 v[88:91], v[180:183], v[172:175], v[88:91]
    ds_read_b64_tr_b16 v[202:203], v210 offset:18304
    v_mfma_f32_16x16x32_bf16 v[60:63], v[180:183], v[168:171], v[60:63]
    ds_read_b64_tr_b16 v[204:205], v210 offset:30848
    v_mfma_f32_16x16x32_bf16 v[60:63], v[176:179], v[152:155], v[60:63]
    ds_read_b64_tr_b16 v[206:207], v210 offset:32640
    v_mfma_f32_16x16x32_bf16 v[32:35], v[176:179], v[148:151], v[32:35]
    v_mfma_f32_16x16x32_bf16 v[32:35], v[180:183], v[164:167], v[32:35]
    v_mfma_f32_16x16x32_bf16 v[4:7], v[180:183], v[160:163], v[4:7]
    v_mfma_f32_16x16x32_bf16 v[4:7], v[176:179], v[144:147], v[4:7]
    v_mfma_f32_16x16x32_bf16 v[8:11], v[184:187], v[144:147], v[8:11]
    ds_read_b64_tr_b16 v[176:177], v211 offset:16544
    v_mfma_f32_16x16x32_bf16 v[8:11], v[188:191], v[160:163], v[8:11]
L_wp1:
    s_cbranch_vccnz L_wp5
    s_nop 0
    ds_read_b64_tr_b16 v[178:179], v211 offset:18336
    v_mfma_f32_16x16x32_bf16 v[36:39], v[188:191], v[164:167], v[36:39]
    ds_read_b64_tr_b16 v[180:181], v211 offset:30880
    v_mfma_f32_16x16x32_bf16 v[36:39], v[184:187], v[148:151], v[36:39]
    ds_read_b64_tr_b16 v[182:183], v211 offset:32672
    v_mfma_f32_16x16x32_bf16 v[64:67], v[184:187], v[152:155], v[64:67]
    v_mfma_f32_16x16x32_bf16 v[64:67], v[188:191], v[168:171], v[64:67]
    v_mfma_f32_16x16x32_bf16 v[92:95], v[188:191], v[172:175], v[92:95]
    v_mfma_f32_16x16x32_bf16 v[92:95], v[184:187], v[156:159], v[92:95]
    s_waitcnt lgkmcnt(4)
    s_nop 0
    v_mfma_f32_16x16x32_bf16 v[96:99], v[192:195], v[156:159], v[96:99]
    ds_read_b64_tr_b16 v[184:185], v212 offset:16384
    v_mfma_f32_16x16x32_bf16 v[96:99], v[196:199], v[172:175], v[96:99]
    ds_read_b64_tr_b16 v[186:187], v212 offset:18176
    v_mfma_f32_16x16x32_bf16 v[68:71], v[196:199], v[168:171], v[68:71]
    ds_read_b64_tr_b16 v[188:189], v212 offset:30720
    v_mfma_f32_16x16x32_bf16 v[68:71], v[192:195], v[152:155], v[68:71]
    ds_read_b64_tr_b16 v[190:191], v212 offset:32512
    v_mfma_f32_16x16x32_bf16 v[40:43], v[192:195], v[148:151], v[40:43]
    v_mfma_f32_16x16x32_bf16 v[40:43], v[196:199], v[164:167], v[40:43]
    v_mfma_f32_16x16x32_bf16 v[12:15], v[196:199], v[160:163], v[12:15]
    v_mfma_f32_16x16x32_bf16 v[12:15], v[192:195], v[144:147], v[12:15]
    v_mfma_f32_16x16x32_bf16 v[16:19], v[200:203], v[144:147], v[16:19]
    v_mfma_f32_16x16x32_bf16 v[16:19], v[204:207], v[160:163], v[16:19]
    s_waitcnt lgkmcnt(0)
    s_barrier
    v_mfma_f32_16x16x32_bf16 v[44:47], v[204:207], v[164:167], v[44:47]
    ds_read_b64_tr_b16 v[192:193], v215 offset:16384
    v_mfma_f32_16x16x32_bf16 v[44:47], v[200:203], v[148:151], v[44:47]
    ds_read_b64_tr_b16 v[194:195], v215 offset:18176
    v_mfma_f32_16x16x32_bf16 v[72:75], v[200:203], v[152:155], v[72:75]
    ds_read_b64_tr_b16 v[196:197], v215 offset:30720
    v_mfma_f32_16x16x32_bf16 v[72:75], v[204:207], v[168:171], v[72:75]
    ds_read_b64_tr_b16 v[198:199], v215 offset:32512
    v_mfma_f32_16x16x32_bf16 v[100:103], v[204:207], v[172:175], v[100:103]
    ds_read_b128 v[112:115], v213 offset:0
    v_mfma_f32_16x16x32_bf16 v[100:103], v[200:203], v[156:159], v[100:103]
    ds_read_b128 v[128:131], v214 offset:0
    v_mfma_f32_16x16x32_bf16 v[104:107], v[176:179], v[156:159], v[104:107]
    ds_read_b128 v[116:119], v213 offset:2048
    v_mfma_f32_16x16x32_bf16 v[104:107], v[180:183], v[172:175], v[104:107]
    ds_read_b128 v[132:135], v214 offset:2048
    v_mfma_f32_16x16x32_bf16 v[76:79], v[180:183], v[168:171], v[76:79]
    ds_read_b128 v[120:123], v213 offset:4096
    v_mfma_f32_16x16x32_bf16 v[76:79], v[176:179], v[152:155], v[76:79]
    ds_read_b128 v[136:139], v214 offset:4096
    v_mfma_f32_16x16x32_bf16 v[48:51], v[176:179], v[148:151], v[48:51]
    ds_read_b128 v[124:127], v213 offset:6144
    v_mfma_f32_16x16x32_bf16 v[48:51], v[180:183], v[164:167], v[48:51]
    ds_read_b128 v[140:143], v214 offset:6144
    v_mfma_f32_16x16x32_bf16 v[20:23], v[180:183], v[160:163], v[20:23]
    ds_read_b64_tr_b16 v[200:201], v216 offset:16416
    v_mfma_f32_16x16x32_bf16 v[20:23], v[176:179], v[144:147], v[20:23]
    ds_read_b64_tr_b16 v[202:203], v216 offset:18208
    v_mfma_f32_16x16x32_bf16 v[24:27], v[184:187], v[144:147], v[24:27]
    ds_read_b64_tr_b16 v[204:205], v216 offset:30752
    v_mfma_f32_16x16x32_bf16 v[24:27], v[188:191], v[160:163], v[24:27]
    ds_read_b64_tr_b16 v[206:207], v216 offset:32544
    v_mfma_f32_16x16x32_bf16 v[52:55], v[188:191], v[164:167], v[52:55]
    ds_read_b64_tr_b16 v[176:177], v215 offset:16448
    v_mfma_f32_16x16x32_bf16 v[52:55], v[184:187], v[148:151], v[52:55]
    ds_read_b64_tr_b16 v[178:179], v215 offset:18240
    v_mfma_f32_16x16x32_bf16 v[80:83], v[184:187], v[152:155], v[80:83]
    ds_read_b64_tr_b16 v[180:181], v215 offset:30784
    v_mfma_f32_16x16x32_bf16 v[80:83], v[188:191], v[168:171], v[80:83]
    ds_read_b64_tr_b16 v[182:183], v215 offset:32576
    v_mfma_f32_16x16x32_bf16 v[108:111], v[188:191], v[172:175], v[108:111]
    v_mfma_f32_16x16x32_bf16 v[108:111], v[184:187], v[156:159], v[108:111]
    s_waitcnt lgkmcnt(8)
    s_nop 0
    v_mfma_f32_16x16x32_bf16 v[0:3], v[192:195], v[112:115], v[0:3]
    ds_read_b64_tr_b16 v[184:185], v216 offset:16480
    v_mfma_f32_16x16x32_bf16 v[0:3], v[196:199], v[128:131], v[0:3]
    ds_read_b64_tr_b16 v[186:187], v216 offset:18272
    v_mfma_f32_16x16x32_bf16 v[28:31], v[196:199], v[132:135], v[28:31]
    ds_read_b64_tr_b16 v[188:189], v216 offset:30816
    v_mfma_f32_16x16x32_bf16 v[28:31], v[192:195], v[116:119], v[28:31]
    ds_read_b64_tr_b16 v[190:191], v216 offset:32608
    v_mfma_f32_16x16x32_bf16 v[56:59], v[192:195], v[120:123], v[56:59]
    v_mfma_f32_16x16x32_bf16 v[56:59], v[196:199], v[136:139], v[56:59]
    v_mfma_f32_16x16x32_bf16 v[84:87], v[196:199], v[140:143], v[84:87]
    v_mfma_f32_16x16x32_bf16 v[84:87], v[192:195], v[124:127], v[84:87]
    s_waitcnt lgkmcnt(4)
    s_nop 0
    v_mfma_f32_16x16x32_bf16 v[88:91], v[200:203], v[124:127], v[88:91]
    ds_read_b64_tr_b16 v[192:193], v215 offset:16512
    v_mfma_f32_16x16x32_bf16 v[88:91], v[204:207], v[140:143], v[88:91]
    ds_read_b64_tr_b16 v[194:195], v215 offset:18304
    v_mfma_f32_16x16x32_bf16 v[60:63], v[204:207], v[136:139], v[60:63]
    ds_read_b64_tr_b16 v[196:197], v215 offset:30848
    v_mfma_f32_16x16x32_bf16 v[60:63], v[200:203], v[120:123], v[60:63]
    ds_read_b64_tr_b16 v[198:199], v215 offset:32640
    v_mfma_f32_16x16x32_bf16 v[32:35], v[200:203], v[116:119], v[32:35]
    v_mfma_f32_16x16x32_bf16 v[32:35], v[204:207], v[132:135], v[32:35]
    v_mfma_f32_16x16x32_bf16 v[4:7], v[204:207], v[128:131], v[4:7]
    v_mfma_f32_16x16x32_bf16 v[4:7], v[200:203], v[112:115], v[4:7]
    v_mfma_f32_16x16x32_bf16 v[8:11], v[176:179], v[112:115], v[8:11]
    ds_read_b64_tr_b16 v[200:201], v216 offset:16544
    v_mfma_f32_16x16x32_bf16 v[8:11], v[180:183], v[128:131], v[8:11]
    ds_read_b64_tr_b16 v[202:203], v216 offset:18336
    v_mfma_f32_16x16x32_bf16 v[36:39], v[180:183], v[132:135], v[36:39]
    ds_read_b64_tr_b16 v[204:205], v216 offset:30880
    v_mfma_f32_16x16x32_bf16 v[36:39], v[176:179], v[116:119], v[36:39]
    ds_read_b64_tr_b16 v[206:207], v216 offset:32672
    v_mfma_f32_16x16x32_bf16 v[64:67], v[176:179], v[120:123], v[64:67]
    v_mfma_f32_16x16x32_bf16 v[64:67], v[180:183], v[136:139], v[64:67]
    v_mfma_f32_16x16x32_bf16 v[92:95], v[180:183], v[140:143], v[92:95]
    v_mfma_f32_16x16x32_bf16 v[92:95], v[176:179], v[124:127], v[92:95]
    s_waitcnt lgkmcnt(4)
    s_nop 0
    v_mfma_f32_16x16x32_bf16 v[96:99], v[184:187], v[124:127], v[96:99]
    ds_read_b64_tr_b16 v[176:177], v217 offset:16384
    v_mfma_f32_16x16x32_bf16 v[96:99], v[188:191], v[140:143], v[96:99]
    ds_read_b64_tr_b16 v[178:179], v217 offset:18176
    v_mfma_f32_16x16x32_bf16 v[68:71], v[188:191], v[136:139], v[68:71]
    ds_read_b64_tr_b16 v[180:181], v217 offset:30720
    v_mfma_f32_16x16x32_bf16 v[68:71], v[184:187], v[120:123], v[68:71]
    ds_read_b64_tr_b16 v[182:183], v217 offset:32512
    v_mfma_f32_16x16x32_bf16 v[40:43], v[184:187], v[116:119], v[40:43]
    v_mfma_f32_16x16x32_bf16 v[40:43], v[188:191], v[132:135], v[40:43]
    v_mfma_f32_16x16x32_bf16 v[12:15], v[188:191], v[128:131], v[12:15]
    v_mfma_f32_16x16x32_bf16 v[12:15], v[184:187], v[112:115], v[12:15]
    v_mfma_f32_16x16x32_bf16 v[16:19], v[192:195], v[112:115], v[16:19]
    v_mfma_f32_16x16x32_bf16 v[16:19], v[196:199], v[128:131], v[16:19]
    s_waitcnt lgkmcnt(0)
    s_barrier
    v_mfma_f32_16x16x32_bf16 v[44:47], v[196:199], v[132:135], v[44:47]
    ds_read_b64_tr_b16 v[184:185], v220 offset:16384
    v_mfma_f32_16x16x32_bf16 v[44:47], v[192:195], v[116:119], v[44:47]
    ds_read_b64_tr_b16 v[186:187], v220 offset:18176
    v_mfma_f32_16x16x32_bf16 v[72:75], v[192:195], v[120:123], v[72:75]
    ds_read_b64_tr_b16 v[188:189], v220 offset:30720
    v_mfma_f32_16x16x32_bf16 v[72:75], v[196:199], v[136:139], v[72:75]
    ds_read_b64_tr_b16 v[190:191], v220 offset:32512
    v_mfma_f32_16x16x32_bf16 v[100:103], v[196:199], v[140:143], v[100:103]
    ds_read_b128 v[144:147], v218 offset:0
    v_mfma_f32_16x16x32_bf16 v[100:103], v[192:195], v[124:127], v[100:103]
    ds_read_b128 v[160:163], v219 offset:0
    v_mfma_f32_16x16x32_bf16 v[104:107], v[200:203], v[124:127], v[104:107]
    ds_read_b128 v[148:151], v218 offset:2048
    v_mfma_f32_16x16x32_bf16 v[104:107], v[204:207], v[140:143], v[104:107]
    ds_read_b128 v[164:167], v219 offset:2048
    v_mfma_f32_16x16x32_bf16 v[76:79], v[204:207], v[136:139], v[76:79]
    ds_read_b128 v[152:155], v218 offset:4096
    v_mfma_f32_16x16x32_bf16 v[76:79], v[200:203], v[120:123], v[76:79]
    ds_read_b128 v[168:171], v219 offset:4096
    v_mfma_f32_16x16x32_bf16 v[48:51], v[200:203], v[116:119], v[48:51]
    ds_read_b128 v[156:159], v218 offset:6144
    v_mfma_f32_16x16x32_bf16 v[48:51], v[204:207], v[132:135], v[48:51]
    ds_read_b128 v[172:175], v219 offset:6144
    v_mfma_f32_16x16x32_bf16 v[20:23], v[204:207], v[128:131], v[20:23]
    ds_read_b64_tr_b16 v[192:193], v221 offset:16416
    v_mfma_f32_16x16x32_bf16 v[20:23], v[200:203], v[112:115], v[20:23]
    ds_read_b64_tr_b16 v[194:195], v221 offset:18208
    v_mfma_f32_16x16x32_bf16 v[24:27], v[176:179], v[112:115], v[24:27]
    ds_read_b64_tr_b16 v[196:197], v221 offset:30752
    v_mfma_f32_16x16x32_bf16 v[24:27], v[180:183], v[128:131], v[24:27]
    ds_read_b64_tr_b16 v[198:199], v221 offset:32544
    v_mfma_f32_16x16x32_bf16 v[52:55], v[180:183], v[132:135], v[52:55]
    ds_read_b64_tr_b16 v[200:201], v220 offset:16448
    v_mfma_f32_16x16x32_bf16 v[52:55], v[176:179], v[116:119], v[52:55]
    ds_read_b64_tr_b16 v[202:203], v220 offset:18240
    v_mfma_f32_16x16x32_bf16 v[80:83], v[176:179], v[120:123], v[80:83]
    ds_read_b64_tr_b16 v[204:205], v220 offset:30784
    v_mfma_f32_16x16x32_bf16 v[80:83], v[180:183], v[136:139], v[80:83]
    ds_read_b64_tr_b16 v[206:207], v220 offset:32576
    v_mfma_f32_16x16x32_bf16 v[108:111], v[180:183], v[140:143], v[108:111]
    v_mfma_f32_16x16x32_bf16 v[108:111], v[176:179], v[124:127], v[108:111]
    s_waitcnt lgkmcnt(8)
    s_nop 0
    v_mfma_f32_16x16x32_bf16 v[0:3], v[184:187], v[144:147], v[0:3]
    ds_read_b64_tr_b16 v[176:177], v221 offset:16480
    v_mfma_f32_16x16x32_bf16 v[0:3], v[188:191], v[160:163], v[0:3]
    ds_read_b64_tr_b16 v[178:179], v221 offset:18272
    v_mfma_f32_16x16x32_bf16 v[28:31], v[188:191], v[164:167], v[28:31]
    ds_read_b64_tr_b16 v[180:181], v221 offset:30816
    v_mfma_f32_16x16x32_bf16 v[28:31], v[184:187], v[148:151], v[28:31]
    ds_read_b64_tr_b16 v[182:183], v221 offset:32608
    v_mfma_f32_16x16x32_bf16 v[56:59], v[184:187], v[152:155], v[56:59]
    v_mfma_f32_16x16x32_bf16 v[56:59], v[188:191], v[168:171], v[56:59]
    v_mfma_f32_16x16x32_bf16 v[84:87], v[188:191], v[172:175], v[84:87]
    v_mfma_f32_16x16x32_bf16 v[84:87], v[184:187], v[156:159], v[84:87]
    s_waitcnt lgkmcnt(4)
    s_nop 0
    v_mfma_f32_16x16x32_bf16 v[88:91], v[192:195], v[156:159], v[88:91]
    ds_read_b64_tr_b16 v[184:185], v220 offset:16512
    v_mfma_f32_16x16x32_bf16 v[88:91], v[196:199], v[172:175], v[88:91]
    ds_read_b64_tr_b16 v[186:187], v220 offset:18304
    v_mfma_f32_16x16x32_bf16 v[60:63], v[196:199], v[168:171], v[60:63]
    ds_read_b64_tr_b16 v[188:189], v220 offset:30848
    v_mfma_f32_16x16x32_bf16 v[60:63], v[192:195], v[152:155], v[60:63]
    ds_read_b64_tr_b16 v[190:191], v220 offset:32640
    v_mfma_f32_16x16x32_bf16 v[32:35], v[192:195], v[148:151], v[32:35]
    v_mfma_f32_16x16x32_bf16 v[32:35], v[196:199], v[164:167], v[32:35]
    v_mfma_f32_16x16x32_bf16 v[4:7], v[196:199], v[160:163], v[4:7]
    v_mfma_f32_16x16x32_bf16 v[4:7], v[192:195], v[144:147], v[4:7]
    v_mfma_f32_16x16x32_bf16 v[8:11], v[200:203], v[144:147], v[8:11]
    ds_read_b64_tr_b16 v[192:193], v221 offset:16544
    v_mfma_f32_16x16x32_bf16 v[8:11], v[204:207], v[160:163], v[8:11]
    ds_read_b64_tr_b16 v[194:195], v221 offset:18336
    v_mfma_f32_16x16x32_bf16 v[36:39], v[204:207], v[164:167], v[36:39]
    ds_read_b64_tr_b16 v[196:197], v221 offset:30880
    v_mfma_f32_16x16x32_bf16 v[36:39], v[200:203], v[148:151], v[36:39]
    ds_read_b64_tr_b16 v[198:199], v221 offset:32672
    v_mfma_f32_16x16x32_bf16 v[64:67], v[200:203], v[152:155], v[64:67]
    v_mfma_f32_16x16x32_bf16 v[64:67], v[204:207], v[168:171], v[64:67]
    v_mfma_f32_16x16x32_bf16 v[92:95], v[204:207], v[172:175], v[92:95]
    v_mfma_f32_16x16x32_bf16 v[92:95], v[200:203], v[156:159], v[92:95]
    s_waitcnt lgkmcnt(4)
    s_nop 0
    v_mfma_f32_16x16x32_bf16 v[96:99], v[176:179], v[156:159], v[96:99]
    ds_read_b64_tr_b16 v[200:201], v222 offset:16384
    v_mfma_f32_16x16x32_bf16 v[96:99], v[180:183], v[172:175], v[96:99]
    ds_read_b64_tr_b16 v[202:203], v222 offset:18176
    v_mfma_f32_16x16x32_bf16 v[68:71], v[180:183], v[168:171], v[68:71]
    ds_read_b64_tr_b16 v[204:205], v222 offset:30720
    v_mfma_f32_16x16x32_bf16 v[68:71], v[176:179], v[152:155], v[68:71]
    ds_read_b64_tr_b16 v[206:207], v222 offset:32512
    v_mfma_f32_16x16x32_bf16 v[40:43], v[176:179], v[148:151], v[40:43]
    v_mfma_f32_16x16x32_bf16 v[40:43], v[180:183], v[164:167], v[40:43]
    v_mfma_f32_16x16x32_bf16 v[12:15], v[180:183], v[160:163], v[12:15]
    v_mfma_f32_16x16x32_bf16 v[12:15], v[176:179], v[144:147], v[12:15]
    v_mfma_f32_16x16x32_bf16 v[16:19], v[184:187], v[144:147], v[16:19]
    v_mfma_f32_16x16x32_bf16 v[16:19], v[188:191], v[160:163], v[16:19]
    s_waitcnt lgkmcnt(0)
    s_barrier
    v_mfma_f32_16x16x32_bf16 v[44:47], v[188:191], v[164:167], v[44:47]
    ds_read_b64_tr_b16 v[176:177], v210 offset:16384
    v_mfma_f32_16x16x32_bf16 v[44:47], v[184:187], v[148:151], v[44:47]
    ds_read_b64_tr_b16 v[178:179], v210 offset:18176
    v_mfma_f32_16x16x32_bf16 v[72:75], v[184:187], v[152:155], v[72:75]
    ds_read_b64_tr_b16 v[180:181], v210 offset:30720
    v_mfma_f32_16x16x32_bf16 v[72:75], v[188:191], v[168:171], v[72:75]
    ds_read_b64_tr_b16 v[182:183], v210 offset:32512
    v_mfma_f32_16x16x32_bf16 v[100:103], v[188:191], v[172:175], v[100:103]
    ds_read_b128 v[112:115], v208 offset:0
    v_mfma_f32_16x16x32_bf16 v[100:103], v[184:187], v[156:159], v[100:103]
    ds_read_b128 v[128:131], v209 offset:0
    v_mfma_f32_16x16x32_bf16 v[104:107], v[192:195], v[156:159], v[104:107]
    ds_read_b128 v[116:119], v208 offset:2048
    v_mfma_f32_16x16x32_bf16 v[104:107], v[196:199], v[172:175], v[104:107]
    ds_read_b128 v[132:135], v209 offset:2048
    v_mfma_f32_16x16x32_bf16 v[76:79], v[196:199], v[168:171], v[76:79]
    ds_read_b128 v[120:123], v208 offset:4096
    v_mfma_f32_16x16x32_bf16 v[76:79], v[192:195], v[152:155], v[76:79]
    ds_read_b128 v[136:139], v209 offset:4096
    v_mfma_f32_16x16x32_bf16 v[48:51], v[192:195], v[148:151], v[48:51]
    ds_read_b128 v[124:127], v208 offset:6144
    v_mfma_f32_16x16x32_bf16 v[48:51], v[196:199], v[164:167], v[48:51]
    ds_read_b128 v[140:143], v209 offset:6144
    v_mfma_f32_16x16x32_bf16 v[20:23], v[196:199], v[160:163], v[20:23]
    ds_read_b64_tr_b16 v[184:185], v211 offset:16416
    v_mfma_f32_16x16x32_bf16 v[20:23], v[192:195], v[144:147], v[20:23]
    ds_read_b64_tr_b16 v[186:187], v211 offset:18208
    v_mfma_f32_16x16x32_bf16 v[24:27], v[200:203], v[144:147], v[24:27]
    ds_read_b64_tr_b16 v[188:189], v211 offset:30752
    v_mfma_f32_16x16x32_bf16 v[24:27], v[204:207], v[160:163], v[24:27]
    ds_read_b64_tr_b16 v[190:191], v211 offset:32544
    v_mfma_f32_16x16x32_bf16 v[52:55], v[204:207], v[164:167], v[52:55]
    ds_read_b64_tr_b16 v[192:193], v210 offset:16448
    v_mfma_f32_16x16x32_bf16 v[52:55], v[200:203], v[148:151], v[52:55]
    ds_read_b64_tr_b16 v[194:195], v210 offset:18240
    v_mfma_f32_16x16x32_bf16 v[80:83], v[200:203], v[152:155], v[80:83]
    ds_read_b64_tr_b16 v[196:197], v210 offset:30784
    v_mfma_f32_16x16x32_bf16 v[80:83], v[204:207], v[168:171], v[80:83]
    ds_read_b64_tr_b16 v[198:199], v210 offset:32576
    v_mfma_f32_16x16x32_bf16 v[108:111], v[204:207], v[172:175], v[108:111]
    v_mfma_f32_16x16x32_bf16 v[108:111], v[200:203], v[156:159], v[108:111]
    s_waitcnt lgkmcnt(8)
    s_nop 0
    v_mfma_f32_16x16x32_bf16 v[0:3], v[176:179], v[112:115], v[0:3]
    ds_read_b64_tr_b16 v[200:201], v211 offset:16480
    v_mfma_f32_16x16x32_bf16 v[0:3], v[180:183], v[128:131], v[0:3]
    ds_read_b64_tr_b16 v[202:203], v211 offset:18272
    v_mfma_f32_16x16x32_bf16 v[28:31], v[180:183], v[132:135], v[28:31]
    ds_read_b64_tr_b16 v[204:205], v211 offset:30816
    v_mfma_f32_16x16x32_bf16 v[28:31], v[176:179], v[116:119], v[28:31]
    ds_read_b64_tr_b16 v[206:207], v211 offset:32608
    v_mfma_f32_16x16x32_bf16 v[56:59], v[176:179], v[120:123], v[56:59]
    v_mfma_f32_16x16x32_bf16 v[56:59], v[180:183], v[136:139], v[56:59]
    v_mfma_f32_16x16x32_bf16 v[84:87], v[180:183], v[140:143], v[84:87]
    v_mfma_f32_16x16x32_bf16 v[84:87], v[176:179], v[124:127], v[84:87]
    s_waitcnt lgkmcnt(4)
    s_nop 0
    v_mfma_f32_16x16x32_bf16 v[88:91], v[184:187], v[124:127], v[88:91]
    ds_read_b64_tr_b16 v[176:177], v210 offset:16512
    v_mfma_f32_16x16x32_bf16 v[88:91], v[188:191], v[140:143], v[88:91]
    ds_read_b64_tr_b16 v[178:179], v210 offset:18304
    v_mfma_f32_16x16x32_bf16 v[60:63], v[188:191], v[136:139], v[60:63]
    ds_read_b64_tr_b16 v[180:181], v210 offset:30848
    v_mfma_f32_16x16x32_bf16 v[60:63], v[184:187], v[120:123], v[60:63]
    ds_read_b64_tr_b16 v[182:183], v210 offset:32640
    v_mfma_f32_16x16x32_bf16 v[32:35], v[184:187], v[116:119], v[32:35]
    v_mfma_f32_16x16x32_bf16 v[32:35], v[188:191], v[132:135], v[32:35]
    v_mfma_f32_16x16x32_bf16 v[4:7], v[188:191], v[128:131], v[4:7]
    v_mfma_f32_16x16x32_bf16 v[4:7], v[184:187], v[112:115], v[4:7]
    v_mfma_f32_16x16x32_bf16 v[8:11], v[192:195], v[112:115], v[8:11]
    ds_read_b64_tr_b16 v[184:185], v211 offset:16544
    v_mfma_f32_16x16x32_bf16 v[8:11], v[196:199], v[128:131], v[8:11]
    ds_read_b64_tr_b16 v[186:187], v211 offset:18336
    v_mfma_f32_16x16x32_bf16 v[36:39], v[196:199], v[132:135], v[36:39]
    ds_read_b64_tr_b16 v[188:189], v211 offset:30880
    v_mfma_f32_16x16x32_bf16 v[36:39], v[192:195], v[116:119], v[36:39]
    ds_read_b64_tr_b16 v[190:191], v211 offset:32672
    v_mfma_f32_16x16x32_bf16 v[64:67], v[192:195], v[120:123], v[64:67]
    v_mfma_f32_16x16x32_bf16 v[64:67], v[196:199], v[136:139], v[64:67]
    v_mfma_f32_16x16x32_bf16 v[92:95], v[196:199], v[140:143], v[92:95]
    v_mfma_f32_16x16x32_bf16 v[92:95], v[192:195], v[124:127], v[92:95]
    s_waitcnt lgkmcnt(4)
    s_nop 0
    v_mfma_f32_16x16x32_bf16 v[96:99], v[200:203], v[124:127], v[96:99]
    ds_read_b64_tr_b16 v[192:193], v212 offset:16384
    v_mfma_f32_16x16x32_bf16 v[96:99], v[204:207], v[140:143], v[96:99]
    ds_read_b64_tr_b16 v[194:195], v212 offset:18176
    v_mfma_f32_16x16x32_bf16 v[68:71], v[204:207], v[136:139], v[68:71]
    ds_read_b64_tr_b16 v[196:197], v212 offset:30720
    v_mfma_f32_16x16x32_bf16 v[68:71], v[200:203], v[120:123], v[68:71]
    ds_read_b64_tr_b16 v[198:199], v212 offset:32512
    v_mfma_f32_16x16x32_bf16 v[40:43], v[200:203], v[116:119], v[40:43]
    v_mfma_f32_16x16x32_bf16 v[40:43], v[204:207], v[132:135], v[40:43]
    v_mfma_f32_16x16x32_bf16 v[12:15], v[204:207], v[128:131], v[12:15]
    v_mfma_f32_16x16x32_bf16 v[12:15], v[200:203], v[112:115], v[12:15]
    v_mfma_f32_16x16x32_bf16 v[16:19], v[176:179], v[112:115], v[16:19]
    v_mfma_f32_16x16x32_bf16 v[16:19], v[180:183], v[128:131], v[16:19]
    s_waitcnt lgkmcnt(0)
    s_barrier
    v_mfma_f32_16x16x32_bf16 v[44:47], v[180:183], v[132:135], v[44:47]
    ds_read_b64_tr_b16 v[200:201], v215 offset:16384
    v_mfma_f32_16x16x32_bf16 v[44:47], v[176:179], v[116:119], v[44:47]
    ds_read_b64_tr_b16 v[202:203], v215 offset:18176
    v_mfma_f32_16x16x32_bf16 v[72:75], v[176:179], v[120:123], v[72:75]
    ds_read_b64_tr_b16 v[204:205], v215 offset:30720
    v_mfma_f32_16x16x32_bf16 v[72:75], v[180:183], v[136:139], v[72:75]
    ds_read_b64_tr_b16 v[206:207], v215 offset:32512
    v_mfma_f32_16x16x32_bf16 v[100:103], v[180:183], v[140:143], v[100:103]
    ds_read_b128 v[144:147], v213 offset:0
    v_mfma_f32_16x16x32_bf16 v[100:103], v[176:179], v[124:127], v[100:103]
    ds_read_b128 v[160:163], v214 offset:0
    v_mfma_f32_16x16x32_bf16 v[104:107], v[184:187], v[124:127], v[104:107]
    ds_read_b128 v[148:151], v213 offset:2048
    v_mfma_f32_16x16x32_bf16 v[104:107], v[188:191], v[140:143], v[104:107]
    ds_read_b128 v[164:167], v214 offset:2048
    v_mfma_f32_16x16x32_bf16 v[76:79], v[188:191], v[136:139], v[76:79]
    ds_read_b128 v[152:155], v213 offset:4096
    v_mfma_f32_16x16x32_bf16 v[76:79], v[184:187], v[120:123], v[76:79]
    ds_read_b128 v[168:171], v214 offset:4096
    v_mfma_f32_16x16x32_bf16 v[48:51], v[184:187], v[116:119], v[48:51]
    ds_read_b128 v[156:159], v213 offset:6144
    v_mfma_f32_16x16x32_bf16 v[48:51], v[188:191], v[132:135], v[48:51]
    ds_read_b128 v[172:175], v214 offset:6144
    v_mfma_f32_16x16x32_bf16 v[20:23], v[188:191], v[128:131], v[20:23]
    ds_read_b64_tr_b16 v[176:177], v216 offset:16416
    v_mfma_f32_16x16x32_bf16 v[20:23], v[184:187], v[112:115], v[20:23]
    ds_read_b64_tr_b16 v[178:179], v216 offset:18208
    v_mfma_f32_16x16x32_bf16 v[24:27], v[192:195], v[112:115], v[24:27]
    ds_read_b64_tr_b16 v[180:181], v216 offset:30752
    v_mfma_f32_16x16x32_bf16 v[24:27], v[196:199], v[128:131], v[24:27]
    ds_read_b64_tr_b16 v[182:183], v216 offset:32544
    v_mfma_f32_16x16x32_bf16 v[52:55], v[196:199], v[132:135], v[52:55]
    ds_read_b64_tr_b16 v[184:185], v215 offset:16448
    v_mfma_f32_16x16x32_bf16 v[52:55], v[192:195], v[116:119], v[52:55]
    ds_read_b64_tr_b16 v[186:187], v215 offset:18240
    v_mfma_f32_16x16x32_bf16 v[80:83], v[192:195], v[120:123], v[80:83]
    ds_read_b64_tr_b16 v[188:189], v215 offset:30784
    v_mfma_f32_16x16x32_bf16 v[80:83], v[196:199], v[136:139], v[80:83]
    ds_read_b64_tr_b16 v[190:191], v215 offset:32576
    v_mfma_f32_16x16x32_bf16 v[108:111], v[196:199], v[140:143], v[108:111]
    v_mfma_f32_16x16x32_bf16 v[108:111], v[192:195], v[124:127], v[108:111]
    s_waitcnt lgkmcnt(8)
    s_nop 0
    v_mfma_f32_16x16x32_bf16 v[0:3], v[200:203], v[144:147], v[0:3]
    ds_read_b64_tr_b16 v[192:193], v216 offset:16480
    v_mfma_f32_16x16x32_bf16 v[0:3], v[204:207], v[160:163], v[0:3]
    ds_read_b64_tr_b16 v[194:195], v216 offset:18272
    v_mfma_f32_16x16x32_bf16 v[28:31], v[204:207], v[164:167], v[28:31]
    ds_read_b64_tr_b16 v[196:197], v216 offset:30816
    v_mfma_f32_16x16x32_bf16 v[28:31], v[200:203], v[148:151], v[28:31]
    ds_read_b64_tr_b16 v[198:199], v216 offset:32608
    v_mfma_f32_16x16x32_bf16 v[56:59], v[200:203], v[152:155], v[56:59]
    v_mfma_f32_16x16x32_bf16 v[56:59], v[204:207], v[168:171], v[56:59]
    v_mfma_f32_16x16x32_bf16 v[84:87], v[204:207], v[172:175], v[84:87]
    v_mfma_f32_16x16x32_bf16 v[84:87], v[200:203], v[156:159], v[84:87]
    s_waitcnt lgkmcnt(4)
    s_nop 0
    v_mfma_f32_16x16x32_bf16 v[88:91], v[176:179], v[156:159], v[88:91]
    ds_read_b64_tr_b16 v[200:201], v215 offset:16512
    v_mfma_f32_16x16x32_bf16 v[88:91], v[180:183], v[172:175], v[88:91]
    ds_read_b64_tr_b16 v[202:203], v215 offset:18304
    v_mfma_f32_16x16x32_bf16 v[60:63], v[180:183], v[168:171], v[60:63]
    ds_read_b64_tr_b16 v[204:205], v215 offset:30848
    v_mfma_f32_16x16x32_bf16 v[60:63], v[176:179], v[152:155], v[60:63]
    ds_read_b64_tr_b16 v[206:207], v215 offset:32640
    v_mfma_f32_16x16x32_bf16 v[32:35], v[176:179], v[148:151], v[32:35]
    v_mfma_f32_16x16x32_bf16 v[32:35], v[180:183], v[164:167], v[32:35]
    v_mfma_f32_16x16x32_bf16 v[4:7], v[180:183], v[160:163], v[4:7]
    v_mfma_f32_16x16x32_bf16 v[4:7], v[176:179], v[144:147], v[4:7]
    v_mfma_f32_16x16x32_bf16 v[8:11], v[184:187], v[144:147], v[8:11]
    ds_read_b64_tr_b16 v[176:177], v216 offset:16544
    v_mfma_f32_16x16x32_bf16 v[8:11], v[188:191], v[160:163], v[8:11]
    ds_read_b64_tr_b16 v[178:179], v216 offset:18336
    v_mfma_f32_16x16x32_bf16 v[36:39], v[188:191], v[164:167], v[36:39]
    ds_read_b64_tr_b16 v[180:181], v216 offset:30880
    v_mfma_f32_16x16x32_bf16 v[36:39], v[184:187], v[148:151], v[36:39]
    ds_read_b64_tr_b16 v[182:183], v216 offset:32672
    v_mfma_f32_16x16x32_bf16 v[64:67], v[184:187], v[152:155], v[64:67]
    v_mfma_f32_16x16x32_bf16 v[64:67], v[188:191], v[168:171], v[64:67]
    v_mfma_f32_16x16x32_bf16 v[92:95], v[188:191], v[172:175], v[92:95]
    v_mfma_f32_16x16x32_bf16 v[92:95], v[184:187], v[156:159], v[92:95]
    s_waitcnt lgkmcnt(4)
    s_nop 0
    v_mfma_f32_16x16x32_bf16 v[96:99], v[192:195], v[156:159], v[96:99]
    ds_read_b64_tr_b16 v[184:185], v217 offset:16384
    v_mfma_f32_16x16x32_bf16 v[96:99], v[196:199], v[172:175], v[96:99]
    ds_read_b64_tr_b16 v[186:187], v217 offset:18176
    v_mfma_f32_16x16x32_bf16 v[68:71], v[196:199], v[168:171], v[68:71]
    ds_read_b64_tr_b16 v[188:189], v217 offset:30720
    v_mfma_f32_16x16x32_bf16 v[68:71], v[192:195], v[152:155], v[68:71]
    ds_read_b64_tr_b16 v[190:191], v217 offset:32512
    v_mfma_f32_16x16x32_bf16 v[40:43], v[192:195], v[148:151], v[40:43]
    v_mfma_f32_16x16x32_bf16 v[40:43], v[196:199], v[164:167], v[40:43]
    v_mfma_f32_16x16x32_bf16 v[12:15], v[196:199], v[160:163], v[12:15]
    v_mfma_f32_16x16x32_bf16 v[12:15], v[192:195], v[144:147], v[12:15]
    v_mfma_f32_16x16x32_bf16 v[16:19], v[200:203], v[144:147], v[16:19]
    v_mfma_f32_16x16x32_bf16 v[16:19], v[204:207], v[160:163], v[16:19]
    s_waitcnt lgkmcnt(0)
    s_barrier
    v_mfma_f32_16x16x32_bf16 v[44:47], v[204:207], v[164:167], v[44:47]
    ds_read_b64_tr_b16 v[192:193], v220 offset:16384
    v_mfma_f32_16x16x32_bf16 v[44:47], v[200:203], v[148:151], v[44:47]
    ds_read_b64_tr_b16 v[194:195], v220 offset:18176
    v_mfma_f32_16x16x32_bf16 v[72:75], v[200:203], v[152:155], v[72:75]
    ds_read_b64_tr_b16 v[196:197], v220 offset:30720
    v_mfma_f32_16x16x32_bf16 v[72:75], v[204:207], v[168:171], v[72:75]
    ds_read_b64_tr_b16 v[198:199], v220 offset:32512
    v_mfma_f32_16x16x32_bf16 v[100:103], v[204:207], v[172:175], v[100:103]
    ds_read_b128 v[112:115], v218 offset:0
    v_mfma_f32_16x16x32_bf16 v[100:103], v[200:203], v[156:159], v[100:103]
    ds_read_b128 v[128:131], v219 offset:0
    v_mfma_f32_16x16x32_bf16 v[104:107], v[176:179], v[156:159], v[104:107]
    ds_read_b128 v[116:119], v218 offset:2048
    v_mfma_f32_16x16x32_bf16 v[104:107], v[180:183], v[172:175], v[104:107]
    ds_read_b128 v[132:135], v219 offset:2048
    v_mfma_f32_16x16x32_bf16 v[76:79], v[180:183], v[168:171], v[76:79]
    ds_read_b128 v[120:123], v218 offset:4096
    v_mfma_f32_16x16x32_bf16 v[76:79], v[176:179], v[152:155], v[76:79]
    ds_read_b128 v[136:139], v219 offset:4096
    v_mfma_f32_16x16x32_bf16 v[48:51], v[176:179], v[148:151], v[48:51]
    ds_read_b128 v[124:127], v218 offset:6144
    v_mfma_f32_16x16x32_bf16 v[48:51], v[180:183], v[164:167], v[48:51]
    ds_read_b128 v[140:143], v219 offset:6144
    v_mfma_f32_16x16x32_bf16 v[20:23], v[180:183], v[160:163], v[20:23]
    ds_read_b64_tr_b16 v[200:201], v221 offset:16416
    v_mfma_f32_16x16x32_bf16 v[20:23], v[176:179], v[144:147], v[20:23]
    ds_read_b64_tr_b16 v[202:203], v221 offset:18208
    v_mfma_f32_16x16x32_bf16 v[24:27], v[184:187], v[144:147], v[24:27]
    ds_read_b64_tr_b16 v[204:205], v221 offset:30752
    v_mfma_f32_16x16x32_bf16 v[24:27], v[188:191], v[160:163], v[24:27]
    ds_read_b64_tr_b16 v[206:207], v221 offset:32544
    v_mfma_f32_16x16x32_bf16 v[52:55], v[188:191], v[164:167], v[52:55]
    ds_read_b64_tr_b16 v[176:177], v220 offset:16448
    v_mfma_f32_16x16x32_bf16 v[52:55], v[184:187], v[148:151], v[52:55]
    ds_read_b64_tr_b16 v[178:179], v220 offset:18240
    v_mfma_f32_16x16x32_bf16 v[80:83], v[184:187], v[152:155], v[80:83]
    ds_read_b64_tr_b16 v[180:181], v220 offset:30784
    v_mfma_f32_16x16x32_bf16 v[80:83], v[188:191], v[168:171], v[80:83]
    ds_read_b64_tr_b16 v[182:183], v220 offset:32576
    v_mfma_f32_16x16x32_bf16 v[108:111], v[188:191], v[172:175], v[108:111]
    v_mfma_f32_16x16x32_bf16 v[108:111], v[184:187], v[156:159], v[108:111]
    s_waitcnt lgkmcnt(8)
    s_nop 0
    v_mfma_f32_16x16x32_bf16 v[0:3], v[192:195], v[112:115], v[0:3]
    ds_read_b64_tr_b16 v[184:185], v221 offset:16480
    v_mfma_f32_16x16x32_bf16 v[0:3], v[196:199], v[128:131], v[0:3]
    ds_read_b64_tr_b16 v[186:187], v221 offset:18272
    v_mfma_f32_16x16x32_bf16 v[28:31], v[196:199], v[132:135], v[28:31]
    ds_read_b64_tr_b16 v[188:189], v221 offset:30816
    v_mfma_f32_16x16x32_bf16 v[28:31], v[192:195], v[116:119], v[28:31]
    ds_read_b64_tr_b16 v[190:191], v221 offset:32608
    v_mfma_f32_16x16x32_bf16 v[56:59], v[192:195], v[120:123], v[56:59]
    v_mfma_f32_16x16x32_bf16 v[56:59], v[196:199], v[136:139], v[56:59]
    v_mfma_f32_16x16x32_bf16 v[84:87], v[196:199], v[140:143], v[84:87]
    v_mfma_f32_16x16x32_bf16 v[84:87], v[192:195], v[124:127], v[84:87]
    s_waitcnt lgkmcnt(4)
    s_nop 0
    v_mfma_f32_16x16x32_bf16 v[88:91], v[200:203], v[124:127], v[88:91]
    ds_read_b64_tr_b16 v[192:193], v220 offset:16512
    v_mfma_f32_16x16x32_bf16 v[88:91], v[204:207], v[140:143], v[88:91]
    ds_read_b64_tr_b16 v[194:195], v220 offset:18304
    v_mfma_f32_16x16x32_bf16 v[60:63], v[204:207], v[136:139], v[60:63]
    ds_read_b64_tr_b16 v[196:197], v220 offset:30848
    v_mfma_f32_16x16x32_bf16 v[60:63], v[200:203], v[120:123], v[60:63]
    ds_read_b64_tr_b16 v[198:199], v220 offset:32640
    v_mfma_f32_16x16x32_bf16 v[32:35], v[200:203], v[116:119], v[32:35]
    v_mfma_f32_16x16x32_bf16 v[32:35], v[204:207], v[132:135], v[32:35]
    v_mfma_f32_16x16x32_bf16 v[4:7], v[204:207], v[128:131], v[4:7]
    v_mfma_f32_16x16x32_bf16 v[4:7], v[200:203], v[112:115], v[4:7]
    v_mfma_f32_16x16x32_bf16 v[8:11], v[176:179], v[112:115], v[8:11]
    ds_read_b64_tr_b16 v[200:201], v221 offset:16544
    v_mfma_f32_16x16x32_bf16 v[8:11], v[180:183], v[128:131], v[8:11]
    ds_read_b64_tr_b16 v[202:203], v221 offset:18336
    v_mfma_f32_16x16x32_bf16 v[36:39], v[180:183], v[132:135], v[36:39]
    ds_read_b64_tr_b16 v[204:205], v221 offset:30880
    v_mfma_f32_16x16x32_bf16 v[36:39], v[176:179], v[116:119], v[36:39]
    ds_read_b64_tr_b16 v[206:207], v221 offset:32672
    v_mfma_f32_16x16x32_bf16 v[64:67], v[176:179], v[120:123], v[64:67]
    v_mfma_f32_16x16x32_bf16 v[64:67], v[180:183], v[136:139], v[64:67]
    v_mfma_f32_16x16x32_bf16 v[92:95], v[180:183], v[140:143], v[92:95]
    v_mfma_f32_16x16x32_bf16 v[92:95], v[176:179], v[124:127], v[92:95]
    s_waitcnt lgkmcnt(4)
    s_nop 0
    v_mfma_f32_16x16x32_bf16 v[96:99], v[184:187], v[124:127], v[96:99]
    ds_read_b64_tr_b16 v[176:177], v222 offset:16384
    v_mfma_f32_16x16x32_bf16 v[96:99], v[188:191], v[140:143], v[96:99]
    ds_read_b64_tr_b16 v[178:179], v222 offset:18176
    v_mfma_f32_16x16x32_bf16 v[68:71], v[188:191], v[136:139], v[68:71]
    ds_read_b64_tr_b16 v[180:181], v222 offset:30720
    v_mfma_f32_16x16x32_bf16 v[68:71], v[184:187], v[120:123], v[68:71]
    ds_read_b64_tr_b16 v[182:183], v222 offset:32512
    v_mfma_f32_16x16x32_bf16 v[40:43], v[184:187], v[116:119], v[40:43]
    v_mfma_f32_16x16x32_bf16 v[40:43], v[188:191], v[132:135], v[40:43]
    v_mfma_f32_16x16x32_bf16 v[12:15], v[188:191], v[128:131], v[12:15]
    v_mfma_f32_16x16x32_bf16 v[12:15], v[184:187], v[112:115], v[12:15]
    v_mfma_f32_16x16x32_bf16 v[16:19], v[192:195], v[112:115], v[16:19]
    v_mfma_f32_16x16x32_bf16 v[16:19], v[196:199], v[128:131], v[16:19]
    s_waitcnt lgkmcnt(0)
    s_barrier
    v_mfma_f32_16x16x32_bf16 v[44:47], v[196:199], v[132:135], v[44:47]
    ds_read_b64_tr_b16 v[184:185], v210 offset:16384
    v_mfma_f32_16x16x32_bf16 v[44:47], v[192:195], v[116:119], v[44:47]
    ds_read_b64_tr_b16 v[186:187], v210 offset:18176
    v_mfma_f32_16x16x32_bf16 v[72:75], v[192:195], v[120:123], v[72:75]
    ds_read_b64_tr_b16 v[188:189], v210 offset:30720
L_wp2:
    s_cbranch_vccnz L_wp6
    s_nop 0
    v_mfma_f32_16x16x32_bf16 v[72:75], v[196:199], v[136:139], v[72:75]
    ds_read_b64_tr_b16 v[190:191], v210 offset:32512
    v_mfma_f32_16x16x32_bf16 v[100:103], v[196:199], v[140:143], v[100:103]
    ds_read_b128 v[144:147], v208 offset:0
    v_mfma_f32_16x16x32_bf16 v[100:103], v[192:195], v[124:127], v[100:103]
    ds_read_b128 v[160:163], v209 offset:0
    v_mfma_f32_16x16x32_bf16 v[104:107], v[200:203], v[124:127], v[104:107]
    ds_read_b128 v[148:151], v208 offset:2048
    v_mfma_f32_16x16x32_bf16 v[104:107], v[204:207], v[140:143], v[104:107]
    ds_read_b128 v[164:167], v209 offset:2048
    v_mfma_f32_16x16x32_bf16 v[76:79], v[204:207], v[136:139], v[76:79]
    ds_read_b128 v[152:155], v208 offset:4096
    v_mfma_f32_16x16x32_bf16 v[76:79], v[200:203], v[120:123], v[76:79]
    ds_read_b128 v[168:171], v209 offset:4096
    v_mfma_f32_16x16x32_bf16 v[48:51], v[200:203], v[116:119], v[48:51]
    ds_read_b128 v[156:159], v208 offset:6144
    v_mfma_f32_16x16x32_bf16 v[48:51], v[204:207], v[132:135], v[48:51]
    ds_read_b128 v[172:175], v209 offset:6144
    v_mfma_f32_16x16x32_bf16 v[20:23], v[204:207], v[128:131], v[20:23]
    ds_read_b64_tr_b16 v[192:193], v211 offset:16416
    v_mfma_f32_16x16x32_bf16 v[20:23], v[200:203], v[112:115], v[20:23]
    ds_read_b64_tr_b16 v[194:195], v211 offset:18208
    v_mfma_f32_16x16x32_bf16 v[24:27], v[176:179], v[112:115], v[24:27]
    ds_read_b64_tr_b16 v[196:197], v211 offset:30752
    v_mfma_f32_16x16x32_bf16 v[24:27], v[180:183], v[128:131], v[24:27]
    ds_read_b64_tr_b16 v[198:199], v211 offset:32544
    v_mfma_f32_16x16x32_bf16 v[52:55], v[180:183], v[132:135], v[52:55]
    ds_read_b64_tr_b16 v[200:201], v210 offset:16448
    v_mfma_f32_16x16x32_bf16 v[52:55], v[176:179], v[116:119], v[52:55]
    ds_read_b64_tr_b16 v[202:203], v210 offset:18240
    v_mfma_f32_16x16x32_bf16 v[80:83], v[176:179], v[120:123], v[80:83]
    ds_read_b64_tr_b16 v[204:205], v210 offset:30784
    v_mfma_f32_16x16x32_bf16 v[80:83], v[180:183], v[136:139], v[80:83]
    ds_read_b64_tr_b16 v[206:207], v210 offset:32576
    v_mfma_f32_16x16x32_bf16 v[108:111], v[180:183], v[140:143], v[108:111]
    v_mfma_f32_16x16x32_bf16 v[108:111], v[176:179], v[124:127], v[108:111]
    s_waitcnt lgkmcnt(8)
    s_nop 0
    v_mfma_f32_16x16x32_bf16 v[0:3], v[184:187], v[144:147], v[0:3]
    ds_read_b64_tr_b16 v[176:177], v211 offset:16480
    v_mfma_f32_16x16x32_bf16 v[0:3], v[188:191], v[160:163], v[0:3]
    ds_read_b64_tr_b16 v[178:179], v211 offset:18272
    v_mfma_f32_16x16x32_bf16 v[28:31], v[188:191], v[164:167], v[28:31]
    ds_read_b64_tr_b16 v[180:181], v211 offset:30816
    v_mfma_f32_16x16x32_bf16 v[28:31], v[184:187], v[148:151], v[28:31]
    ds_read_b64_tr_b16 v[182:183], v211 offset:32608
    v_mfma_f32_16x16x32_bf16 v[56:59], v[184:187], v[152:155], v[56:59]
    v_mfma_f32_16x16x32_bf16 v[56:59], v[188:191], v[168:171], v[56:59]
    v_mfma_f32_16x16x32_bf16 v[84:87], v[188:191], v[172:175], v[84:87]
    v_mfma_f32_16x16x32_bf16 v[84:87], v[184:187], v[156:159], v[84:87]
    s_waitcnt lgkmcnt(4)
    s_nop 0
    v_mfma_f32_16x16x32_bf16 v[88:91], v[192:195], v[156:159], v[88:91]
    ds_read_b64_tr_b16 v[184:185], v210 offset:16512
    v_mfma_f32_16x16x32_bf16 v[88:91], v[196:199], v[172:175], v[88:91]
    ds_read_b64_tr_b16 v[186:187], v210 offset:18304
    v_mfma_f32_16x16x32_bf16 v[60:63], v[196:199], v[168:171], v[60:63]
    ds_read_b64_tr_b16 v[188:189], v210 offset:30848
    v_mfma_f32_16x16x32_bf16 v[60:63], v[192:195], v[152:155], v[60:63]
    ds_read_b64_tr_b16 v[190:191], v210 offset:32640
    v_mfma_f32_16x16x32_bf16 v[32:35], v[192:195], v[148:151], v[32:35]
    v_mfma_f32_16x16x32_bf16 v[32:35], v[196:199], v[164:167], v[32:35]
    v_mfma_f32_16x16x32_bf16 v[4:7], v[196:199], v[160:163], v[4:7]
    v_mfma_f32_16x16x32_bf16 v[4:7], v[192:195], v[144:147], v[4:7]
    v_mfma_f32_16x16x32_bf16 v[8:11], v[200:203], v[144:147], v[8:11]
    ds_read_b64_tr_b16 v[192:193], v211 offset:16544
    v_mfma_f32_16x16x32_bf16 v[8:11], v[204:207], v[160:163], v[8:11]
    ds_read_b64_tr_b16 v[194:195], v211 offset:18336
    v_mfma_f32_16x16x32_bf16 v[36:39], v[204:207], v[164:167], v[36:39]
    ds_read_b64_tr_b16 v[196:197], v211 offset:30880
    v_mfma_f32_16x16x32_bf16 v[36:39], v[200:203], v[148:151], v[36:39]
    ds_read_b64_tr_b16 v[198:199], v211 offset:32672
    v_mfma_f32_16x16x32_bf16 v[64:67], v[200:203], v[152:155], v[64:67]
    v_mfma_f32_16x16x32_bf16 v[64:67], v[204:207], v[168:171], v[64:67]
    v_mfma_f32_16x16x32_bf16 v[92:95], v[204:207], v[172:175], v[92:95]
    v_mfma_f32_16x16x32_bf16 v[92:95], v[200:203], v[156:159], v[92:95]
    s_waitcnt lgkmcnt(4)
    s_nop 0
    v_mfma_f32_16x16x32_bf16 v[96:99], v[176:179], v[156:159], v[96:99]
    ds_read_b64_tr_b16 v[200:201], v212 offset:16384
    v_mfma_f32_16x16x32_bf16 v[96:99], v[180:183], v[172:175], v[96:99]
    ds_read_b64_tr_b16 v[202:203], v212 offset:18176
    v_mfma_f32_16x16x32_bf16 v[68:71], v[180:183], v[168:171], v[68:71]
    ds_read_b64_tr_b16 v[204:205], v212 offset:30720
    v_mfma_f32_16x16x32_bf16 v[68:71], v[176:179], v[152:155], v[68:71]
    ds_read_b64_tr_b16 v[206:207], v212 offset:32512
    v_mfma_f32_16x16x32_bf16 v[40:43], v[176:179], v[148:151], v[40:43]
    v_mfma_f32_16x16x32_bf16 v[40:43], v[180:183], v[164:167], v[40:43]
    v_mfma_f32_16x16x32_bf16 v[12:15], v[180:183], v[160:163], v[12:15]
    v_mfma_f32_16x16x32_bf16 v[12:15], v[176:179], v[144:147], v[12:15]
    v_mfma_f32_16x16x32_bf16 v[16:19], v[184:187], v[144:147], v[16:19]
    v_mfma_f32_16x16x32_bf16 v[16:19], v[188:191], v[160:163], v[16:19]
    s_waitcnt lgkmcnt(0)
    s_barrier
    v_mfma_f32_16x16x32_bf16 v[44:47], v[188:191], v[164:167], v[44:47]
    ds_read_b64 v[208:209], v225 offset:0
    v_mfma_f32_16x16x32_bf16 v[44:47], v[184:187], v[148:151], v[44:47]
    ds_read_b64 v[210:211], v225 offset:128
    v_mfma_f32_16x16x32_bf16 v[72:75], v[184:187], v[152:155], v[72:75]
    ds_read_b64 v[212:213], v225 offset:256
    v_mfma_f32_16x16x32_bf16 v[72:75], v[188:191], v[168:171], v[72:75]
    ds_read_b64 v[214:215], v225 offset:384
    v_mfma_f32_16x16x32_bf16 v[100:103], v[188:191], v[172:175], v[100:103]
    ds_read_b128 v[176:179], v223 offset:896
    v_mfma_f32_16x16x32_bf16 v[100:103], v[184:187], v[156:159], v[100:103]
    ds_read_b128 v[180:183], v223 offset:960
    v_mfma_f32_16x16x32_bf16 v[104:107], v[192:195], v[156:159], v[104:107]
    ds_read_b128 v[112:115], v223 offset:0
    v_mfma_f32_16x16x32_bf16 v[104:107], v[196:199], v[172:175], v[104:107]
    ds_read_b128 v[116:119], v223 offset:64
    v_mfma_f32_16x16x32_bf16 v[76:79], v[196:199], v[168:171], v[76:79]
    ds_read_b128 v[120:123], v223 offset:128
    v_mfma_f32_16x16x32_bf16 v[76:79], v[192:195], v[152:155], v[76:79]
    ds_read_b128 v[124:127], v223 offset:192
    v_mfma_f32_16x16x32_bf16 v[48:51], v[192:195], v[148:151], v[48:51]
    ds_read_b128 v[128:131], v223 offset:256
    v_mfma_f32_16x16x32_bf16 v[48:51], v[196:199], v[164:167], v[48:51]
    ds_read_b128 v[132:135], v223 offset:320
    v_mfma_f32_16x16x32_bf16 v[20:23], v[196:199], v[160:163], v[20:23]
    ds_read_b128 v[136:139], v224 offset:0
    v_mfma_f32_16x16x32_bf16 v[20:23], v[192:195], v[144:147], v[20:23]
    ds_read_b128 v[184:187], v223 offset:1024
    v_mfma_f32_16x16x32_bf16 v[24:27], v[200:203], v[144:147], v[24:27]
    ds_read_b128 v[188:191], v223 offset:1088
    v_mfma_f32_16x16x32_bf16 v[24:27], v[204:207], v[160:163], v[24:27]
    ds_read_b128 v[192:195], v223 offset:1152
    v_mfma_f32_16x16x32_bf16 v[52:55], v[204:207], v[164:167], v[52:55]
    ds_read_b128 v[196:199], v223 offset:1216
    v_mfma_f32_16x16x32_bf16 v[52:55], v[200:203], v[148:151], v[52:55]
    v_mfma_f32_16x16x32_bf16 v[80:83], v[200:203], v[152:155], v[80:83]
    v_mfma_f32_16x16x32_bf16 v[80:83], v[204:207], v[168:171], v[80:83]
    v_mfma_f32_16x16x32_bf16 v[108:111], v[204:207], v[172:175], v[108:111]
    v_mfma_f32_16x16x32_bf16 v[108:111], v[200:203], v[156:159], v[108:111]
L_epi:
    s_waitcnt lgkmcnt(0)
    s_nop 0
    v_pk_fma_f32 v[144:145], v[112:113], v[208:209], v[176:177] op_sel:[0,1,0] op_sel_hi:[1,1,1]
    v_pk_fma_f32 v[146:147], v[114:115], v[208:209], v[178:179] op_sel:[0,1,0] op_sel_hi:[1,1,1]
    v_pk_fma_f32 v[148:149], v[116:117], v[208:209], v[180:181] op_sel:[0,1,0] op_sel_hi:[1,1,1]
    v_pk_fma_f32 v[150:151], v[118:119], v[208:209], v[182:183] op_sel:[0,1,0] op_sel_hi:[1,1,1]
    v_pk_fma_f32 v[152:153], v[112:113], v[210:211], v[176:177] op_sel:[0,1,0] op_sel_hi:[1,1,1]
    v_pk_fma_f32 v[154:155], v[114:115], v[210:211], v[178:179] op_sel:[0,1,0] op_sel_hi:[1,1,1]
    v_pk_fma_f32 v[156:157], v[116:117], v[210:211], v[180:181] op_sel:[0,1,0] op_sel_hi:[1,1,1]
    v_pk_fma_f32 v[158:159], v[118:119], v[210:211], v[182:183] op_sel:[0,1,0] op_sel_hi:[1,1,1]
    v_pk_fma_f32 v[0:1], v[0:1], v[208:209], v[144:145] op_sel:[0,0,0] op_sel_hi:[1,0,1]
    v_pk_fma_f32 v[2:3], v[2:3], v[208:209], v[146:147] op_sel:[0,0,0] op_sel_hi:[1,0,1]
    v_pk_fma_f32 v[4:5], v[4:5], v[208:209], v[148:149] op_sel:[0,0,0] op_sel_hi:[1,0,1]
    v_pk_fma_f32 v[6:7], v[6:7], v[208:209], v[150:151] op_sel:[0,0,0] op_sel_hi:[1,0,1]
    v_pk_fma_f32 v[28:29], v[28:29], v[210:211], v[152:153] op_sel:[0,0,0] op_sel_hi:[1,0,1]
    v_pk_fma_f32 v[30:31], v[30:31], v[210:211], v[154:155] op_sel:[0,0,0] op_sel_hi:[1,0,1]
    v_pk_fma_f32 v[32:33], v[32:33], v[210:211], v[156:157] op_sel:[0,0,0] op_sel_hi:[1,0,1]
    v_pk_fma_f32 v[34:35], v[34:35], v[210:211], v[158:159] op_sel:[0,0,0] op_sel_hi:[1,0,1]
    v_pk_mul_f32 v[144:145], v[0:1], v[0:1]
    v_pk_mul_f32 v[146:147], v[2:3], v[2:3]
    v_pk_mul_f32 v[148:149], v[4:5], v[4:5]
    v_pk_mul_f32 v[150:151], v[6:7], v[6:7]
    v_pk_mul_f32 v[152:153], v[28:29], v[28:29]
    v_pk_mul_f32 v[154:155], v[30:31], v[30:31]
    v_pk_mul_f32 v[156:157], v[32:33], v[32:33]
    v_pk_mul_f32 v[158:159], v[34:35], v[34:35]
    v_pk_fma_f32 v[144:145], v[144:145], v[228:229], v[228:229] op_sel:[0,1,0] op_sel_hi:[1,1,0]
    v_pk_fma_f32 v[146:147], v[146:147], v[228:229], v[228:229] op_sel:[0,1,0] op_sel_hi:[1,1,0]
    v_pk_fma_f32 v[148:149], v[148:149], v[228:229], v[228:229] op_sel:[0,1,0] op_sel_hi:[1,1,0]
    v_pk_fma_f32 v[150:151], v[150:151], v[228:229], v[228:229] op_sel:[0,1,0] op_sel_hi:[1,1,0]
    v_pk_fma_f32 v[152:153], v[152:153], v[228:229], v[228:229] op_sel:[0,1,0] op_sel_hi:[1,1,0]
    v_pk_fma_f32 v[154:155], v[154:155], v[228:229], v[228:229] op_sel:[0,1,0] op_sel_hi:[1,1,0]
    v_pk_fma_f32 v[156:157], v[156:157], v[228:229], v[228:229] op_sel:[0,1,0] op_sel_hi:[1,1,0]
    v_pk_fma_f32 v[158:159], v[158:159], v[228:229], v[228:229] op_sel:[0,1,0] op_sel_hi:[1,1,0]
    v_pk_mul_f32 v[144:145], v[144:145], v[0:1]
    v_pk_mul_f32 v[146:147], v[146:147], v[2:3]
    v_pk_mul_f32 v[148:149], v[148:149], v[4:5]
    v_pk_mul_f32 v[150:151], v[150:151], v[6:7]
    v_pk_mul_f32 v[152:153], v[152:153], v[28:29]
    v_pk_mul_f32 v[154:155], v[154:155], v[30:31]
    v_pk_mul_f32 v[156:157], v[156:157], v[32:33]
    v_pk_mul_f32 v[158:159], v[158:159], v[34:35]
    v_exp_f32 v144, v144
    v_exp_f32 v145, v145
    ds_read_b128 v[200:203], v224 offset:896
    v_exp_f32 v146, v146
    v_exp_f32 v147, v147
    v_exp_f32 v148, v148
    v_exp_f32 v149, v149
    ds_read_b64 v[216:217], v250 offset:0
    v_exp_f32 v150, v150
    v_exp_f32 v151, v151
    v_exp_f32 v152, v152
    v_exp_f32 v153, v153
    ds_read_b64 v[218:219], v250 offset:32
    v_exp_f32 v154, v154
    v_exp_f32 v155, v155
    v_exp_f32 v156, v156
    v_exp_f32 v157, v157
    v_exp_f32 v158, v158
    v_exp_f32 v159, v159
    v_pk_add_f32 v[144:145], v[144:145], 1.0 op_sel_hi:[1,0]
    v_pk_add_f32 v[146:147], v[146:147], 1.0 op_sel_hi:[1,0]
    v_pk_add_f32 v[148:149], v[148:149], 1.0 op_sel_hi:[1,0]
    v_pk_add_f32 v[150:151], v[150:151], 1.0 op_sel_hi:[1,0]
    v_pk_add_f32 v[152:153], v[152:153], 1.0 op_sel_hi:[1,0]
    v_pk_add_f32 v[154:155], v[154:155], 1.0 op_sel_hi:[1,0]
    v_pk_add_f32 v[156:157], v[156:157], 1.0 op_sel_hi:[1,0]
    v_pk_add_f32 v[158:159], v[158:159], 1.0 op_sel_hi:[1,0]
    v_rcp_f32 v144, v144
    v_rcp_f32 v145, v145
    v_rcp_f32 v146, v146
    v_rcp_f32 v147, v147
    v_rcp_f32 v148, v148
    v_rcp_f32 v149, v149
    v_rcp_f32 v150, v150
    v_rcp_f32 v151, v151
    v_rcp_f32 v152, v152
    v_rcp_f32 v153, v153
    v_rcp_f32 v154, v154
    v_rcp_f32 v155, v155
    v_rcp_f32 v156, v156
    v_rcp_f32 v157, v157
    v_rcp_f32 v158, v158
    v_rcp_f32 v159, v159
    v_pk_mul_f32 v[144:145], v[144:145], v[0:1]
    v_pk_mul_f32 v[146:147], v[146:147], v[2:3]
    v_pk_mul_f32 v[148:149], v[148:149], v[4:5]
    v_pk_mul_f32 v[150:151], v[150:151], v[6:7]
    v_pk_mul_f32 v[152:153], v[152:153], v[28:29]
    v_pk_mul_f32 v[154:155], v[154:155], v[30:31]
    v_pk_mul_f32 v[156:157], v[156:157], v[32:33]
    v_pk_mul_f32 v[158:159], v[158:159], v[34:35]
    v_cvt_pk_bf16_f32 v160, v144, v145
    v_cvt_pk_bf16_f32 v161, v146, v147
    v_cvt_pk_bf16_f32 v162, v148, v149
    v_cvt_pk_bf16_f32 v163, v150, v151
    v_cvt_pk_bf16_f32 v164, v152, v153
    v_cvt_pk_bf16_f32 v165, v154, v155
    v_cvt_pk_bf16_f32 v166, v156, v157
    v_cvt_pk_bf16_f32 v167, v158, v159
    v_pk_fma_f32 v[144:145], v[112:113], v[212:213], v[176:177] op_sel:[0,1,0] op_sel_hi:[1,1,1]
    v_pk_fma_f32 v[146:147], v[114:115], v[212:213], v[178:179] op_sel:[0,1,0] op_sel_hi:[1,1,1]
    v_pk_fma_f32 v[148:149], v[116:117], v[212:213], v[180:181] op_sel:[0,1,0] op_sel_hi:[1,1,1]
    v_pk_fma_f32 v[150:151], v[118:119], v[212:213], v[182:183] op_sel:[0,1,0] op_sel_hi:[1,1,1]
    v_pk_fma_f32 v[152:153], v[112:113], v[214:215], v[176:177] op_sel:[0,1,0] op_sel_hi:[1,1,1]
    v_pk_fma_f32 v[154:155], v[114:115], v[214:215], v[178:179] op_sel:[0,1,0] op_sel_hi:[1,1,1]
    v_pk_fma_f32 v[156:157], v[116:117], v[214:215], v[180:181] op_sel:[0,1,0] op_sel_hi:[1,1,1]
    v_pk_fma_f32 v[158:159], v[118:119], v[214:215], v[182:183] op_sel:[0,1,0] op_sel_hi:[1,1,1]
    v_pk_fma_f32 v[56:57], v[56:57], v[212:213], v[144:145] op_sel:[0,0,0] op_sel_hi:[1,0,1]
    v_pk_fma_f32 v[58:59], v[58:59], v[212:213], v[146:147] op_sel:[0,0,0] op_sel_hi:[1,0,1]
    v_pk_fma_f32 v[60:61], v[60:61], v[212:213], v[148:149] op_sel:[0,0,0] op_sel_hi:[1,0,1]
    v_pk_fma_f32 v[62:63], v[62:63], v[212:213], v[150:151] op_sel:[0,0,0] op_sel_hi:[1,0,1]
    v_pk_fma_f32 v[84:85], v[84:85], v[214:215], v[152:153] op_sel:[0,0,0] op_sel_hi:[1,0,1]
    v_pk_fma_f32 v[86:87], v[86:87], v[214:215], v[154:155] op_sel:[0,0,0] op_sel_hi:[1,0,1]
    v_pk_fma_f32 v[88:89], v[88:89], v[214:215], v[156:157] op_sel:[0,0,0] op_sel_hi:[1,0,1]
    v_pk_fma_f32 v[90:91], v[90:91], v[214:215], v[158:159] op_sel:[0,0,0] op_sel_hi:[1,0,1]
    v_pk_mul_f32 v[144:145], v[56:57], v[56:57]
    v_pk_mul_f32 v[146:147], v[58:59], v[58:59]
    v_pk_mul_f32 v[148:149], v[60:61], v[60:61]
    v_pk_mul_f32 v[150:151], v[62:63], v[62:63]
    v_pk_mul_f32 v[152:153], v[84:85], v[84:85]
    v_pk_mul_f32 v[154:155], v[86:87], v[86:87]
    v_pk_mul_f32 v[156:157], v[88:89], v[88:89]
    v_pk_mul_f32 v[158:159], v[90:91], v[90:91]
    v_pk_fma_f32 v[144:145], v[144:145], v[228:229], v[228:229] op_sel:[0,1,0] op_sel_hi:[1,1,0]
    v_pk_fma_f32 v[146:147], v[146:147], v[228:229], v[228:229] op_sel:[0,1,0] op_sel_hi:[1,1,0]
    v_pk_fma_f32 v[148:149], v[148:149], v[228:229], v[228:229] op_sel:[0,1,0] op_sel_hi:[1,1,0]
    v_pk_fma_f32 v[150:151], v[150:151], v[228:229], v[228:229] op_sel:[0,1,0] op_sel_hi:[1,1,0]
    v_pk_fma_f32 v[152:153], v[152:153], v[228:229], v[228:229] op_sel:[0,1,0] op_sel_hi:[1,1,0]
    v_pk_fma_f32 v[154:155], v[154:155], v[228:229], v[228:229] op_sel:[0,1,0] op_sel_hi:[1,1,0]
    v_pk_fma_f32 v[156:157], v[156:157], v[228:229], v[228:229] op_sel:[0,1,0] op_sel_hi:[1,1,0]
    v_pk_fma_f32 v[158:159], v[158:159], v[228:229], v[228:229] op_sel:[0,1,0] op_sel_hi:[1,1,0]
    v_pk_mul_f32 v[144:145], v[144:145], v[56:57]
    v_pk_mul_f32 v[146:147], v[146:147], v[58:59]
    v_pk_mul_f32 v[148:149], v[148:149], v[60:61]
    v_pk_mul_f32 v[150:151], v[150:151], v[62:63]
    v_pk_mul_f32 v[152:153], v[152:153], v[84:85]
    v_pk_mul_f32 v[154:155], v[154:155], v[86:87]
    v_pk_mul_f32 v[156:157], v[156:157], v[88:89]
    v_pk_mul_f32 v[158:159], v[158:159], v[90:91]
    v_exp_f32 v144, v144
    v_exp_f32 v145, v145
    ds_write_b128 v226, v[160:163] offset:0
    v_exp_f32 v146, v146
    v_exp_f32 v147, v147
    v_exp_f32 v148, v148
    v_exp_f32 v149, v149
    ds_write_b128 v226, v[164:167] offset:1024
    v_exp_f32 v150, v150
    v_exp_f32 v151, v151
    v_exp_f32 v152, v152
    v_exp_f32 v153, v153
    v_exp_f32 v154, v154
    v_exp_f32 v155, v155
    v_exp_f32 v156, v156
    v_exp_f32 v157, v157
    v_exp_f32 v158, v158
    v_exp_f32 v159, v159
    v_pk_add_f32 v[144:145], v[144:145], 1.0 op_sel_hi:[1,0]
    v_pk_add_f32 v[146:147], v[146:147], 1.0 op_sel_hi:[1,0]
    v_pk_add_f32 v[148:149], v[148:149], 1.0 op_sel_hi:[1,0]
    v_pk_add_f32 v[150:151], v[150:151], 1.0 op_sel_hi:[1,0]
    v_pk_add_f32 v[152:153], v[152:153], 1.0 op_sel_hi:[1,0]
    v_pk_add_f32 v[154:155], v[154:155], 1.0 op_sel_hi:[1,0]
    v_pk_add_f32 v[156:157], v[156:157], 1.0 op_sel_hi:[1,0]
    v_pk_add_f32 v[158:159], v[158:159], 1.0 op_sel_hi:[1,0]
    v_rcp_f32 v144, v144
    v_rcp_f32 v145, v145
    v_rcp_f32 v146, v146
    v_rcp_f32 v147, v147
    v_rcp_f32 v148, v148
    v_rcp_f32 v149, v149
    v_rcp_f32 v150, v150
    v_rcp_f32 v151, v151
    v_rcp_f32 v152, v152
    v_rcp_f32 v153, v153
    v_rcp_f32 v154, v154
    v_rcp_f32 v155, v155
    v_rcp_f32 v156, v156
    v_rcp_f32 v157, v157
    v_rcp_f32 v158, v158
    v_rcp_f32 v159, v159
    v_pk_mul_f32 v[144:145], v[144:145], v[56:57]
    v_pk_mul_f32 v[146:147], v[146:147], v[58:59]
    v_pk_mul_f32 v[148:149], v[148:149], v[60:61]
    v_pk_mul_f32 v[150:151], v[150:151], v[62:63]
    v_pk_mul_f32 v[152:153], v[152:153], v[84:85]
    v_pk_mul_f32 v[154:155], v[154:155], v[86:87]
    v_pk_mul_f32 v[156:157], v[156:157], v[88:89]
    v_pk_mul_f32 v[158:159], v[158:159], v[90:91]
    v_cvt_pk_bf16_f32 v168, v144, v145
    v_cvt_pk_bf16_f32 v169, v146, v147
    v_cvt_pk_bf16_f32 v170, v148, v149
    v_cvt_pk_bf16_f32 v171, v150, v151
    v_cvt_pk_bf16_f32 v172, v152, v153
    v_cvt_pk_bf16_f32 v173, v154, v155
    v_cvt_pk_bf16_f32 v174, v156, v157
    v_cvt_pk_bf16_f32 v175, v158, v159
    v_pk_fma_f32 v[144:145], v[120:121], v[208:209], v[184:185] op_sel:[0,1,0] op_sel_hi:[1,1,1]
    v_pk_fma_f32 v[146:147], v[122:123], v[208:209], v[186:187] op_sel:[0,1,0] op_sel_hi:[1,1,1]
    v_pk_fma_f32 v[148:149], v[124:125], v[208:209], v[188:189] op_sel:[0,1,0] op_sel_hi:[1,1,1]
    v_pk_fma_f32 v[150:151], v[126:127], v[208:209], v[190:191] op_sel:[0,1,0] op_sel_hi:[1,1,1]
    v_pk_fma_f32 v[152:153], v[120:121], v[210:211], v[184:185] op_sel:[0,1,0] op_sel_hi:[1,1,1]
    v_pk_fma_f32 v[154:155], v[122:123], v[210:211], v[186:187] op_sel:[0,1,0] op_sel_hi:[1,1,1]
    v_pk_fma_f32 v[156:157], v[124:125], v[210:211], v[188:189] op_sel:[0,1,0] op_sel_hi:[1,1,1]
    v_pk_fma_f32 v[158:159], v[126:127], v[210:211], v[190:191] op_sel:[0,1,0] op_sel_hi:[1,1,1]
    v_pk_fma_f32 v[8:9], v[8:9], v[208:209], v[144:145] op_sel:[0,0,0] op_sel_hi:[1,0,1]
    v_pk_fma_f32 v[10:11], v[10:11], v[208:209], v[146:147] op_sel:[0,0,0] op_sel_hi:[1,0,1]
    v_pk_fma_f32 v[12:13], v[12:13], v[208:209], v[148:149] op_sel:[0,0,0] op_sel_hi:[1,0,1]
    v_pk_fma_f32 v[14:15], v[14:15], v[208:209], v[150:151] op_sel:[0,0,0] op_sel_hi:[1,0,1]
    v_pk_fma_f32 v[36:37], v[36:37], v[210:211], v[152:153] op_sel:[0,0,0] op_sel_hi:[1,0,1]
    v_pk_fma_f32 v[38:39], v[38:39], v[210:211], v[154:155] op_sel:[0,0,0] op_sel_hi:[1,0,1]
    v_pk_fma_f32 v[40:41], v[40:41], v[210:211], v[156:157] op_sel:[0,0,0] op_sel_hi:[1,0,1]
    v_pk_fma_f32 v[42:43], v[42:43], v[210:211], v[158:159] op_sel:[0,0,0] op_sel_hi:[1,0,1]
    v_pk_mul_f32 v[144:145], v[8:9], v[8:9]
    v_pk_mul_f32 v[146:147], v[10:11], v[10:11]
    v_pk_mul_f32 v[148:149], v[12:13], v[12:13]
    v_pk_mul_f32 v[150:151], v[14:15], v[14:15]
    v_pk_mul_f32 v[152:153], v[36:37], v[36:37]
    v_pk_mul_f32 v[154:155], v[38:39], v[38:39]
    v_pk_mul_f32 v[156:157], v[40:41], v[40:41]
    v_pk_mul_f32 v[158:159], v[42:43], v[42:43]
    v_pk_fma_f32 v[144:145], v[144:145], v[228:229], v[228:229] op_sel:[0,1,0] op_sel_hi:[1,1,0]
    v_pk_fma_f32 v[146:147], v[146:147], v[228:229], v[228:229] op_sel:[0,1,0] op_sel_hi:[1,1,0]
    v_pk_fma_f32 v[148:149], v[148:149], v[228:229], v[228:229] op_sel:[0,1,0] op_sel_hi:[1,1,0]
    v_pk_fma_f32 v[150:151], v[150:151], v[228:229], v[228:229] op_sel:[0,1,0] op_sel_hi:[1,1,0]
    v_pk_fma_f32 v[152:153], v[152:153], v[228:229], v[228:229] op_sel:[0,1,0] op_sel_hi:[1,1,0]
    v_pk_fma_f32 v[154:155], v[154:155], v[228:229], v[228:229] op_sel:[0,1,0] op_sel_hi:[1,1,0]
    v_pk_fma_f32 v[156:157], v[156:157], v[228:229], v[228:229] op_sel:[0,1,0] op_sel_hi:[1,1,0]
    v_pk_fma_f32 v[158:159], v[158:159], v[228:229], v[228:229] op_sel:[0,1,0] op_sel_hi:[1,1,0]
    v_pk_mul_f32 v[144:145], v[144:145], v[8:9]
    v_pk_mul_f32 v[146:147], v[146:147], v[10:11]
    v_pk_mul_f32 v[148:149], v[148:149], v[12:13]
    v_pk_mul_f32 v[150:151], v[150:151], v[14:15]
    v_pk_mul_f32 v[152:153], v[152:153], v[36:37]
    v_pk_mul_f32 v[154:155], v[154:155], v[38:39]
    v_pk_mul_f32 v[156:157], v[156:157], v[40:41]
    v_pk_mul_f32 v[158:159], v[158:159], v[42:43]
    v_exp_f32 v144, v144
    v_exp_f32 v145, v145
    ds_write_b128 v226, v[168:171] offset:2048
    v_exp_f32 v146, v146
    v_exp_f32 v147, v147
    v_exp_f32 v148, v148
    v_exp_f32 v149, v149
    ds_write_b128 v226, v[172:175] offset:3072
    v_exp_f32 v150, v150
    v_exp_f32 v151, v151
    v_exp_f32 v152, v152
    v_exp_f32 v153, v153
    v_exp_f32 v154, v154
    v_exp_f32 v155, v155
    v_exp_f32 v156, v156
    v_exp_f32 v157, v157
    v_exp_f32 v158, v158
    v_exp_f32 v159, v159
    v_pk_add_f32 v[144:145], v[144:145], 1.0 op_sel_hi:[1,0]
    v_pk_add_f32 v[146:147], v[146:147], 1.0 op_sel_hi:[1,0]
    v_pk_add_f32 v[148:149], v[148:149], 1.0 op_sel_hi:[1,0]
    v_pk_add_f32 v[150:151], v[150:151], 1.0 op_sel_hi:[1,0]
    v_pk_add_f32 v[152:153], v[152:153], 1.0 op_sel_hi:[1,0]
    v_pk_add_f32 v[154:155], v[154:155], 1.0 op_sel_hi:[1,0]
    v_pk_add_f32 v[156:157], v[156:157], 1.0 op_sel_hi:[1,0]
    v_pk_add_f32 v[158:159], v[158:159], 1.0 op_sel_hi:[1,0]
    v_rcp_f32 v144, v144
    v_rcp_f32 v145, v145
    v_rcp_f32 v146, v146
    v_rcp_f32 v147, v147
    v_rcp_f32 v148, v148
    v_rcp_f32 v149, v149
    v_rcp_f32 v150, v150
    v_rcp_f32 v151, v151
    v_rcp_f32 v152, v152
    v_rcp_f32 v153, v153
    v_rcp_f32 v154, v154
    v_rcp_f32 v155, v155
    v_rcp_f32 v156, v156
    v_rcp_f32 v157, v157
    s_waitcnt lgkmcnt(0)
    s_barrier
    v_rcp_f32 v158, v158
    v_rcp_f32 v159, v159
    v_pk_mul_f32 v[144:145], v[144:145], v[8:9]
    v_pk_mul_f32 v[146:147], v[146:147], v[10:11]
    v_pk_mul_f32 v[148:149], v[148:149], v[12:13]
    v_pk_mul_f32 v[150:151], v[150:151], v[14:15]
    v_pk_mul_f32 v[152:153], v[152:153], v[36:37]
    v_pk_mul_f32 v[154:155], v[154:155], v[38:39]
    v_pk_mul_f32 v[156:157], v[156:157], v[40:41]
    v_pk_mul_f32 v[158:159], v[158:159], v[42:43]
    v_cvt_pk_bf16_f32 v160, v144, v145
    v_cvt_pk_bf16_f32 v161, v146, v147
    v_cvt_pk_bf16_f32 v162, v148, v149
    v_cvt_pk_bf16_f32 v163, v150, v151
    v_cvt_pk_bf16_f32 v164, v152, v153
    v_cvt_pk_bf16_f32 v165, v154, v155
    v_cvt_pk_bf16_f32 v166, v156, v157
    v_cvt_pk_bf16_f32 v167, v158, v159
    v_pk_fma_f32 v[144:145], v[120:121], v[212:213], v[184:185] op_sel:[0,1,0] op_sel_hi:[1,1,1]
    v_pk_fma_f32 v[146:147], v[122:123], v[212:213], v[186:187] op_sel:[0,1,0] op_sel_hi:[1,1,1]
    v_pk_fma_f32 v[148:149], v[124:125], v[212:213], v[188:189] op_sel:[0,1,0] op_sel_hi:[1,1,1]
    v_pk_fma_f32 v[150:151], v[126:127], v[212:213], v[190:191] op_sel:[0,1,0] op_sel_hi:[1,1,1]
    v_pk_fma_f32 v[152:153], v[120:121], v[214:215], v[184:185] op_sel:[0,1,0] op_sel_hi:[1,1,1]
    v_pk_fma_f32 v[154:155], v[122:123], v[214:215], v[186:187] op_sel:[0,1,0] op_sel_hi:[1,1,1]
    v_pk_fma_f32 v[156:157], v[124:125], v[214:215], v[188:189] op_sel:[0,1,0] op_sel_hi:[1,1,1]
    v_pk_fma_f32 v[158:159], v[126:127], v[214:215], v[190:191] op_sel:[0,1,0] op_sel_hi:[1,1,1]
    v_pk_fma_f32 v[64:65], v[64:65], v[212:213], v[144:145] op_sel:[0,0,0] op_sel_hi:[1,0,1]
    v_pk_fma_f32 v[66:67], v[66:67], v[212:213], v[146:147] op_sel:[0,0,0] op_sel_hi:[1,0,1]
    v_pk_fma_f32 v[68:69], v[68:69], v[212:213], v[148:149] op_sel:[0,0,0] op_sel_hi:[1,0,1]
    v_pk_fma_f32 v[70:71], v[70:71], v[212:213], v[150:151] op_sel:[0,0,0] op_sel_hi:[1,0,1]
    v_pk_fma_f32 v[92:93], v[92:93], v[214:215], v[152:153] op_sel:[0,0,0] op_sel_hi:[1,0,1]
    v_pk_fma_f32 v[94:95], v[94:95], v[214:215], v[154:155] op_sel:[0,0,0] op_sel_hi:[1,0,1]
    v_pk_fma_f32 v[96:97], v[96:97], v[214:215], v[156:157] op_sel:[0,0,0] op_sel_hi:[1,0,1]
    v_pk_fma_f32 v[98:99], v[98:99], v[214:215], v[158:159] op_sel:[0,0,0] op_sel_hi:[1,0,1]
    v_pk_mul_f32 v[144:145], v[64:65], v[64:65]
    v_pk_mul_f32 v[146:147], v[66:67], v[66:67]
    v_pk_mul_f32 v[148:149], v[68:69], v[68:69]
    v_pk_mul_f32 v[150:151], v[70:71], v[70:71]
    v_pk_mul_f32 v[152:153], v[92:93], v[92:93]
    v_pk_mul_f32 v[154:155], v[94:95], v[94:95]
    v_pk_mul_f32 v[156:157], v[96:97], v[96:97]
    v_pk_mul_f32 v[158:159], v[98:99], v[98:99]
    v_pk_fma_f32 v[144:145], v[144:145], v[228:229], v[228:229] op_sel:[0,1,0] op_sel_hi:[1,1,0]
    v_pk_fma_f32 v[146:147], v[146:147], v[228:229], v[228:229] op_sel:[0,1,0] op_sel_hi:[1,1,0]
    v_pk_fma_f32 v[148:149], v[148:149], v[228:229], v[228:229] op_sel:[0,1,0] op_sel_hi:[1,1,0]
    v_pk_fma_f32 v[150:151], v[150:151], v[228:229], v[228:229] op_sel:[0,1,0] op_sel_hi:[1,1,0]
    v_pk_fma_f32 v[152:153], v[152:153], v[228:229], v[228:229] op_sel:[0,1,0] op_sel_hi:[1,1,0]
    v_pk_fma_f32 v[154:155], v[154:155], v[228:229], v[228:229] op_sel:[0,1,0] op_sel_hi:[1,1,0]
    v_pk_fma_f32 v[156:157], v[156:157], v[228:229], v[228:229] op_sel:[0,1,0] op_sel_hi:[1,1,0]
    v_pk_fma_f32 v[158:159], v[158:159], v[228:229], v[228:229] op_sel:[0,1,0] op_sel_hi:[1,1,0]
    v_pk_mul_f32 v[144:145], v[144:145], v[64:65]
    v_pk_mul_f32 v[146:147], v[146:147], v[66:67]
    v_pk_mul_f32 v[148:149], v[148:149], v[68:69]
    v_pk_mul_f32 v[150:151], v[150:151], v[70:71]
    v_pk_mul_f32 v[152:153], v[152:153], v[92:93]
    v_pk_mul_f32 v[154:155], v[154:155], v[94:95]
    v_pk_mul_f32 v[156:157], v[156:157], v[96:97]
    v_pk_mul_f32 v[158:159], v[158:159], v[98:99]
    v_exp_f32 v144, v144
    v_exp_f32 v145, v145
    ds_write_b128 v226, v[160:163] offset:8192
    v_exp_f32 v146, v146
    v_exp_f32 v147, v147
    v_exp_f32 v148, v148
    v_exp_f32 v149, v149
    ds_write_b128 v226, v[164:167] offset:9216
    v_exp_f32 v150, v150
    v_exp_f32 v151, v151
    v_exp_f32 v152, v152
    v_exp_f32 v153, v153
    v_exp_f32 v154, v154
    v_exp_f32 v155, v155
    v_exp_f32 v156, v156
    v_exp_f32 v157, v157
    v_exp_f32 v158, v158
    v_exp_f32 v159, v159
    v_pk_add_f32 v[144:145], v[144:145], 1.0 op_sel_hi:[1,0]
    v_pk_add_f32 v[146:147], v[146:147], 1.0 op_sel_hi:[1,0]
    v_pk_add_f32 v[148:149], v[148:149], 1.0 op_sel_hi:[1,0]
    v_pk_add_f32 v[150:151], v[150:151], 1.0 op_sel_hi:[1,0]
    v_pk_add_f32 v[152:153], v[152:153], 1.0 op_sel_hi:[1,0]
    v_pk_add_f32 v[154:155], v[154:155], 1.0 op_sel_hi:[1,0]
    v_pk_add_f32 v[156:157], v[156:157], 1.0 op_sel_hi:[1,0]
    v_pk_add_f32 v[158:159], v[158:159], 1.0 op_sel_hi:[1,0]
    v_rcp_f32 v144, v144
    v_rcp_f32 v145, v145
    v_rcp_f32 v146, v146
    v_rcp_f32 v147, v147
    v_rcp_f32 v148, v148
    v_rcp_f32 v149, v149
    v_rcp_f32 v150, v150
    v_rcp_f32 v151, v151
    v_rcp_f32 v152, v152
    v_rcp_f32 v153, v153
    v_rcp_f32 v154, v154
    v_rcp_f32 v155, v155
    v_rcp_f32 v156, v156
    v_rcp_f32 v157, v157
    v_rcp_f32 v158, v158
    v_rcp_f32 v159, v159
    v_pk_mul_f32 v[144:145], v[144:145], v[64:65]
    v_pk_mul_f32 v[146:147], v[146:147], v[66:67]
    v_pk_mul_f32 v[148:149], v[148:149], v[68:69]
    v_pk_mul_f32 v[150:151], v[150:151], v[70:71]
    v_pk_mul_f32 v[152:153], v[152:153], v[92:93]
    v_pk_mul_f32 v[154:155], v[154:155], v[94:95]
    v_pk_mul_f32 v[156:157], v[156:157], v[96:97]
    v_pk_mul_f32 v[158:159], v[158:159], v[98:99]
    v_cvt_pk_bf16_f32 v168, v144, v145
    v_cvt_pk_bf16_f32 v169, v146, v147
    v_cvt_pk_bf16_f32 v170, v148, v149
    v_cvt_pk_bf16_f32 v171, v150, v151
    v_cvt_pk_bf16_f32 v172, v152, v153
    v_cvt_pk_bf16_f32 v173, v154, v155
    v_cvt_pk_bf16_f32 v174, v156, v157
    v_cvt_pk_bf16_f32 v175, v158, v159
    v_pk_fma_f32 v[144:145], v[128:129], v[208:209], v[192:193] op_sel:[0,1,0] op_sel_hi:[1,1,1]
    v_pk_fma_f32 v[146:147], v[130:131], v[208:209], v[194:195] op_sel:[0,1,0] op_sel_hi:[1,1,1]
    v_pk_fma_f32 v[148:149], v[132:133], v[208:209], v[196:197] op_sel:[0,1,0] op_sel_hi:[1,1,1]
    v_pk_fma_f32 v[150:151], v[134:135], v[208:209], v[198:199] op_sel:[0,1,0] op_sel_hi:[1,1,1]
    v_pk_fma_f32 v[152:153], v[128:129], v[210:211], v[192:193] op_sel:[0,1,0] op_sel_hi:[1,1,1]
    v_pk_fma_f32 v[154:155], v[130:131], v[210:211], v[194:195] op_sel:[0,1,0] op_sel_hi:[1,1,1]
    v_pk_fma_f32 v[156:157], v[132:133], v[210:211], v[196:197] op_sel:[0,1,0] op_sel_hi:[1,1,1]
    v_pk_fma_f32 v[158:159], v[134:135], v[210:211], v[198:199] op_sel:[0,1,0] op_sel_hi:[1,1,1]
    v_pk_fma_f32 v[16:17], v[16:17], v[208:209], v[144:145] op_sel:[0,0,0] op_sel_hi:[1,0,1]
    v_pk_fma_f32 v[18:19], v[18:19], v[208:209], v[146:147] op_sel:[0,0,0] op_sel_hi:[1,0,1]
    v_pk_fma_f32 v[20:21], v[20:21], v[208:209], v[148:149] op_sel:[0,0,0] op_sel_hi:[1,0,1]
    v_pk_fma_f32 v[22:23], v[22:23], v[208:209], v[150:151] op_sel:[0,0,0] op_sel_hi:[1,0,1]
    v_pk_fma_f32 v[44:45], v[44:45], v[210:211], v[152:153] op_sel:[0,0,0] op_sel_hi:[1,0,1]
    v_pk_fma_f32 v[46:47], v[46:47], v[210:211], v[154:155] op_sel:[0,0,0] op_sel_hi:[1,0,1]
    v_pk_fma_f32 v[48:49], v[48:49], v[210:211], v[156:157] op_sel:[0,0,0] op_sel_hi:[1,0,1]
    v_pk_fma_f32 v[50:51], v[50:51], v[210:211], v[158:159] op_sel:[0,0,0] op_sel_hi:[1,0,1]
    v_pk_mul_f32 v[144:145], v[16:17], v[16:17]
    v_pk_mul_f32 v[146:147], v[18:19], v[18:19]
    v_pk_mul_f32 v[148:149], v[20:21], v[20:21]
    v_pk_mul_f32 v[150:151], v[22:23], v[22:23]
    v_pk_mul_f32 v[152:153], v[44:45], v[44:45]
    v_pk_mul_f32 v[154:155], v[46:47], v[46:47]
    v_pk_mul_f32 v[156:157], v[48:49], v[48:49]
    v_pk_mul_f32 v[158:159], v[50:51], v[50:51]
    v_pk_fma_f32 v[144:145], v[144:145], v[228:229], v[228:229] op_sel:[0,1,0] op_sel_hi:[1,1,0]
    v_pk_fma_f32 v[146:147], v[146:147], v[228:229], v[228:229] op_sel:[0,1,0] op_sel_hi:[1,1,0]
    v_pk_fma_f32 v[148:149], v[148:149], v[228:229], v[228:229] op_sel:[0,1,0] op_sel_hi:[1,1,0]
    v_pk_fma_f32 v[150:151], v[150:151], v[228:229], v[228:229] op_sel:[0,1,0] op_sel_hi:[1,1,0]
    v_pk_fma_f32 v[152:153], v[152:153], v[228:229], v[228:229] op_sel:[0,1,0] op_sel_hi:[1,1,0]
    v_pk_fma_f32 v[154:155], v[154:155], v[228:229], v[228:229] op_sel:[0,1,0] op_sel_hi:[1,1,0]
    v_pk_fma_f32 v[156:157], v[156:157], v[228:229], v[228:229] op_sel:[0,1,0] op_sel_hi:[1,1,0]
    v_pk_fma_f32 v[158:159], v[158:159], v[228:229], v[228:229] op_sel:[0,1,0] op_sel_hi:[1,1,0]
    v_pk_mul_f32 v[144:145], v[144:145], v[16:17]
    v_pk_mul_f32 v[146:147], v[146:147], v[18:19]
    v_pk_mul_f32 v[148:149], v[148:149], v[20:21]
    v_pk_mul_f32 v[150:151], v[150:151], v[22:23]
    v_pk_mul_f32 v[152:153], v[152:153], v[44:45]
    v_pk_mul_f32 v[154:155], v[154:155], v[46:47]
    v_pk_mul_f32 v[156:157], v[156:157], v[48:49]
    v_pk_mul_f32 v[158:159], v[158:159], v[50:51]
    v_exp_f32 v144, v144
    v_exp_f32 v145, v145
    ds_write_b128 v226, v[168:171] offset:10240
    v_exp_f32 v146, v146
    v_exp_f32 v147, v147
    v_exp_f32 v148, v148
    v_exp_f32 v149, v149
    ds_write_b128 v226, v[172:175] offset:11264
    v_exp_f32 v150, v150
    v_exp_f32 v151, v151
    v_exp_f32 v152, v152
    v_exp_f32 v153, v153
    v_exp_f32 v154, v154
    v_exp_f32 v155, v155
    v_exp_f32 v156, v156
    v_exp_f32 v157, v157
    v_exp_f32 v158, v158
    v_exp_f32 v159, v159
    v_pk_add_f32 v[144:145], v[144:145], 1.0 op_sel_hi:[1,0]
L_wp3:
    s_cbranch_vccnz L_wp7
    s_nop 0
    v_pk_add_f32 v[146:147], v[146:147], 1.0 op_sel_hi:[1,0]
    v_pk_add_f32 v[148:149], v[148:149], 1.0 op_sel_hi:[1,0]
    v_pk_add_f32 v[150:151], v[150:151], 1.0 op_sel_hi:[1,0]
    v_pk_add_f32 v[152:153], v[152:153], 1.0 op_sel_hi:[1,0]
    v_pk_add_f32 v[154:155], v[154:155], 1.0 op_sel_hi:[1,0]
    v_pk_add_f32 v[156:157], v[156:157], 1.0 op_sel_hi:[1,0]
    v_pk_add_f32 v[158:159], v[158:159], 1.0 op_sel_hi:[1,0]
    v_rcp_f32 v144, v144
    v_rcp_f32 v145, v145
    v_rcp_f32 v146, v146
    v_rcp_f32 v147, v147
    v_rcp_f32 v148, v148
    v_rcp_f32 v149, v149
    v_rcp_f32 v150, v150
    v_rcp_f32 v151, v151
    v_rcp_f32 v152, v152
    v_rcp_f32 v153, v153
    v_rcp_f32 v154, v154
    v_rcp_f32 v155, v155
    v_rcp_f32 v156, v156
    v_rcp_f32 v157, v157
    s_waitcnt lgkmcnt(0)
    s_barrier
    v_rcp_f32 v158, v158
    v_rcp_f32 v159, v159
    v_pk_mul_f32 v[144:145], v[144:145], v[16:17]
    v_pk_mul_f32 v[146:147], v[146:147], v[18:19]
    v_pk_mul_f32 v[148:149], v[148:149], v[20:21]
    v_pk_mul_f32 v[150:151], v[150:151], v[22:23]
    v_pk_mul_f32 v[152:153], v[152:153], v[44:45]
    v_pk_mul_f32 v[154:155], v[154:155], v[46:47]
    v_pk_mul_f32 v[156:157], v[156:157], v[48:49]
    v_pk_mul_f32 v[158:159], v[158:159], v[50:51]
    v_cvt_pk_bf16_f32 v160, v144, v145
    v_cvt_pk_bf16_f32 v161, v146, v147
    v_cvt_pk_bf16_f32 v162, v148, v149
    v_cvt_pk_bf16_f32 v163, v150, v151
    v_cvt_pk_bf16_f32 v164, v152, v153
    v_cvt_pk_bf16_f32 v165, v154, v155
    v_cvt_pk_bf16_f32 v166, v156, v157
    v_cvt_pk_bf16_f32 v167, v158, v159
    v_pk_fma_f32 v[144:145], v[128:129], v[212:213], v[192:193] op_sel:[0,1,0] op_sel_hi:[1,1,1]
    v_pk_fma_f32 v[146:147], v[130:131], v[212:213], v[194:195] op_sel:[0,1,0] op_sel_hi:[1,1,1]
    v_pk_fma_f32 v[148:149], v[132:133], v[212:213], v[196:197] op_sel:[0,1,0] op_sel_hi:[1,1,1]
    v_pk_fma_f32 v[150:151], v[134:135], v[212:213], v[198:199] op_sel:[0,1,0] op_sel_hi:[1,1,1]
    v_pk_fma_f32 v[152:153], v[128:129], v[214:215], v[192:193] op_sel:[0,1,0] op_sel_hi:[1,1,1]
    v_pk_fma_f32 v[154:155], v[130:131], v[214:215], v[194:195] op_sel:[0,1,0] op_sel_hi:[1,1,1]
    v_pk_fma_f32 v[156:157], v[132:133], v[214:215], v[196:197] op_sel:[0,1,0] op_sel_hi:[1,1,1]
    v_pk_fma_f32 v[158:159], v[134:135], v[214:215], v[198:199] op_sel:[0,1,0] op_sel_hi:[1,1,1]
    v_pk_fma_f32 v[72:73], v[72:73], v[212:213], v[144:145] op_sel:[0,0,0] op_sel_hi:[1,0,1]
    v_pk_fma_f32 v[74:75], v[74:75], v[212:213], v[146:147] op_sel:[0,0,0] op_sel_hi:[1,0,1]
    v_pk_fma_f32 v[76:77], v[76:77], v[212:213], v[148:149] op_sel:[0,0,0] op_sel_hi:[1,0,1]
    v_pk_fma_f32 v[78:79], v[78:79], v[212:213], v[150:151] op_sel:[0,0,0] op_sel_hi:[1,0,1]
    v_pk_fma_f32 v[100:101], v[100:101], v[214:215], v[152:153] op_sel:[0,0,0] op_sel_hi:[1,0,1]
    v_pk_fma_f32 v[102:103], v[102:103], v[214:215], v[154:155] op_sel:[0,0,0] op_sel_hi:[1,0,1]
    v_pk_fma_f32 v[104:105], v[104:105], v[214:215], v[156:157] op_sel:[0,0,0] op_sel_hi:[1,0,1]
    v_pk_fma_f32 v[106:107], v[106:107], v[214:215], v[158:159] op_sel:[0,0,0] op_sel_hi:[1,0,1]
    v_pk_mul_f32 v[144:145], v[72:73], v[72:73]
    v_pk_mul_f32 v[146:147], v[74:75], v[74:75]
    v_pk_mul_f32 v[148:149], v[76:77], v[76:77]
    v_pk_mul_f32 v[150:151], v[78:79], v[78:79]
    v_pk_mul_f32 v[152:153], v[100:101], v[100:101]
    v_pk_mul_f32 v[154:155], v[102:103], v[102:103]
    v_pk_mul_f32 v[156:157], v[104:105], v[104:105]
    v_pk_mul_f32 v[158:159], v[106:107], v[106:107]
    v_pk_fma_f32 v[144:145], v[144:145], v[228:229], v[228:229] op_sel:[0,1,0] op_sel_hi:[1,1,0]
    v_pk_fma_f32 v[146:147], v[146:147], v[228:229], v[228:229] op_sel:[0,1,0] op_sel_hi:[1,1,0]
    v_pk_fma_f32 v[148:149], v[148:149], v[228:229], v[228:229] op_sel:[0,1,0] op_sel_hi:[1,1,0]
    v_pk_fma_f32 v[150:151], v[150:151], v[228:229], v[228:229] op_sel:[0,1,0] op_sel_hi:[1,1,0]
    v_pk_fma_f32 v[152:153], v[152:153], v[228:229], v[228:229] op_sel:[0,1,0] op_sel_hi:[1,1,0]
    v_pk_fma_f32 v[154:155], v[154:155], v[228:229], v[228:229] op_sel:[0,1,0] op_sel_hi:[1,1,0]
    v_pk_fma_f32 v[156:157], v[156:157], v[228:229], v[228:229] op_sel:[0,1,0] op_sel_hi:[1,1,0]
    v_pk_fma_f32 v[158:159], v[158:159], v[228:229], v[228:229] op_sel:[0,1,0] op_sel_hi:[1,1,0]
    v_pk_mul_f32 v[144:145], v[144:145], v[72:73]
    v_pk_mul_f32 v[146:147], v[146:147], v[74:75]
    v_pk_mul_f32 v[148:149], v[148:149], v[76:77]
    v_pk_mul_f32 v[150:151], v[150:151], v[78:79]
    v_pk_mul_f32 v[152:153], v[152:153], v[100:101]
    v_pk_mul_f32 v[154:155], v[154:155], v[102:103]
    v_pk_mul_f32 v[156:157], v[156:157], v[104:105]
    v_pk_mul_f32 v[158:159], v[158:159], v[106:107]
    v_exp_f32 v144, v144
    v_exp_f32 v145, v145
    ds_write_b128 v226, v[160:163] offset:16384
    v_exp_f32 v146, v146
    v_exp_f32 v147, v147
    v_exp_f32 v148, v148
    v_exp_f32 v149, v149
    ds_write_b128 v226, v[164:167] offset:17408
    v_exp_f32 v150, v150
    v_exp_f32 v151, v151
    v_exp_f32 v152, v152
    v_exp_f32 v153, v153
    v_exp_f32 v154, v154
    v_exp_f32 v155, v155
    v_exp_f32 v156, v156
    v_exp_f32 v157, v157
    v_exp_f32 v158, v158
    v_exp_f32 v159, v159
    v_pk_add_f32 v[144:145], v[144:145], 1.0 op_sel_hi:[1,0]
    v_pk_add_f32 v[146:147], v[146:147], 1.0 op_sel_hi:[1,0]
    v_pk_add_f32 v[148:149], v[148:149], 1.0 op_sel_hi:[1,0]
    v_pk_add_f32 v[150:151], v[150:151], 1.0 op_sel_hi:[1,0]
    v_pk_add_f32 v[152:153], v[152:153], 1.0 op_sel_hi:[1,0]
    v_pk_add_f32 v[154:155], v[154:155], 1.0 op_sel_hi:[1,0]
    v_pk_add_f32 v[156:157], v[156:157], 1.0 op_sel_hi:[1,0]
    v_pk_add_f32 v[158:159], v[158:159], 1.0 op_sel_hi:[1,0]
    v_rcp_f32 v144, v144
    v_rcp_f32 v145, v145
    v_rcp_f32 v146, v146
    v_rcp_f32 v147, v147
    v_rcp_f32 v148, v148
    v_rcp_f32 v149, v149
    v_rcp_f32 v150, v150
    v_rcp_f32 v151, v151
    v_rcp_f32 v152, v152
    v_rcp_f32 v153, v153
    v_rcp_f32 v154, v154
    v_rcp_f32 v155, v155
    v_rcp_f32 v156, v156
    v_rcp_f32 v157, v157
    v_rcp_f32 v158, v158
    v_rcp_f32 v159, v159
    v_pk_mul_f32 v[144:145], v[144:145], v[72:73]
    v_pk_mul_f32 v[146:147], v[146:147], v[74:75]
    v_pk_mul_f32 v[148:149], v[148:149], v[76:77]
    v_pk_mul_f32 v[150:151], v[150:151], v[78:79]
    v_pk_mul_f32 v[152:153], v[152:153], v[100:101]
    v_pk_mul_f32 v[154:155], v[154:155], v[102:103]
    v_pk_mul_f32 v[156:157], v[156:157], v[104:105]
    v_pk_mul_f32 v[158:159], v[158:159], v[106:107]
    v_cvt_pk_bf16_f32 v168, v144, v145
    v_cvt_pk_bf16_f32 v169, v146, v147
    v_cvt_pk_bf16_f32 v170, v148, v149
    v_cvt_pk_bf16_f32 v171, v150, v151
    v_cvt_pk_bf16_f32 v172, v152, v153
    v_cvt_pk_bf16_f32 v173, v154, v155
    v_cvt_pk_bf16_f32 v174, v156, v157
    v_cvt_pk_bf16_f32 v175, v158, v159
    v_pk_fma_f32 v[144:145], v[136:137], v[208:209], v[200:201] op_sel:[0,1,0] op_sel_hi:[1,1,1]
    v_pk_fma_f32 v[146:147], v[138:139], v[208:209], v[202:203] op_sel:[0,1,0] op_sel_hi:[1,1,1]
    v_pk_fma_f32 v[148:149], v[136:137], v[210:211], v[200:201] op_sel:[0,1,0] op_sel_hi:[1,1,1]
    v_pk_fma_f32 v[150:151], v[138:139], v[210:211], v[202:203] op_sel:[0,1,0] op_sel_hi:[1,1,1]
    v_pk_fma_f32 v[152:153], v[136:137], v[212:213], v[200:201] op_sel:[0,1,0] op_sel_hi:[1,1,1]
    v_pk_fma_f32 v[154:155], v[138:139], v[212:213], v[202:203] op_sel:[0,1,0] op_sel_hi:[1,1,1]
    v_pk_fma_f32 v[156:157], v[136:137], v[214:215], v[200:201] op_sel:[0,1,0] op_sel_hi:[1,1,1]
    v_pk_fma_f32 v[158:159], v[138:139], v[214:215], v[202:203] op_sel:[0,1,0] op_sel_hi:[1,1,1]
    v_pk_fma_f32 v[24:25], v[24:25], v[208:209], v[144:145] op_sel:[0,0,0] op_sel_hi:[1,0,1]
    v_pk_fma_f32 v[26:27], v[26:27], v[208:209], v[146:147] op_sel:[0,0,0] op_sel_hi:[1,0,1]
    v_pk_fma_f32 v[52:53], v[52:53], v[210:211], v[148:149] op_sel:[0,0,0] op_sel_hi:[1,0,1]
    v_pk_fma_f32 v[54:55], v[54:55], v[210:211], v[150:151] op_sel:[0,0,0] op_sel_hi:[1,0,1]
    v_pk_fma_f32 v[80:81], v[80:81], v[212:213], v[152:153] op_sel:[0,0,0] op_sel_hi:[1,0,1]
    v_pk_fma_f32 v[82:83], v[82:83], v[212:213], v[154:155] op_sel:[0,0,0] op_sel_hi:[1,0,1]
    v_pk_fma_f32 v[108:109], v[108:109], v[214:215], v[156:157] op_sel:[0,0,0] op_sel_hi:[1,0,1]
    v_pk_fma_f32 v[110:111], v[110:111], v[214:215], v[158:159] op_sel:[0,0,0] op_sel_hi:[1,0,1]
    v_pk_mul_f32 v[144:145], v[24:25], v[24:25]
    v_pk_mul_f32 v[146:147], v[26:27], v[26:27]
    v_pk_mul_f32 v[148:149], v[52:53], v[52:53]
    v_pk_mul_f32 v[150:151], v[54:55], v[54:55]
    v_pk_mul_f32 v[152:153], v[80:81], v[80:81]
    v_pk_mul_f32 v[154:155], v[82:83], v[82:83]
    v_pk_mul_f32 v[156:157], v[108:109], v[108:109]
    v_pk_mul_f32 v[158:159], v[110:111], v[110:111]
    v_pk_fma_f32 v[144:145], v[144:145], v[228:229], v[228:229] op_sel:[0,1,0] op_sel_hi:[1,1,0]
    v_pk_fma_f32 v[146:147], v[146:147], v[228:229], v[228:229] op_sel:[0,1,0] op_sel_hi:[1,1,0]
    v_pk_fma_f32 v[148:149], v[148:149], v[228:229], v[228:229] op_sel:[0,1,0] op_sel_hi:[1,1,0]
    v_pk_fma_f32 v[150:151], v[150:151], v[228:229], v[228:229] op_sel:[0,1,0] op_sel_hi:[1,1,0]
    v_pk_fma_f32 v[152:153], v[152:153], v[228:229], v[228:229] op_sel:[0,1,0] op_sel_hi:[1,1,0]
    v_pk_fma_f32 v[154:155], v[154:155], v[228:229], v[228:229] op_sel:[0,1,0] op_sel_hi:[1,1,0]
    v_pk_fma_f32 v[156:157], v[156:157], v[228:229], v[228:229] op_sel:[0,1,0] op_sel_hi:[1,1,0]
    v_pk_fma_f32 v[158:159], v[158:159], v[228:229], v[228:229] op_sel:[0,1,0] op_sel_hi:[1,1,0]
    v_pk_mul_f32 v[144:145], v[144:145], v[24:25]
    v_pk_mul_f32 v[146:147], v[146:147], v[26:27]
    v_pk_mul_f32 v[148:149], v[148:149], v[52:53]
    v_pk_mul_f32 v[150:151], v[150:151], v[54:55]
    v_pk_mul_f32 v[152:153], v[152:153], v[80:81]
    v_pk_mul_f32 v[154:155], v[154:155], v[82:83]
    v_pk_mul_f32 v[156:157], v[156:157], v[108:109]
    v_pk_mul_f32 v[158:159], v[158:159], v[110:111]
    v_exp_f32 v144, v144
    v_exp_f32 v145, v145
    ds_write_b128 v226, v[168:171] offset:18432
    v_exp_f32 v146, v146
    v_exp_f32 v147, v147
    v_exp_f32 v148, v148
    v_exp_f32 v149, v149
    ds_write_b128 v226, v[172:175] offset:19456
    v_exp_f32 v150, v150
    v_exp_f32 v151, v151
    v_exp_f32 v152, v152
    v_exp_f32 v153, v153
    v_exp_f32 v154, v154
    v_exp_f32 v155, v155
    v_exp_f32 v156, v156
    v_exp_f32 v157, v157
    v_exp_f32 v158, v158
    v_exp_f32 v159, v159
    v_pk_add_f32 v[144:145], v[144:145], 1.0 op_sel_hi:[1,0]
    v_pk_add_f32 v[146:147], v[146:147], 1.0 op_sel_hi:[1,0]
    v_pk_add_f32 v[148:149], v[148:149], 1.0 op_sel_hi:[1,0]
    v_pk_add_f32 v[150:151], v[150:151], 1.0 op_sel_hi:[1,0]
    v_pk_add_f32 v[152:153], v[152:153], 1.0 op_sel_hi:[1,0]
    v_pk_add_f32 v[154:155], v[154:155], 1.0 op_sel_hi:[1,0]
    v_pk_add_f32 v[156:157], v[156:157], 1.0 op_sel_hi:[1,0]
    v_pk_add_f32 v[158:159], v[158:159], 1.0 op_sel_hi:[1,0]
    v_rcp_f32 v144, v144
    v_rcp_f32 v145, v145
    s_waitcnt lgkmcnt(0)
    s_barrier
    v_rcp_f32_e64 v146, v146
    ds_read_b64_tr_b16 v[112:113], v234 offset:57344
    v_rcp_f32_e64 v147, v147
    ds_read_b64_tr_b16 v[114:115], v234 offset:61440
    v_rcp_f32_e64 v148, v148
    ds_read_b64_tr_b16 v[176:177], v240 offset:0
    v_rcp_f32_e64 v149, v149
    ds_read_b64_tr_b16 v[178:179], v240 offset:4096
    v_rcp_f32_e64 v150, v150
    ds_read_b128 v[64:67], v232 offset:0
    v_rcp_f32_e64 v151, v151
    ds_read_b128 v[84:87], v232 offset:32768
    v_rcp_f32_e64 v152, v152
    ds_read_b128 v[68:71], v232 offset:1024
    v_rcp_f32_e64 v153, v153
    ds_read_b128 v[88:91], v232 offset:33792
    v_rcp_f32_e64 v154, v154
    ds_read_b128 v[72:75], v232 offset:2048
    v_rcp_f32_e64 v155, v155
    ds_read_b128 v[92:95], v232 offset:34816
    v_rcp_f32_e64 v156, v156
    ds_read_b128 v[76:79], v232 offset:3072
    v_rcp_f32_e64 v157, v157
    ds_read_b128 v[96:99], v232 offset:35840
    v_rcp_f32_e64 v158, v158
    ds_read_b64_tr_b16 v[116:117], v235 offset:57344
    v_rcp_f32_e64 v159, v159
    ds_read_b64_tr_b16 v[118:119], v235 offset:61440
    v_pk_mul_f32 v[144:145], v[144:145], v[24:25]
    ds_read_b64_tr_b16 v[180:181], v241 offset:0
    v_pk_mul_f32 v[146:147], v[146:147], v[26:27]
    ds_read_b64_tr_b16 v[182:183], v241 offset:4096
    v_pk_mul_f32 v[148:149], v[148:149], v[52:53]
    ds_read_b64_tr_b16 v[120:121], v236 offset:57344
    v_pk_mul_f32 v[150:151], v[150:151], v[54:55]
    ds_read_b64_tr_b16 v[122:123], v236 offset:61440
    v_pk_mul_f32 v[152:153], v[152:153], v[80:81]
    ds_read_b64_tr_b16 v[184:185], v242 offset:0
    v_pk_mul_f32 v[154:155], v[154:155], v[82:83]
    ds_read_b64_tr_b16 v[186:187], v242 offset:4096
    v_pk_mul_f32 v[156:157], v[156:157], v[108:109]
    ds_read_b64_tr_b16 v[124:125], v237 offset:57344
    v_pk_mul_f32 v[158:159], v[158:159], v[110:111]
    ds_read_b64_tr_b16 v[126:127], v237 offset:61440
    v_cvt_pk_bf16_f32 v160, v144, v145
    v_cvt_pk_bf16_f32 v161, v146, v147
    v_cvt_pk_bf16_f32 v162, v148, v149
    v_cvt_pk_bf16_f32 v163, v150, v151
    v_cvt_pk_bf16_f32 v164, v152, v153
    v_cvt_pk_bf16_f32 v165, v154, v155
    v_cvt_pk_bf16_f32 v166, v156, v157
    v_cvt_pk_bf16_f32 v167, v158, v159
    s_waitcnt lgkmcnt(10)
    s_nop 0
    v_mfma_f32_16x16x32_bf16 v[0:3], v[112:115], v[64:67], 0
    ds_read_b64_tr_b16 v[188:189], v243 offset:0
    v_mfma_f32_16x16x32_bf16 v[0:3], v[176:179], v[84:87], v[0:3]
    ds_read_b64_tr_b16 v[190:191], v243 offset:4096
    v_mfma_f32_16x16x32_bf16 v[4:7], v[176:179], v[88:91], 0
    ds_write_b64 v227, v[160:161] offset:24576
    v_mfma_f32_16x16x32_bf16 v[4:7], v[112:115], v[68:71], v[4:7]
    ds_write_b64 v227, v[162:163] offset:25600
    v_mfma_f32_16x16x32_bf16 v[8:11], v[112:115], v[72:75], 0
    ds_write_b64 v227, v[164:165] offset:26624
    v_mfma_f32_16x16x32_bf16 v[8:11], v[176:179], v[92:95], v[8:11]
    ds_write_b64 v227, v[166:167] offset:27648
    v_mfma_f32_16x16x32_bf16 v[12:15], v[176:179], v[96:99], 0
    v_mfma_f32_16x16x32_bf16 v[12:15], v[112:115], v[76:79], v[12:15]
    s_waitcnt lgkmcnt(0)
    s_barrier
    v_mfma_f32_16x16x32_bf16 v[28:31], v[116:119], v[76:79], 0
    ds_read_b64_tr_b16 v[80:81], v240 offset:8192
    v_mfma_f32_16x16x32_bf16 v[28:31], v[180:183], v[96:99], v[28:31]
    ds_read_b64_tr_b16 v[82:83], v240 offset:12288
    v_mfma_f32_16x16x32_bf16 v[24:27], v[180:183], v[92:95], 0
    ds_read_b64_tr_b16 v[192:193], v240 offset:16384
    v_mfma_f32_16x16x32_bf16 v[24:27], v[116:119], v[72:75], v[24:27]
    ds_read_b64_tr_b16 v[194:195], v240 offset:20480
    v_mfma_f32_16x16x32_bf16 v[20:23], v[116:119], v[68:71], 0
    ds_read_b128 v[128:131], v232 offset:8192
    v_mfma_f32_16x16x32_bf16 v[20:23], v[180:183], v[88:91], v[20:23]
    ds_read_b128 v[144:147], v232 offset:40960
    v_mfma_f32_16x16x32_bf16 v[16:19], v[180:183], v[84:87], 0
    ds_read_b128 v[132:135], v232 offset:9216
    v_mfma_f32_16x16x32_bf16 v[16:19], v[116:119], v[64:67], v[16:19]
    ds_read_b128 v[148:151], v232 offset:41984
    v_mfma_f32_16x16x32_bf16 v[32:35], v[120:123], v[64:67], 0
    ds_read_b128 v[136:139], v232 offset:10240
    v_mfma_f32_16x16x32_bf16 v[32:35], v[184:187], v[84:87], v[32:35]
    ds_read_b128 v[152:155], v232 offset:43008
    v_mfma_f32_16x16x32_bf16 v[36:39], v[184:187], v[88:91], 0
    ds_read_b128 v[140:143], v232 offset:11264
    v_mfma_f32_16x16x32_bf16 v[36:39], v[120:123], v[68:71], v[36:39]
    ds_read_b128 v[156:159], v232 offset:44032
    v_mfma_f32_16x16x32_bf16 v[40:43], v[120:123], v[72:75], 0
    ds_read_b64_tr_b16 v[100:101], v241 offset:8192
    v_mfma_f32_16x16x32_bf16 v[40:43], v[184:187], v[92:95], v[40:43]
    ds_read_b64_tr_b16 v[102:103], v241 offset:12288
    v_mfma_f32_16x16x32_bf16 v[44:47], v[184:187], v[96:99], 0
    ds_read_b64_tr_b16 v[196:197], v241 offset:16384
    v_mfma_f32_16x16x32_bf16 v[44:47], v[120:123], v[76:79], v[44:47]
    ds_read_b64_tr_b16 v[198:199], v241 offset:20480
    v_mfma_f32_16x16x32_bf16 v[60:63], v[124:127], v[76:79], 0
    ds_read_b64_tr_b16 v[104:105], v242 offset:8192
    v_mfma_f32_16x16x32_bf16 v[60:63], v[188:191], v[96:99], v[60:63]
    ds_read_b64_tr_b16 v[106:107], v242 offset:12288
    v_mfma_f32_16x16x32_bf16 v[56:59], v[188:191], v[92:95], 0
    ds_read_b64_tr_b16 v[200:201], v242 offset:16384
    v_mfma_f32_16x16x32_bf16 v[56:59], v[124:127], v[72:75], v[56:59]
    ds_read_b64_tr_b16 v[202:203], v242 offset:20480
    v_mfma_f32_16x16x32_bf16 v[52:55], v[124:127], v[68:71], 0
    ds_read_b64_tr_b16 v[108:109], v243 offset:8192
    v_mfma_f32_16x16x32_bf16 v[52:55], v[188:191], v[88:91], v[52:55]
    ds_read_b64_tr_b16 v[110:111], v243 offset:12288
    v_mfma_f32_16x16x32_bf16 v[48:51], v[188:191], v[84:87], 0
    ds_read_b64_tr_b16 v[204:205], v243 offset:16384
    v_mfma_f32_16x16x32_bf16 v[48:51], v[124:127], v[64:67], v[48:51]
    ds_read_b64_tr_b16 v[206:207], v243 offset:20480
    s_waitcnt lgkmcnt(12)
    s_nop 0
    v_mfma_f32_16x16x32_bf16 v[0:3], v[80:83], v[128:131], v[0:3]
    v_mfma_f32_16x16x32_bf16 v[0:3], v[192:195], v[144:147], v[0:3]
    v_mfma_f32_16x16x32_bf16 v[4:7], v[192:195], v[148:151], v[4:7]
    v_mfma_f32_16x16x32_bf16 v[4:7], v[80:83], v[132:135], v[4:7]
    v_mfma_f32_16x16x32_bf16 v[8:11], v[80:83], v[136:139], v[8:11]
    v_mfma_f32_16x16x32_bf16 v[8:11], v[192:195], v[152:155], v[8:11]
    s_waitcnt lgkmcnt(0)
    s_barrier
    v_mfma_f32_16x16x32_bf16 v[12:15], v[192:195], v[156:159], v[12:15]
    ds_read_b64_tr_b16 v[112:113], v240 offset:24576
    v_mfma_f32_16x16x32_bf16 v[12:15], v[80:83], v[140:143], v[12:15]
    ds_read_b64_tr_b16 v[114:115], v240 offset:28672
    v_mfma_f32_16x16x32_bf16 v[28:31], v[100:103], v[140:143], v[28:31]
    ds_read_b64_tr_b16 v[176:177], v240 offset:32768
    v_mfma_f32_16x16x32_bf16 v[28:31], v[196:199], v[156:159], v[28:31]
    ds_read_b64_tr_b16 v[178:179], v240 offset:36864
    v_mfma_f32_16x16x32_bf16 v[24:27], v[196:199], v[152:155], v[24:27]
    ds_read_b128 v[64:67], v232 offset:16384
    v_mfma_f32_16x16x32_bf16 v[24:27], v[100:103], v[136:139], v[24:27]
    ds_read_b128 v[84:87], v232 offset:49152
    v_mfma_f32_16x16x32_bf16 v[20:23], v[100:103], v[132:135], v[20:23]
    ds_read_b128 v[68:71], v232 offset:17408
    v_mfma_f32_16x16x32_bf16 v[20:23], v[196:199], v[148:151], v[20:23]
    ds_read_b128 v[88:91], v232 offset:50176
    v_mfma_f32_16x16x32_bf16 v[16:19], v[196:199], v[144:147], v[16:19]
    ds_read_b128 v[72:75], v232 offset:18432
    v_mfma_f32_16x16x32_bf16 v[16:19], v[100:103], v[128:131], v[16:19]
    ds_read_b128 v[92:95], v232 offset:51200
    v_mfma_f32_16x16x32_bf16 v[32:35], v[104:107], v[128:131], v[32:35]
    ds_read_b128 v[76:79], v232 offset:19456
    v_mfma_f32_16x16x32_bf16 v[32:35], v[200:203], v[144:147], v[32:35]
    ds_read_b128 v[96:99], v232 offset:52224
    v_mfma_f32_16x16x32_bf16 v[36:39], v[200:203], v[148:151], v[36:39]
    ds_read_b64_tr_b16 v[116:117], v241 offset:24576
    v_mfma_f32_16x16x32_bf16 v[36:39], v[104:107], v[132:135], v[36:39]
    ds_read_b64_tr_b16 v[118:119], v241 offset:28672
    v_mfma_f32_16x16x32_bf16 v[40:43], v[104:107], v[136:139], v[40:43]
    ds_read_b64_tr_b16 v[180:181], v241 offset:32768
    v_mfma_f32_16x16x32_bf16 v[40:43], v[200:203], v[152:155], v[40:43]
    ds_read_b64_tr_b16 v[182:183], v241 offset:36864
    v_mfma_f32_16x16x32_bf16 v[44:47], v[200:203], v[156:159], v[44:47]
    ds_read_b64_tr_b16 v[120:121], v242 offset:24576
    v_mfma_f32_16x16x32_bf16 v[44:47], v[104:107], v[140:143], v[44:47]
    ds_read_b64_tr_b16 v[122:123], v242 offset:28672
    v_mfma_f32_16x16x32_bf16 v[60:63], v[108:111], v[140:143], v[60:63]
    ds_read_b64_tr_b16 v[184:185], v242 offset:32768
    v_mfma_f32_16x16x32_bf16 v[60:63], v[204:207], v[156:159], v[60:63]
    ds_read_b64_tr_b16 v[186:187], v242 offset:36864
    v_mfma_f32_16x16x32_bf16 v[56:59], v[204:207], v[152:155], v[56:59]
    ds_read_b64_tr_b16 v[124:125], v243 offset:24576
    v_mfma_f32_16x16x32_bf16 v[56:59], v[108:111], v[136:139], v[56:59]
    ds_read_b64_tr_b16 v[126:127], v243 offset:28672
    v_mfma_f32_16x16x32_bf16 v[52:55], v[108:111], v[132:135], v[52:55]
    ds_read_b64_tr_b16 v[188:189], v243 offset:32768
    v_mfma_f32_16x16x32_bf16 v[52:55], v[204:207], v[148:151], v[52:55]
    ds_read_b64_tr_b16 v[190:191], v243 offset:36864
    v_mfma_f32_16x16x32_bf16 v[48:51], v[204:207], v[144:147], v[48:51]
    v_mfma_f32_16x16x32_bf16 v[48:51], v[108:111], v[128:131], v[48:51]
    s_waitcnt lgkmcnt(12)
    s_nop 0
    v_mfma_f32_16x16x32_bf16 v[0:3], v[112:115], v[64:67], v[0:3]
    v_mfma_f32_16x16x32_bf16 v[0:3], v[176:179], v[84:87], v[0:3]
    v_mfma_f32_16x16x32_bf16 v[4:7], v[176:179], v[88:91], v[4:7]
    v_mfma_f32_16x16x32_bf16 v[4:7], v[112:115], v[68:71], v[4:7]
    v_mfma_f32_16x16x32_bf16 v[8:11], v[112:115], v[72:75], v[8:11]
    v_mfma_f32_16x16x32_bf16 v[8:11], v[176:179], v[92:95], v[8:11]
    s_waitcnt lgkmcnt(0)
    s_barrier
    v_mfma_f32_16x16x32_bf16 v[12:15], v[176:179], v[96:99], v[12:15]
    ds_read_b64_tr_b16 v[80:81], v240 offset:40960
    ds_read_b64_tr_b16 v[82:83], v240 offset:45056
    v_mfma_f32_16x16x32_bf16 v[12:15], v[112:115], v[76:79], v[12:15]
    ds_read_b64_tr_b16 v[192:193], v240 offset:49152
    ds_read_b64_tr_b16 v[194:195], v240 offset:53248
    v_mfma_f32_16x16x32_bf16 v[28:31], v[116:119], v[76:79], v[28:31]
    ds_read_b64 v[128:129], v233 offset:24576
    v_mfma_f32_16x16x32_bf16 v[28:31], v[180:183], v[96:99], v[28:31]
    ds_read_b64 v[130:131], v233 offset:25088
    v_mfma_f32_16x16x32_bf16 v[24:27], v[180:183], v[92:95], v[24:27]
    ds_read_b128 v[144:147], v244 offset:24576
    v_mfma_f32_16x16x32_bf16 v[24:27], v[116:119], v[72:75], v[24:27]
    ds_read_b64 v[132:133], v233 offset:25600
    v_mfma_f32_16x16x32_bf16 v[20:23], v[116:119], v[68:71], v[20:23]
    ds_read_b64 v[134:135], v233 offset:26112
    v_mfma_f32_16x16x32_bf16 v[20:23], v[180:183], v[88:91], v[20:23]
    ds_read_b128 v[148:151], v244 offset:25600
    v_mfma_f32_16x16x32_bf16 v[16:19], v[180:183], v[84:87], v[16:19]
    ds_read_b64 v[136:137], v233 offset:26624
    v_mfma_f32_16x16x32_bf16 v[16:19], v[116:119], v[64:67], v[16:19]
    ds_read_b64 v[138:139], v233 offset:27136
    v_mfma_f32_16x16x32_bf16 v[32:35], v[120:123], v[64:67], v[32:35]
    ds_read_b128 v[152:155], v244 offset:26624
    v_mfma_f32_16x16x32_bf16 v[32:35], v[184:187], v[84:87], v[32:35]
    ds_read_b64 v[140:141], v233 offset:27648
    v_mfma_f32_16x16x32_bf16 v[36:39], v[184:187], v[88:91], v[36:39]
    ds_read_b64 v[142:143], v233 offset:28160
    v_mfma_f32_16x16x32_bf16 v[36:39], v[120:123], v[68:71], v[36:39]
    ds_read_b128 v[156:159], v244 offset:27648
    v_mfma_f32_16x16x32_bf16 v[40:43], v[120:123], v[72:75], v[40:43]
    ds_read_b64_tr_b16 v[100:101], v241 offset:40960
    v_mfma_f32_16x16x32_bf16 v[40:43], v[184:187], v[92:95], v[40:43]
    ds_read_b64_tr_b16 v[102:103], v241 offset:45056
    v_mfma_f32_16x16x32_bf16 v[44:47], v[184:187], v[96:99], v[44:47]
    ds_read_b64_tr_b16 v[196:197], v241 offset:49152
    v_mfma_f32_16x16x32_bf16 v[44:47], v[120:123], v[76:79], v[44:47]
    ds_read_b64_tr_b16 v[198:199], v241 offset:53248
    v_mfma_f32_16x16x32_bf16 v[60:63], v[124:127], v[76:79], v[60:63]
    ds_read_b64_tr_b16 v[104:105], v242 offset:40960
    v_mfma_f32_16x16x32_bf16 v[60:63], v[188:191], v[96:99], v[60:63]
    ds_read_b64_tr_b16 v[106:107], v242 offset:45056
    v_mfma_f32_16x16x32_bf16 v[56:59], v[188:191], v[92:95], v[56:59]
    ds_read_b64_tr_b16 v[200:201], v242 offset:49152
    v_mfma_f32_16x16x32_bf16 v[56:59], v[124:127], v[72:75], v[56:59]
    ds_read_b64_tr_b16 v[202:203], v242 offset:53248
    v_mfma_f32_16x16x32_bf16 v[52:55], v[124:127], v[68:71], v[52:55]
    ds_read_b64_tr_b16 v[108:109], v243 offset:40960
    v_mfma_f32_16x16x32_bf16 v[52:55], v[188:191], v[88:91], v[52:55]
    ds_read_b64_tr_b16 v[110:111], v243 offset:45056
    v_mfma_f32_16x16x32_bf16 v[48:51], v[188:191], v[84:87], v[48:51]
    ds_read_b64_tr_b16 v[204:205], v243 offset:49152
    v_mfma_f32_16x16x32_bf16 v[48:51], v[124:127], v[64:67], v[48:51]
    ds_read_b64_tr_b16 v[206:207], v243 offset:53248
    s_waitcnt lgkmcnt(12)
    s_nop 0
    v_mfma_f32_16x16x32_bf16 v[0:3], v[80:83], v[128:131], v[0:3]
    v_mfma_f32_16x16x32_bf16 v[0:3], v[192:195], v[144:147], v[0:3]
    v_mfma_f32_16x16x32_bf16 v[4:7], v[192:195], v[148:151], v[4:7]
    v_mfma_f32_16x16x32_bf16 v[4:7], v[80:83], v[132:135], v[4:7]
    v_mfma_f32_16x16x32_bf16 v[8:11], v[80:83], v[136:139], v[8:11]
    v_mfma_f32_16x16x32_bf16 v[8:11], v[192:195], v[152:155], v[8:11]
    s_waitcnt lgkmcnt(0)
    s_barrier
    v_mfma_f32_16x16x32_bf16 v[12:15], v[192:195], v[156:159], v[12:15]
    ds_read_b64_tr_b16 v[112:113], v240 offset:57344
    v_mfma_f32_16x16x32_bf16 v[12:15], v[80:83], v[140:143], v[12:15]
    ds_read_b64_tr_b16 v[114:115], v240 offset:61440
    v_mfma_f32_16x16x32_bf16 v[28:31], v[100:103], v[140:143], v[28:31]
    ds_read_b64_tr_b16 v[176:177], v246 offset:0
    v_mfma_f32_16x16x32_bf16 v[28:31], v[196:199], v[156:159], v[28:31]
    ds_read_b64_tr_b16 v[178:179], v246 offset:4096
    v_mfma_f32_16x16x32_bf16 v[24:27], v[196:199], v[152:155], v[24:27]
    ds_read_b128 v[64:67], v232 offset:0
    v_mfma_f32_16x16x32_bf16 v[24:27], v[100:103], v[136:139], v[24:27]
    ds_read_b128 v[84:87], v232 offset:32768
    v_mfma_f32_16x16x32_bf16 v[20:23], v[100:103], v[132:135], v[20:23]
    ds_read_b128 v[68:71], v232 offset:1024
    v_mfma_f32_16x16x32_bf16 v[20:23], v[196:199], v[148:151], v[20:23]
    ds_read_b128 v[88:91], v232 offset:33792
    v_mfma_f32_16x16x32_bf16 v[16:19], v[196:199], v[144:147], v[16:19]
    ds_read_b128 v[72:75], v232 offset:2048
    v_mfma_f32_16x16x32_bf16 v[16:19], v[100:103], v[128:131], v[16:19]
    ds_read_b128 v[92:95], v232 offset:34816
    v_mfma_f32_16x16x32_bf16 v[32:35], v[104:107], v[128:131], v[32:35]
    ds_read_b128 v[76:79], v232 offset:3072
    v_mfma_f32_16x16x32_bf16 v[32:35], v[200:203], v[144:147], v[32:35]
    ds_read_b128 v[96:99], v232 offset:35840
    v_mfma_f32_16x16x32_bf16 v[36:39], v[200:203], v[148:151], v[36:39]
    ds_read_b64_tr_b16 v[116:117], v241 offset:57344
    v_mfma_f32_16x16x32_bf16 v[36:39], v[104:107], v[132:135], v[36:39]
    ds_read_b64_tr_b16 v[118:119], v241 offset:61440
    v_mfma_f32_16x16x32_bf16 v[40:43], v[104:107], v[136:139], v[40:43]
    ds_read_b64_tr_b16 v[180:181], v247 offset:0
    v_mfma_f32_16x16x32_bf16 v[40:43], v[200:203], v[152:155], v[40:43]
    ds_read_b64_tr_b16 v[182:183], v247 offset:4096
    v_mfma_f32_16x16x32_bf16 v[44:47], v[200:203], v[156:159], v[44:47]
    ds_read_b64_tr_b16 v[120:121], v242 offset:57344
    v_mfma_f32_16x16x32_bf16 v[44:47], v[104:107], v[140:143], v[44:47]
    ds_read_b64_tr_b16 v[122:123], v242 offset:61440
    v_mfma_f32_16x16x32_bf16 v[60:63], v[108:111], v[140:143], v[60:63]
    ds_read_b64_tr_b16 v[184:185], v248 offset:0
    v_mfma_f32_16x16x32_bf16 v[60:63], v[204:207], v[156:159], v[60:63]
    ds_read_b64_tr_b16 v[186:187], v248 offset:4096
    v_mfma_f32_16x16x32_bf16 v[56:59], v[204:207], v[152:155], v[56:59]
    ds_read_b64_tr_b16 v[124:125], v243 offset:57344
    v_mfma_f32_16x16x32_bf16 v[56:59], v[108:111], v[136:139], v[56:59]
    ds_read_b64_tr_b16 v[126:127], v243 offset:61440
    v_mfma_f32_16x16x32_bf16 v[52:55], v[108:111], v[132:135], v[52:55]
    ds_read_b64_tr_b16 v[188:189], v249 offset:0
    v_mfma_f32_16x16x32_bf16 v[52:55], v[204:207], v[148:151], v[52:55]
    ds_read_b64_tr_b16 v[190:191], v249 offset:4096
    v_mfma_f32_16x16x32_bf16 v[48:51], v[204:207], v[144:147], v[48:51]
    v_mfma_f32_16x16x32_bf16 v[48:51], v[108:111], v[128:131], v[48:51]
    s_waitcnt lgkmcnt(12)
    s_nop 0
    v_mfma_f32_16x16x32_bf16 v[0:3], v[112:115], v[64:67], v[0:3]
    v_mfma_f32_16x16x32_bf16 v[0:3], v[176:179], v[84:87], v[0:3]
    v_mfma_f32_16x16x32_bf16 v[4:7], v[176:179], v[88:91], v[4:7]
    v_mfma_f32_16x16x32_bf16 v[4:7], v[112:115], v[68:71], v[4:7]
    v_mfma_f32_16x16x32_bf16 v[8:11], v[112:115], v[72:75], v[8:11]
    v_mfma_f32_16x16x32_bf16 v[8:11], v[176:179], v[92:95], v[8:11]
    s_waitcnt lgkmcnt(0)
    s_barrier
    v_mfma_f32_16x16x32_bf16 v[12:15], v[176:179], v[96:99], v[12:15]
    ds_read_b64_tr_b16 v[80:81], v246 offset:8192
    v_mfma_f32_16x16x32_bf16 v[12:15], v[112:115], v[76:79], v[12:15]
    ds_read_b64_tr_b16 v[82:83], v246 offset:12288
    v_mfma_f32_16x16x32_bf16 v[28:31], v[116:119], v[76:79], v[28:31]
    ds_read_b64_tr_b16 v[192:193], v246 offset:16384
    v_mfma_f32_16x16x32_bf16 v[28:31], v[180:183], v[96:99], v[28:31]
    ds_read_b64_tr_b16 v[194:195], v246 offset:20480
    v_mfma_f32_16x16x32_bf16 v[24:27], v[180:183], v[92:95], v[24:27]
    ds_read_b128 v[128:131], v232 offset:8192
    v_mfma_f32_16x16x32_bf16 v[24:27], v[116:119], v[72:75], v[24:27]
    ds_read_b128 v[144:147], v232 offset:40960
    v_mfma_f32_16x16x32_bf16 v[20:23], v[116:119], v[68:71], v[20:23]
    ds_read_b128 v[132:135], v232 offset:9216
    v_mfma_f32_16x16x32_bf16 v[20:23], v[180:183], v[88:91], v[20:23]
    ds_read_b128 v[148:151], v232 offset:41984
    v_mfma_f32_16x16x32_bf16 v[16:19], v[180:183], v[84:87], v[16:19]
    ds_read_b128 v[136:139], v232 offset:10240
    v_mfma_f32_16x16x32_bf16 v[16:19], v[116:119], v[64:67], v[16:19]
    ds_read_b128 v[152:155], v232 offset:43008
    v_mfma_f32_16x16x32_bf16 v[32:35], v[120:123], v[64:67], v[32:35]
    ds_read_b128 v[140:143], v232 offset:11264
    v_mfma_f32_16x16x32_bf16 v[32:35], v[184:187], v[84:87], v[32:35]
    ds_read_b128 v[156:159], v232 offset:44032
    v_mfma_f32_16x16x32_bf16 v[36:39], v[184:187], v[88:91], v[36:39]
    ds_read_b64_tr_b16 v[100:101], v247 offset:8192
    v_mfma_f32_16x16x32_bf16 v[36:39], v[120:123], v[68:71], v[36:39]
    ds_read_b64_tr_b16 v[102:103], v247 offset:12288
    v_mfma_f32_16x16x32_bf16 v[40:43], v[120:123], v[72:75], v[40:43]
    ds_read_b64_tr_b16 v[196:197], v247 offset:16384
    v_mfma_f32_16x16x32_bf16 v[40:43], v[184:187], v[92:95], v[40:43]
    ds_read_b64_tr_b16 v[198:199], v247 offset:20480
    v_mfma_f32_16x16x32_bf16 v[44:47], v[184:187], v[96:99], v[44:47]
    ds_read_b64_tr_b16 v[104:105], v248 offset:8192
    v_mfma_f32_16x16x32_bf16 v[44:47], v[120:123], v[76:79], v[44:47]
L_wp4:
    s_cbranch_vccnz L_warm_done
    s_nop 0
    ds_read_b64_tr_b16 v[106:107], v248 offset:12288
    v_mfma_f32_16x16x32_bf16 v[60:63], v[124:127], v[76:79], v[60:63]
    ds_read_b64_tr_b16 v[200:201], v248 offset:16384
    v_mfma_f32_16x16x32_bf16 v[60:63], v[188:191], v[96:99], v[60:63]
    ds_read_b64_tr_b16 v[202:203], v248 offset:20480
    v_mfma_f32_16x16x32_bf16 v[56:59], v[188:191], v[92:95], v[56:59]
    ds_read_b64_tr_b16 v[108:109], v249 offset:8192
    v_mfma_f32_16x16x32_bf16 v[56:59], v[124:127], v[72:75], v[56:59]
    ds_read_b64_tr_b16 v[110:111], v249 offset:12288
    v_mfma_f32_16x16x32_bf16 v[52:55], v[124:127], v[68:71], v[52:55]
    ds_read_b64_tr_b16 v[204:205], v249 offset:16384
    v_mfma_f32_16x16x32_bf16 v[52:55], v[188:191], v[88:91], v[52:55]
    ds_read_b64_tr_b16 v[206:207], v249 offset:20480
    v_mfma_f32_16x16x32_bf16 v[48:51], v[188:191], v[84:87], v[48:51]
    v_mfma_f32_16x16x32_bf16 v[48:51], v[124:127], v[64:67], v[48:51]
    s_waitcnt lgkmcnt(12)
    s_nop 0
    v_mfma_f32_16x16x32_bf16 v[0:3], v[80:83], v[128:131], v[0:3]
    v_mfma_f32_16x16x32_bf16 v[0:3], v[192:195], v[144:147], v[0:3]
    v_mfma_f32_16x16x32_bf16 v[4:7], v[192:195], v[148:151], v[4:7]
    v_mfma_f32_16x16x32_bf16 v[4:7], v[80:83], v[132:135], v[4:7]
    v_mfma_f32_16x16x32_bf16 v[8:11], v[80:83], v[136:139], v[8:11]
    v_mfma_f32_16x16x32_bf16 v[8:11], v[192:195], v[152:155], v[8:11]
    s_waitcnt lgkmcnt(0)
    s_barrier
    v_mfma_f32_16x16x32_bf16 v[12:15], v[192:195], v[156:159], v[12:15]
    ds_read_b64_tr_b16 v[112:113], v234 offset:57344
    v_mfma_f32_16x16x32_bf16 v[12:15], v[80:83], v[140:143], v[12:15]
    ds_read_b64_tr_b16 v[114:115], v234 offset:61440
    v_mfma_f32_16x16x32_bf16 v[28:31], v[100:103], v[140:143], v[28:31]
    ds_read_b64_tr_b16 v[176:177], v240 offset:0
    v_mfma_f32_16x16x32_bf16 v[28:31], v[196:199], v[156:159], v[28:31]
    ds_read_b64_tr_b16 v[178:179], v240 offset:4096
    v_mfma_f32_16x16x32_bf16 v[24:27], v[196:199], v[152:155], v[24:27]
    ds_read_b128 v[64:67], v232 offset:16384
    v_mfma_f32_16x16x32_bf16 v[24:27], v[100:103], v[136:139], v[24:27]
    ds_read_b128 v[84:87], v232 offset:49152
    v_mfma_f32_16x16x32_bf16 v[20:23], v[100:103], v[132:135], v[20:23]
    ds_read_b128 v[68:71], v232 offset:17408
    v_mfma_f32_16x16x32_bf16 v[20:23], v[196:199], v[148:151], v[20:23]
    ds_read_b128 v[88:91], v232 offset:50176
    v_mfma_f32_16x16x32_bf16 v[16:19], v[196:199], v[144:147], v[16:19]
    ds_read_b128 v[72:75], v232 offset:18432
    v_mfma_f32_16x16x32_bf16 v[16:19], v[100:103], v[128:131], v[16:19]
    ds_read_b128 v[92:95], v232 offset:51200
    v_mfma_f32_16x16x32_bf16 v[32:35], v[104:107], v[128:131], v[32:35]
    ds_read_b128 v[76:79], v232 offset:19456
    v_mfma_f32_16x16x32_bf16 v[32:35], v[200:203], v[144:147], v[32:35]
    ds_read_b128 v[96:99], v232 offset:52224
    v_mfma_f32_16x16x32_bf16 v[36:39], v[200:203], v[148:151], v[36:39]
    ds_read_b64_tr_b16 v[116:117], v235 offset:57344
    v_mfma_f32_16x16x32_bf16 v[36:39], v[104:107], v[132:135], v[36:39]
    ds_read_b64_tr_b16 v[118:119], v235 offset:61440
    v_mfma_f32_16x16x32_bf16 v[40:43], v[104:107], v[136:139], v[40:43]
    ds_read_b64_tr_b16 v[180:181], v241 offset:0
    v_mfma_f32_16x16x32_bf16 v[40:43], v[200:203], v[152:155], v[40:43]
    ds_read_b64_tr_b16 v[182:183], v241 offset:4096
    v_mfma_f32_16x16x32_bf16 v[44:47], v[200:203], v[156:159], v[44:47]
    ds_read_b64_tr_b16 v[120:121], v236 offset:57344
    v_mfma_f32_16x16x32_bf16 v[44:47], v[104:107], v[140:143], v[44:47]
    ds_read_b64_tr_b16 v[122:123], v236 offset:61440
    v_mfma_f32_16x16x32_bf16 v[60:63], v[108:111], v[140:143], v[60:63]
    ds_read_b64_tr_b16 v[184:185], v242 offset:0
    v_mfma_f32_16x16x32_bf16 v[60:63], v[204:207], v[156:159], v[60:63]
    ds_read_b64_tr_b16 v[186:187], v242 offset:4096
    v_mfma_f32_16x16x32_bf16 v[56:59], v[204:207], v[152:155], v[56:59]
    ds_read_b64_tr_b16 v[124:125], v237 offset:57344
    v_mfma_f32_16x16x32_bf16 v[56:59], v[108:111], v[136:139], v[56:59]
    ds_read_b64_tr_b16 v[126:127], v237 offset:61440
    v_mfma_f32_16x16x32_bf16 v[52:55], v[108:111], v[132:135], v[52:55]
    ds_read_b64_tr_b16 v[188:189], v243 offset:0
    v_mfma_f32_16x16x32_bf16 v[52:55], v[204:207], v[148:151], v[52:55]
    ds_read_b64_tr_b16 v[190:191], v243 offset:4096
    v_mfma_f32_16x16x32_bf16 v[48:51], v[204:207], v[144:147], v[48:51]
    v_mfma_f32_16x16x32_bf16 v[48:51], v[108:111], v[128:131], v[48:51]
    s_waitcnt lgkmcnt(12)
    s_nop 0
    v_mfma_f32_16x16x32_bf16 v[0:3], v[112:115], v[64:67], v[0:3]
    v_mfma_f32_16x16x32_bf16 v[0:3], v[176:179], v[84:87], v[0:3]
    v_mfma_f32_16x16x32_bf16 v[4:7], v[176:179], v[88:91], v[4:7]
    v_mfma_f32_16x16x32_bf16 v[4:7], v[112:115], v[68:71], v[4:7]
    v_mfma_f32_16x16x32_bf16 v[8:11], v[112:115], v[72:75], v[8:11]
    v_mfma_f32_16x16x32_bf16 v[8:11], v[176:179], v[92:95], v[8:11]
    s_waitcnt lgkmcnt(0)
    s_barrier
    v_mfma_f32_16x16x32_bf16 v[12:15], v[176:179], v[96:99], v[12:15]
    ds_read_b64_tr_b16 v[80:81], v240 offset:8192
    v_mfma_f32_16x16x32_bf16 v[12:15], v[112:115], v[76:79], v[12:15]
    ds_read_b64_tr_b16 v[82:83], v240 offset:12288
    v_mfma_f32_16x16x32_bf16 v[28:31], v[116:119], v[76:79], v[28:31]
    ds_read_b64_tr_b16 v[192:193], v240 offset:16384
    v_mfma_f32_16x16x32_bf16 v[28:31], v[180:183], v[96:99], v[28:31]
    ds_read_b64_tr_b16 v[194:195], v240 offset:20480
    v_mfma_f32_16x16x32_bf16 v[24:27], v[180:183], v[92:95], v[24:27]
    ds_read_b128 v[128:131], v232 offset:24576
    v_mfma_f32_16x16x32_bf16 v[24:27], v[116:119], v[72:75], v[24:27]
    ds_read_b128 v[144:147], v244 offset:24576
    v_mfma_f32_16x16x32_bf16 v[20:23], v[116:119], v[68:71], v[20:23]
    ds_read_b128 v[132:135], v232 offset:25600
    v_mfma_f32_16x16x32_bf16 v[20:23], v[180:183], v[88:91], v[20:23]
    ds_read_b128 v[148:151], v244 offset:25600
    v_mfma_f32_16x16x32_bf16 v[16:19], v[180:183], v[84:87], v[16:19]
    ds_read_b128 v[136:139], v232 offset:26624
    v_mfma_f32_16x16x32_bf16 v[16:19], v[116:119], v[64:67], v[16:19]
    ds_read_b128 v[152:155], v244 offset:26624
    v_mfma_f32_16x16x32_bf16 v[32:35], v[120:123], v[64:67], v[32:35]
    ds_read_b128 v[140:143], v232 offset:27648
    v_mfma_f32_16x16x32_bf16 v[32:35], v[184:187], v[84:87], v[32:35]
    ds_read_b128 v[156:159], v244 offset:27648
    v_mfma_f32_16x16x32_bf16 v[36:39], v[184:187], v[88:91], v[36:39]
    ds_read_b64_tr_b16 v[100:101], v241 offset:8192
    v_mfma_f32_16x16x32_bf16 v[36:39], v[120:123], v[68:71], v[36:39]
    ds_read_b64_tr_b16 v[102:103], v241 offset:12288
    v_mfma_f32_16x16x32_bf16 v[40:43], v[120:123], v[72:75], v[40:43]
    ds_read_b64_tr_b16 v[196:197], v241 offset:16384
    v_mfma_f32_16x16x32_bf16 v[40:43], v[184:187], v[92:95], v[40:43]
    ds_read_b64_tr_b16 v[198:199], v241 offset:20480
    v_mfma_f32_16x16x32_bf16 v[44:47], v[184:187], v[96:99], v[44:47]
    ds_read_b64_tr_b16 v[104:105], v242 offset:8192
    v_mfma_f32_16x16x32_bf16 v[44:47], v[120:123], v[76:79], v[44:47]
    ds_read_b64_tr_b16 v[106:107], v242 offset:12288
    v_mfma_f32_16x16x32_bf16 v[60:63], v[124:127], v[76:79], v[60:63]
    ds_read_b64_tr_b16 v[200:201], v242 offset:16384
    v_mfma_f32_16x16x32_bf16 v[60:63], v[188:191], v[96:99], v[60:63]
    ds_read_b64_tr_b16 v[202:203], v242 offset:20480
    v_mfma_f32_16x16x32_bf16 v[56:59], v[188:191], v[92:95], v[56:59]
    ds_read_b64_tr_b16 v[108:109], v243 offset:8192
    v_mfma_f32_16x16x32_bf16 v[56:59], v[124:127], v[72:75], v[56:59]
    ds_read_b64_tr_b16 v[110:111], v243 offset:12288
    v_mfma_f32_16x16x32_bf16 v[52:55], v[124:127], v[68:71], v[52:55]
    ds_read_b64_tr_b16 v[204:205], v243 offset:16384
    v_mfma_f32_16x16x32_bf16 v[52:55], v[188:191], v[88:91], v[52:55]
    ds_read_b64_tr_b16 v[206:207], v243 offset:20480
    v_mfma_f32_16x16x32_bf16 v[48:51], v[188:191], v[84:87], v[48:51]
    v_mfma_f32_16x16x32_bf16 v[48:51], v[124:127], v[64:67], v[48:51]
    s_waitcnt lgkmcnt(12)
    s_nop 0
    v_mfma_f32_16x16x32_bf16 v[0:3], v[80:83], v[128:131], v[0:3]
    v_mfma_f32_16x16x32_bf16 v[0:3], v[192:195], v[144:147], v[0:3]
    v_mfma_f32_16x16x32_bf16 v[4:7], v[192:195], v[148:151], v[4:7]
    v_mfma_f32_16x16x32_bf16 v[4:7], v[80:83], v[132:135], v[4:7]
    v_mfma_f32_16x16x32_bf16 v[8:11], v[80:83], v[136:139], v[8:11]
    v_mfma_f32_16x16x32_bf16 v[8:11], v[192:195], v[152:155], v[8:11]
    s_waitcnt lgkmcnt(0)
    s_barrier
    v_mfma_f32_16x16x32_bf16 v[12:15], v[192:195], v[156:159], v[12:15]
    ds_read_b64_tr_b16 v[112:113], v240 offset:24576
    v_mfma_f32_16x16x32_bf16 v[12:15], v[80:83], v[140:143], v[12:15]
    ds_read_b64_tr_b16 v[114:115], v240 offset:28672
    v_mfma_f32_16x16x32_bf16 v[28:31], v[100:103], v[140:143], v[28:31]
    ds_read_b64_tr_b16 v[176:177], v240 offset:32768
    v_mfma_f32_16x16x32_bf16 v[28:31], v[196:199], v[156:159], v[28:31]
    ds_read_b64_tr_b16 v[178:179], v240 offset:36864
    v_mfma_f32_16x16x32_bf16 v[24:27], v[196:199], v[152:155], v[24:27]
    ds_read_b128 v[64:67], v232 offset:0
    v_mfma_f32_16x16x32_bf16 v[24:27], v[100:103], v[136:139], v[24:27]
    ds_read_b128 v[84:87], v232 offset:32768
    v_mfma_f32_16x16x32_bf16 v[20:23], v[100:103], v[132:135], v[20:23]
    ds_read_b128 v[68:71], v232 offset:1024
    v_mfma_f32_16x16x32_bf16 v[20:23], v[196:199], v[148:151], v[20:23]
    ds_read_b128 v[88:91], v232 offset:33792
    v_mfma_f32_16x16x32_bf16 v[16:19], v[196:199], v[144:147], v[16:19]
    ds_read_b128 v[72:75], v232 offset:2048
    v_mfma_f32_16x16x32_bf16 v[16:19], v[100:103], v[128:131], v[16:19]
    ds_read_b128 v[92:95], v232 offset:34816
    v_mfma_f32_16x16x32_bf16 v[32:35], v[104:107], v[128:131], v[32:35]
    ds_read_b128 v[76:79], v232 offset:3072
    v_mfma_f32_16x16x32_bf16 v[32:35], v[200:203], v[144:147], v[32:35]
    ds_read_b128 v[96:99], v232 offset:35840
    v_mfma_f32_16x16x32_bf16 v[36:39], v[200:203], v[148:151], v[36:39]
    ds_read_b64_tr_b16 v[116:117], v241 offset:24576
    v_mfma_f32_16x16x32_bf16 v[36:39], v[104:107], v[132:135], v[36:39]
    ds_read_b64_tr_b16 v[118:119], v241 offset:28672
    v_mfma_f32_16x16x32_bf16 v[40:43], v[104:107], v[136:139], v[40:43]
    ds_read_b64_tr_b16 v[180:181], v241 offset:32768
    v_mfma_f32_16x16x32_bf16 v[40:43], v[200:203], v[152:155], v[40:43]
    ds_read_b64_tr_b16 v[182:183], v241 offset:36864
    v_mfma_f32_16x16x32_bf16 v[44:47], v[200:203], v[156:159], v[44:47]
    ds_read_b64_tr_b16 v[120:121], v242 offset:24576
    v_mfma_f32_16x16x32_bf16 v[44:47], v[104:107], v[140:143], v[44:47]
    ds_read_b64_tr_b16 v[122:123], v242 offset:28672
    v_mfma_f32_16x16x32_bf16 v[60:63], v[108:111], v[140:143], v[60:63]
    ds_read_b64_tr_b16 v[184:185], v242 offset:32768
    v_mfma_f32_16x16x32_bf16 v[60:63], v[204:207], v[156:159], v[60:63]
    ds_read_b64_tr_b16 v[186:187], v242 offset:36864
    v_mfma_f32_16x16x32_bf16 v[56:59], v[204:207], v[152:155], v[56:59]
    ds_read_b64_tr_b16 v[124:125], v243 offset:24576
    v_mfma_f32_16x16x32_bf16 v[56:59], v[108:111], v[136:139], v[56:59]
    ds_read_b64_tr_b16 v[126:127], v243 offset:28672
    v_mfma_f32_16x16x32_bf16 v[52:55], v[108:111], v[132:135], v[52:55]
    ds_read_b64_tr_b16 v[188:189], v243 offset:32768
    v_mfma_f32_16x16x32_bf16 v[52:55], v[204:207], v[148:151], v[52:55]
    ds_read_b64_tr_b16 v[190:191], v243 offset:36864
    v_mfma_f32_16x16x32_bf16 v[48:51], v[204:207], v[144:147], v[48:51]
    v_mfma_f32_16x16x32_bf16 v[48:51], v[108:111], v[128:131], v[48:51]
    s_waitcnt lgkmcnt(12)
    s_nop 0
    v_mfma_f32_16x16x32_bf16 v[0:3], v[112:115], v[64:67], v[0:3]
    v_mfma_f32_16x16x32_bf16 v[0:3], v[176:179], v[84:87], v[0:3]
    v_mfma_f32_16x16x32_bf16 v[4:7], v[176:179], v[88:91], v[4:7]
    v_mfma_f32_16x16x32_bf16 v[4:7], v[112:115], v[68:71], v[4:7]
    v_mfma_f32_16x16x32_bf16 v[8:11], v[112:115], v[72:75], v[8:11]
    v_mfma_f32_16x16x32_bf16 v[8:11], v[176:179], v[92:95], v[8:11]
    s_waitcnt lgkmcnt(0)
    s_barrier
    v_mfma_f32_16x16x32_bf16 v[12:15], v[176:179], v[96:99], v[12:15]
    ds_read_b64_tr_b16 v[80:81], v240 offset:40960
    v_mfma_f32_16x16x32_bf16 v[12:15], v[112:115], v[76:79], v[12:15]
    ds_read_b64_tr_b16 v[82:83], v240 offset:45056
    v_mfma_f32_16x16x32_bf16 v[28:31], v[116:119], v[76:79], v[28:31]
    ds_read_b64_tr_b16 v[192:193], v240 offset:49152
    v_mfma_f32_16x16x32_bf16 v[28:31], v[180:183], v[96:99], v[28:31]
    ds_read_b64_tr_b16 v[194:195], v240 offset:53248
    v_mfma_f32_16x16x32_bf16 v[24:27], v[180:183], v[92:95], v[24:27]
    ds_read_b128 v[128:131], v232 offset:8192
    v_mfma_f32_16x16x32_bf16 v[24:27], v[116:119], v[72:75], v[24:27]
    ds_read_b128 v[144:147], v232 offset:40960
    v_mfma_f32_16x16x32_bf16 v[20:23], v[116:119], v[68:71], v[20:23]
    ds_read_b128 v[132:135], v232 offset:9216
    v_mfma_f32_16x16x32_bf16 v[20:23], v[180:183], v[88:91], v[20:23]
    ds_read_b128 v[148:151], v232 offset:41984
    v_mfma_f32_16x16x32_bf16 v[16:19], v[180:183], v[84:87], v[16:19]
    ds_read_b128 v[136:139], v232 offset:10240
    v_mfma_f32_16x16x32_bf16 v[16:19], v[116:119], v[64:67], v[16:19]
    ds_read_b128 v[152:155], v232 offset:43008
    v_mfma_f32_16x16x32_bf16 v[32:35], v[120:123], v[64:67], v[32:35]
    ds_read_b128 v[140:143], v232 offset:11264
    v_mfma_f32_16x16x32_bf16 v[32:35], v[184:187], v[84:87], v[32:35]
    ds_read_b128 v[156:159], v232 offset:44032
    v_mfma_f32_16x16x32_bf16 v[36:39], v[184:187], v[88:91], v[36:39]
    ds_read_b64_tr_b16 v[100:101], v241 offset:40960
    v_mfma_f32_16x16x32_bf16 v[36:39], v[120:123], v[68:71], v[36:39]
    ds_read_b64_tr_b16 v[102:103], v241 offset:45056
    v_mfma_f32_16x16x32_bf16 v[40:43], v[120:123], v[72:75], v[40:43]
    ds_read_b64_tr_b16 v[196:197], v241 offset:49152
    v_mfma_f32_16x16x32_bf16 v[40:43], v[184:187], v[92:95], v[40:43]
    ds_read_b64_tr_b16 v[198:199], v241 offset:53248
    v_mfma_f32_16x16x32_bf16 v[44:47], v[184:187], v[96:99], v[44:47]
    ds_read_b64_tr_b16 v[104:105], v242 offset:40960
    v_mfma_f32_16x16x32_bf16 v[44:47], v[120:123], v[76:79], v[44:47]
    ds_read_b64_tr_b16 v[106:107], v242 offset:45056
    v_mfma_f32_16x16x32_bf16 v[60:63], v[124:127], v[76:79], v[60:63]
    ds_read_b64_tr_b16 v[200:201], v242 offset:49152
    v_mfma_f32_16x16x32_bf16 v[60:63], v[188:191], v[96:99], v[60:63]
    ds_read_b64_tr_b16 v[202:203], v242 offset:53248
    v_mfma_f32_16x16x32_bf16 v[56:59], v[188:191], v[92:95], v[56:59]
    ds_read_b64_tr_b16 v[108:109], v243 offset:40960
    v_mfma_f32_16x16x32_bf16 v[56:59], v[124:127], v[72:75], v[56:59]
    ds_read_b64_tr_b16 v[110:111], v243 offset:45056
    v_mfma_f32_16x16x32_bf16 v[52:55], v[124:127], v[68:71], v[52:55]
    ds_read_b64_tr_b16 v[204:205], v243 offset:49152
    v_mfma_f32_16x16x32_bf16 v[52:55], v[188:191], v[88:91], v[52:55]
    ds_read_b64_tr_b16 v[206:207], v243 offset:53248
    v_mfma_f32_16x16x32_bf16 v[48:51], v[188:191], v[84:87], v[48:51]
    v_mfma_f32_16x16x32_bf16 v[48:51], v[124:127], v[64:67], v[48:51]
    s_waitcnt lgkmcnt(12)
    s_nop 0
    v_mfma_f32_16x16x32_bf16 v[0:3], v[80:83], v[128:131], v[0:3]
    v_mfma_f32_16x16x32_bf16 v[0:3], v[192:195], v[144:147], v[0:3]
    v_mfma_f32_16x16x32_bf16 v[4:7], v[192:195], v[148:151], v[4:7]
    v_mfma_f32_16x16x32_bf16 v[4:7], v[80:83], v[132:135], v[4:7]
    v_mfma_f32_16x16x32_bf16 v[8:11], v[80:83], v[136:139], v[8:11]
    v_mfma_f32_16x16x32_bf16 v[8:11], v[192:195], v[152:155], v[8:11]
    s_waitcnt lgkmcnt(0)
    s_barrier
    v_mfma_f32_16x16x32_bf16 v[12:15], v[192:195], v[156:159], v[12:15]
    ds_read_b64_tr_b16 v[112:113], v240 offset:57344
    v_mfma_f32_16x16x32_bf16 v[12:15], v[80:83], v[140:143], v[12:15]
    ds_read_b64_tr_b16 v[114:115], v240 offset:61440
    v_mfma_f32_16x16x32_bf16 v[28:31], v[100:103], v[140:143], v[28:31]
    ds_read_b64_tr_b16 v[176:177], v246 offset:0
    v_mfma_f32_16x16x32_bf16 v[28:31], v[196:199], v[156:159], v[28:31]
    ds_read_b64_tr_b16 v[178:179], v246 offset:4096
    v_mfma_f32_16x16x32_bf16 v[24:27], v[196:199], v[152:155], v[24:27]
    ds_read_b128 v[64:67], v232 offset:16384
    v_mfma_f32_16x16x32_bf16 v[24:27], v[100:103], v[136:139], v[24:27]
    ds_read_b128 v[84:87], v232 offset:49152
    v_mfma_f32_16x16x32_bf16 v[20:23], v[100:103], v[132:135], v[20:23]
    ds_read_b128 v[68:71], v232 offset:17408
    v_mfma_f32_16x16x32_bf16 v[20:23], v[196:199], v[148:151], v[20:23]
    ds_read_b128 v[88:91], v232 offset:50176
    v_mfma_f32_16x16x32_bf16 v[16:19], v[196:199], v[144:147], v[16:19]
    ds_read_b128 v[72:75], v232 offset:18432
    v_mfma_f32_16x16x32_bf16 v[16:19], v[100:103], v[128:131], v[16:19]
    ds_read_b128 v[92:95], v232 offset:51200
    v_mfma_f32_16x16x32_bf16 v[32:35], v[104:107], v[128:131], v[32:35]
    ds_read_b128 v[76:79], v232 offset:19456
    v_mfma_f32_16x16x32_bf16 v[32:35], v[200:203], v[144:147], v[32:35]
    ds_read_b128 v[96:99], v232 offset:52224
    v_mfma_f32_16x16x32_bf16 v[36:39], v[200:203], v[148:151], v[36:39]
    ds_read_b64_tr_b16 v[116:117], v241 offset:57344
    v_mfma_f32_16x16x32_bf16 v[36:39], v[104:107], v[132:135], v[36:39]
    ds_read_b64_tr_b16 v[118:119], v241 offset:61440
    v_mfma_f32_16x16x32_bf16 v[40:43], v[104:107], v[136:139], v[40:43]
    ds_read_b64_tr_b16 v[180:181], v247 offset:0
    v_mfma_f32_16x16x32_bf16 v[40:43], v[200:203], v[152:155], v[40:43]
    ds_read_b64_tr_b16 v[182:183], v247 offset:4096
    v_mfma_f32_16x16x32_bf16 v[44:47], v[200:203], v[156:159], v[44:47]
    ds_read_b64_tr_b16 v[120:121], v242 offset:57344
    v_mfma_f32_16x16x32_bf16 v[44:47], v[104:107], v[140:143], v[44:47]
    ds_read_b64_tr_b16 v[122:123], v242 offset:61440
    v_mfma_f32_16x16x32_bf16 v[60:63], v[108:111], v[140:143], v[60:63]
    ds_read_b64_tr_b16 v[184:185], v248 offset:0
    v_mfma_f32_16x16x32_bf16 v[60:63], v[204:207], v[156:159], v[60:63]
    ds_read_b64_tr_b16 v[186:187], v248 offset:4096
    v_mfma_f32_16x16x32_bf16 v[56:59], v[204:207], v[152:155], v[56:59]
    ds_read_b64_tr_b16 v[124:125], v243 offset:57344
    v_mfma_f32_16x16x32_bf16 v[56:59], v[108:111], v[136:139], v[56:59]
    ds_read_b64_tr_b16 v[126:127], v243 offset:61440
    v_mfma_f32_16x16x32_bf16 v[52:55], v[108:111], v[132:135], v[52:55]
    ds_read_b64_tr_b16 v[188:189], v249 offset:0
    v_mfma_f32_16x16x32_bf16 v[52:55], v[204:207], v[148:151], v[52:55]
    ds_read_b64_tr_b16 v[190:191], v249 offset:4096
    v_mfma_f32_16x16x32_bf16 v[48:51], v[204:207], v[144:147], v[48:51]
    v_mfma_f32_16x16x32_bf16 v[48:51], v[108:111], v[128:131], v[48:51]
    s_waitcnt lgkmcnt(12)
    s_nop 0
    v_mfma_f32_16x16x32_bf16 v[0:3], v[112:115], v[64:67], v[0:3]
    v_mfma_f32_16x16x32_bf16 v[0:3], v[176:179], v[84:87], v[0:3]
    v_mfma_f32_16x16x32_bf16 v[4:7], v[176:179], v[88:91], v[4:7]
    v_mfma_f32_16x16x32_bf16 v[4:7], v[112:115], v[68:71], v[4:7]
    v_mfma_f32_16x16x32_bf16 v[8:11], v[112:115], v[72:75], v[8:11]
    v_mfma_f32_16x16x32_bf16 v[8:11], v[176:179], v[92:95], v[8:11]
    s_waitcnt lgkmcnt(0)
    s_barrier
    v_mfma_f32_16x16x32_bf16 v[12:15], v[176:179], v[96:99], v[12:15]
    ds_read_b64_tr_b16 v[80:81], v246 offset:8192
    ds_read_b64_tr_b16 v[82:83], v246 offset:12288
    v_mfma_f32_16x16x32_bf16 v[12:15], v[112:115], v[76:79], v[12:15]
    ds_read_b64_tr_b16 v[192:193], v246 offset:16384
    ds_read_b64_tr_b16 v[194:195], v246 offset:20480
    v_mfma_f32_16x16x32_bf16 v[28:31], v[116:119], v[76:79], v[28:31]
    ds_read_b128 v[128:131], v232 offset:24576
    v_mfma_f32_16x16x32_bf16 v[28:31], v[180:183], v[96:99], v[28:31]
    ds_read_b64 v[144:145], v245 offset:24576
    v_mfma_f32_16x16x32_bf16 v[24:27], v[180:183], v[92:95], v[24:27]
    ds_read_b64 v[146:147], v245 offset:25088
    v_mfma_f32_16x16x32_bf16 v[24:27], v[116:119], v[72:75], v[24:27]
    ds_read_b128 v[132:135], v232 offset:25600
    v_mfma_f32_16x16x32_bf16 v[20:23], v[116:119], v[68:71], v[20:23]
    ds_read_b64 v[148:149], v245 offset:25600
    v_mfma_f32_16x16x32_bf16 v[20:23], v[180:183], v[88:91], v[20:23]
    ds_read_b64 v[150:151], v245 offset:26112
    v_mfma_f32_16x16x32_bf16 v[16:19], v[180:183], v[84:87], v[16:19]
    ds_read_b128 v[136:139], v232 offset:26624
    v_mfma_f32_16x16x32_bf16 v[16:19], v[116:119], v[64:67], v[16:19]
    ds_read_b64 v[152:153], v245 offset:26624
    v_mfma_f32_16x16x32_bf16 v[32:35], v[120:123], v[64:67], v[32:35]
    ds_read_b64 v[154:155], v245 offset:27136
    v_mfma_f32_16x16x32_bf16 v[32:35], v[184:187], v[84:87], v[32:35]
    ds_read_b128 v[140:143], v232 offset:27648
    v_mfma_f32_16x16x32_bf16 v[36:39], v[184:187], v[88:91], v[36:39]
    ds_read_b64 v[156:157], v245 offset:27648
    v_mfma_f32_16x16x32_bf16 v[36:39], v[120:123], v[68:71], v[36:39]
    ds_read_b64 v[158:159], v245 offset:28160
    v_mfma_f32_16x16x32_bf16 v[40:43], v[120:123], v[72:75], v[40:43]
    ds_read_b64_tr_b16 v[100:101], v247 offset:8192
    v_mfma_f32_16x16x32_bf16 v[40:43], v[184:187], v[92:95], v[40:43]
    ds_read_b64_tr_b16 v[102:103], v247 offset:12288
    v_mfma_f32_16x16x32_bf16 v[44:47], v[184:187], v[96:99], v[44:47]
    ds_read_b64_tr_b16 v[196:197], v247 offset:16384
    v_mfma_f32_16x16x32_bf16 v[44:47], v[120:123], v[76:79], v[44:47]
    ds_read_b64_tr_b16 v[198:199], v247 offset:20480
    v_mfma_f32_16x16x32_bf16 v[60:63], v[124:127], v[76:79], v[60:63]
    ds_read_b64_tr_b16 v[104:105], v248 offset:8192
    v_mfma_f32_16x16x32_bf16 v[60:63], v[188:191], v[96:99], v[60:63]
    ds_read_b64_tr_b16 v[106:107], v248 offset:12288
    v_mfma_f32_16x16x32_bf16 v[56:59], v[188:191], v[92:95], v[56:59]
    ds_read_b64_tr_b16 v[200:201], v248 offset:16384
    v_mfma_f32_16x16x32_bf16 v[56:59], v[124:127], v[72:75], v[56:59]
    ds_read_b64_tr_b16 v[202:203], v248 offset:20480
    v_mfma_f32_16x16x32_bf16 v[52:55], v[124:127], v[68:71], v[52:55]
    ds_read_b64_tr_b16 v[108:109], v249 offset:8192
    v_mfma_f32_16x16x32_bf16 v[52:55], v[188:191], v[88:91], v[52:55]
    ds_read_b64_tr_b16 v[110:111], v249 offset:12288
    v_mfma_f32_16x16x32_bf16 v[48:51], v[188:191], v[84:87], v[48:51]
    ds_read_b64_tr_b16 v[204:205], v249 offset:16384
    v_mfma_f32_16x16x32_bf16 v[48:51], v[124:127], v[64:67], v[48:51]
    ds_read_b64_tr_b16 v[206:207], v249 offset:20480
    s_waitcnt lgkmcnt(12)
    s_nop 0
    v_mfma_f32_16x16x32_bf16 v[0:3], v[80:83], v[128:131], v[0:3]
    v_mfma_f32_16x16x32_bf16 v[0:3], v[192:195], v[144:147], v[0:3]
    v_mfma_f32_16x16x32_bf16 v[4:7], v[192:195], v[148:151], v[4:7]
    v_mfma_f32_16x16x32_bf16 v[4:7], v[80:83], v[132:135], v[4:7]
    v_mfma_f32_16x16x32_bf16 v[8:11], v[80:83], v[136:139], v[8:11]
    v_mfma_f32_16x16x32_bf16 v[8:11], v[192:195], v[152:155], v[8:11]
    s_waitcnt lgkmcnt(0)
    s_barrier
    v_mfma_f32_16x16x32_bf16 v[12:15], v[192:195], v[156:159], v[12:15]
    ds_read_b64_tr_b16 v[112:113], v234 offset:57344
    v_mfma_f32_16x16x32_bf16 v[12:15], v[80:83], v[140:143], v[12:15]
    ds_read_b64_tr_b16 v[114:115], v234 offset:61440
    v_mfma_f32_16x16x32_bf16 v[28:31], v[100:103], v[140:143], v[28:31]
    ds_read_b64_tr_b16 v[176:177], v240 offset:0
    v_mfma_f32_16x16x32_bf16 v[28:31], v[196:199], v[156:159], v[28:31]
    ds_read_b64_tr_b16 v[178:179], v240 offset:4096
    v_mfma_f32_16x16x32_bf16 v[24:27], v[196:199], v[152:155], v[24:27]
    ds_read_b128 v[64:67], v232 offset:0
    v_mfma_f32_16x16x32_bf16 v[24:27], v[100:103], v[136:139], v[24:27]
    ds_read_b128 v[84:87], v232 offset:32768
    v_mfma_f32_16x16x32_bf16 v[20:23], v[100:103], v[132:135], v[20:23]
    ds_read_b128 v[68:71], v232 offset:1024
    v_mfma_f32_16x16x32_bf16 v[20:23], v[196:199], v[148:151], v[20:23]
    ds_read_b128 v[88:91], v232 offset:33792
    v_mfma_f32_16x16x32_bf16 v[16:19], v[196:199], v[144:147], v[16:19]
    ds_read_b128 v[72:75], v232 offset:2048
    v_mfma_f32_16x16x32_bf16 v[16:19], v[100:103], v[128:131], v[16:19]
    ds_read_b128 v[92:95], v232 offset:34816
    v_mfma_f32_16x16x32_bf16 v[32:35], v[104:107], v[128:131], v[32:35]
    ds_read_b128 v[76:79], v232 offset:3072
    v_mfma_f32_16x16x32_bf16 v[32:35], v[200:203], v[144:147], v[32:35]
    ds_read_b128 v[96:99], v232 offset:35840
    v_mfma_f32_16x16x32_bf16 v[36:39], v[200:203], v[148:151], v[36:39]
    ds_read_b64_tr_b16 v[116:117], v235 offset:57344
    v_mfma_f32_16x16x32_bf16 v[36:39], v[104:107], v[132:135], v[36:39]
    ds_read_b64_tr_b16 v[118:119], v235 offset:61440
    v_mfma_f32_16x16x32_bf16 v[40:43], v[104:107], v[136:139], v[40:43]
    ds_read_b64_tr_b16 v[180:181], v241 offset:0
    v_mfma_f32_16x16x32_bf16 v[40:43], v[200:203], v[152:155], v[40:43]
    ds_read_b64_tr_b16 v[182:183], v241 offset:4096
    v_mfma_f32_16x16x32_bf16 v[44:47], v[200:203], v[156:159], v[44:47]
    ds_read_b64_tr_b16 v[120:121], v236 offset:57344
    v_mfma_f32_16x16x32_bf16 v[44:47], v[104:107], v[140:143], v[44:47]
    ds_read_b64_tr_b16 v[122:123], v236 offset:61440
    v_mfma_f32_16x16x32_bf16 v[60:63], v[108:111], v[140:143], v[60:63]
    ds_read_b64_tr_b16 v[184:185], v242 offset:0
    v_mfma_f32_16x16x32_bf16 v[60:63], v[204:207], v[156:159], v[60:63]
    ds_read_b64_tr_b16 v[186:187], v242 offset:4096
    v_mfma_f32_16x16x32_bf16 v[56:59], v[204:207], v[152:155], v[56:59]
    ds_read_b64_tr_b16 v[124:125], v237 offset:57344
    v_mfma_f32_16x16x32_bf16 v[56:59], v[108:111], v[136:139], v[56:59]
    ds_read_b64_tr_b16 v[126:127], v237 offset:61440
    v_mfma_f32_16x16x32_bf16 v[52:55], v[108:111], v[132:135], v[52:55]
    ds_read_b64_tr_b16 v[188:189], v243 offset:0
    v_mfma_f32_16x16x32_bf16 v[52:55], v[204:207], v[148:151], v[52:55]
    ds_read_b64_tr_b16 v[190:191], v243 offset:4096
    v_mfma_f32_16x16x32_bf16 v[48:51], v[204:207], v[144:147], v[48:51]
    v_mfma_f32_16x16x32_bf16 v[48:51], v[108:111], v[128:131], v[48:51]
    s_waitcnt lgkmcnt(12)
    s_nop 0
    v_mfma_f32_16x16x32_bf16 v[0:3], v[112:115], v[64:67], v[0:3]
    v_mfma_f32_16x16x32_bf16 v[0:3], v[176:179], v[84:87], v[0:3]
    v_mfma_f32_16x16x32_bf16 v[4:7], v[176:179], v[88:91], v[4:7]
    v_mfma_f32_16x16x32_bf16 v[4:7], v[112:115], v[68:71], v[4:7]
    v_mfma_f32_16x16x32_bf16 v[8:11], v[112:115], v[72:75], v[8:11]
    v_mfma_f32_16x16x32_bf16 v[8:11], v[176:179], v[92:95], v[8:11]
    s_waitcnt lgkmcnt(0)
    s_barrier
    v_mfma_f32_16x16x32_bf16 v[12:15], v[176:179], v[96:99], v[12:15]
    ds_read_b64_tr_b16 v[80:81], v240 offset:8192
    v_mfma_f32_16x16x32_bf16 v[12:15], v[112:115], v[76:79], v[12:15]
    ds_read_b64_tr_b16 v[82:83], v240 offset:12288
    v_mfma_f32_16x16x32_bf16 v[28:31], v[116:119], v[76:79], v[28:31]
    ds_read_b64_tr_b16 v[192:193], v240 offset:16384
    v_mfma_f32_16x16x32_bf16 v[28:31], v[180:183], v[96:99], v[28:31]
    ds_read_b64_tr_b16 v[194:195], v240 offset:20480
    v_mfma_f32_16x16x32_bf16 v[24:27], v[180:183], v[92:95], v[24:27]
    ds_read_b128 v[128:131], v232 offset:8192
    v_mfma_f32_16x16x32_bf16 v[24:27], v[116:119], v[72:75], v[24:27]
    ds_read_b128 v[144:147], v232 offset:40960
    v_mfma_f32_16x16x32_bf16 v[20:23], v[116:119], v[68:71], v[20:23]
    ds_read_b128 v[132:135], v232 offset:9216
    v_mfma_f32_16x16x32_bf16 v[20:23], v[180:183], v[88:91], v[20:23]
    ds_read_b128 v[148:151], v232 offset:41984
    v_mfma_f32_16x16x32_bf16 v[16:19], v[180:183], v[84:87], v[16:19]
    ds_read_b128 v[136:139], v232 offset:10240
    v_mfma_f32_16x16x32_bf16 v[16:19], v[116:119], v[64:67], v[16:19]
    ds_read_b128 v[152:155], v232 offset:43008
    v_mfma_f32_16x16x32_bf16 v[32:35], v[120:123], v[64:67], v[32:35]
    ds_read_b128 v[140:143], v232 offset:11264
    v_mfma_f32_16x16x32_bf16 v[32:35], v[184:187], v[84:87], v[32:35]
    ds_read_b128 v[156:159], v232 offset:44032
    v_mfma_f32_16x16x32_bf16 v[36:39], v[184:187], v[88:91], v[36:39]
    ds_read_b64_tr_b16 v[100:101], v241 offset:8192
    v_mfma_f32_16x16x32_bf16 v[36:39], v[120:123], v[68:71], v[36:39]
    ds_read_b64_tr_b16 v[102:103], v241 offset:12288
    v_mfma_f32_16x16x32_bf16 v[40:43], v[120:123], v[72:75], v[40:43]
    ds_read_b64_tr_b16 v[196:197], v241 offset:16384
    v_mfma_f32_16x16x32_bf16 v[40:43], v[184:187], v[92:95], v[40:43]
    ds_read_b64_tr_b16 v[198:199], v241 offset:20480
    v_mfma_f32_16x16x32_bf16 v[44:47], v[184:187], v[96:99], v[44:47]
    ds_read_b64_tr_b16 v[104:105], v242 offset:8192
    v_mfma_f32_16x16x32_bf16 v[44:47], v[120:123], v[76:79], v[44:47]
    ds_read_b64_tr_b16 v[106:107], v242 offset:12288
    v_mfma_f32_16x16x32_bf16 v[60:63], v[124:127], v[76:79], v[60:63]
    ds_read_b64_tr_b16 v[200:201], v242 offset:16384
    v_mfma_f32_16x16x32_bf16 v[60:63], v[188:191], v[96:99], v[60:63]
    ds_read_b64_tr_b16 v[202:203], v242 offset:20480
    v_mfma_f32_16x16x32_bf16 v[56:59], v[188:191], v[92:95], v[56:59]
    ds_read_b64_tr_b16 v[108:109], v243 offset:8192
    v_mfma_f32_16x16x32_bf16 v[56:59], v[124:127], v[72:75], v[56:59]
    ds_read_b64_tr_b16 v[110:111], v243 offset:12288
    v_mfma_f32_16x16x32_bf16 v[52:55], v[124:127], v[68:71], v[52:55]
    ds_read_b64_tr_b16 v[204:205], v243 offset:16384
    v_mfma_f32_16x16x32_bf16 v[52:55], v[188:191], v[88:91], v[52:55]
    ds_read_b64_tr_b16 v[206:207], v243 offset:20480
    v_mfma_f32_16x16x32_bf16 v[48:51], v[188:191], v[84:87], v[48:51]
    v_mfma_f32_16x16x32_bf16 v[48:51], v[124:127], v[64:67], v[48:51]
    s_waitcnt lgkmcnt(12)
    s_nop 0
    v_mfma_f32_16x16x32_bf16 v[0:3], v[80:83], v[128:131], v[0:3]
    v_mfma_f32_16x16x32_bf16 v[0:3], v[192:195], v[144:147], v[0:3]
    v_mfma_f32_16x16x32_bf16 v[4:7], v[192:195], v[148:151], v[4:7]
    v_mfma_f32_16x16x32_bf16 v[4:7], v[80:83], v[132:135], v[4:7]
    v_mfma_f32_16x16x32_bf16 v[8:11], v[80:83], v[136:139], v[8:11]
    v_mfma_f32_16x16x32_bf16 v[8:11], v[192:195], v[152:155], v[8:11]
    s_waitcnt lgkmcnt(0)
    s_barrier
    v_mfma_f32_16x16x32_bf16 v[12:15], v[192:195], v[156:159], v[12:15]
    ds_read_b64_tr_b16 v[112:113], v240 offset:24576
    ds_read_b64_tr_b16 v[114:115], v240 offset:28672
    v_mfma_f32_16x16x32_bf16 v[12:15], v[80:83], v[140:143], v[12:15]
    ds_read_b64_tr_b16 v[176:177], v240 offset:32768
    ds_read_b64_tr_b16 v[178:179], v240 offset:36864
    v_mfma_f32_16x16x32_bf16 v[28:31], v[100:103], v[140:143], v[28:31]
    ds_read_b64 v[64:65], v233 offset:16384
    v_mfma_f32_16x16x32_bf16 v[28:31], v[196:199], v[156:159], v[28:31]
    ds_read_b64 v[66:67], v233 offset:16896
    v_mfma_f32_16x16x32_bf16 v[24:27], v[196:199], v[152:155], v[24:27]
    ds_read_b128 v[84:87], v232 offset:49152
    v_mfma_f32_16x16x32_bf16 v[24:27], v[100:103], v[136:139], v[24:27]
    ds_read_b64 v[68:69], v233 offset:17408
    v_mfma_f32_16x16x32_bf16 v[20:23], v[100:103], v[132:135], v[20:23]
    ds_read_b64 v[70:71], v233 offset:17920
    v_mfma_f32_16x16x32_bf16 v[20:23], v[196:199], v[148:151], v[20:23]
    ds_read_b128 v[88:91], v232 offset:50176
    v_mfma_f32_16x16x32_bf16 v[16:19], v[196:199], v[144:147], v[16:19]
    ds_read_b64 v[72:73], v233 offset:18432
L_wp5:
    s_cbranch_vccnz L_warm_done
    s_nop 0
    v_mfma_f32_16x16x32_bf16 v[16:19], v[100:103], v[128:131], v[16:19]
    ds_read_b64 v[74:75], v233 offset:18944
    v_mfma_f32_16x16x32_bf16 v[32:35], v[104:107], v[128:131], v[32:35]
    ds_read_b128 v[92:95], v232 offset:51200
    v_mfma_f32_16x16x32_bf16 v[32:35], v[200:203], v[144:147], v[32:35]
    ds_read_b64 v[76:77], v233 offset:19456
    v_mfma_f32_16x16x32_bf16 v[36:39], v[200:203], v[148:151], v[36:39]
    ds_read_b64 v[78:79], v233 offset:19968
    v_mfma_f32_16x16x32_bf16 v[36:39], v[104:107], v[132:135], v[36:39]
    ds_read_b128 v[96:99], v232 offset:52224
    v_mfma_f32_16x16x32_bf16 v[40:43], v[104:107], v[136:139], v[40:43]
    ds_read_b64_tr_b16 v[116:117], v241 offset:24576
    v_mfma_f32_16x16x32_bf16 v[40:43], v[200:203], v[152:155], v[40:43]
    ds_read_b64_tr_b16 v[118:119], v241 offset:28672
    v_mfma_f32_16x16x32_bf16 v[44:47], v[200:203], v[156:159], v[44:47]
    ds_read_b64_tr_b16 v[180:181], v241 offset:32768
    v_mfma_f32_16x16x32_bf16 v[44:47], v[104:107], v[140:143], v[44:47]
    ds_read_b64_tr_b16 v[182:183], v241 offset:36864
    v_mfma_f32_16x16x32_bf16 v[60:63], v[108:111], v[140:143], v[60:63]
    ds_read_b64_tr_b16 v[120:121], v242 offset:24576
    v_mfma_f32_16x16x32_bf16 v[60:63], v[204:207], v[156:159], v[60:63]
    ds_read_b64_tr_b16 v[122:123], v242 offset:28672
    v_mfma_f32_16x16x32_bf16 v[56:59], v[204:207], v[152:155], v[56:59]
    ds_read_b64_tr_b16 v[184:185], v242 offset:32768
    v_mfma_f32_16x16x32_bf16 v[56:59], v[108:111], v[136:139], v[56:59]
    ds_read_b64_tr_b16 v[186:187], v242 offset:36864
    v_mfma_f32_16x16x32_bf16 v[52:55], v[108:111], v[132:135], v[52:55]
    ds_read_b64_tr_b16 v[124:125], v243 offset:24576
    v_mfma_f32_16x16x32_bf16 v[52:55], v[204:207], v[148:151], v[52:55]
    ds_read_b64_tr_b16 v[126:127], v243 offset:28672
    v_mfma_f32_16x16x32_bf16 v[48:51], v[204:207], v[144:147], v[48:51]
    ds_read_b64_tr_b16 v[188:189], v243 offset:32768
    v_mfma_f32_16x16x32_bf16 v[48:51], v[108:111], v[128:131], v[48:51]
    ds_read_b64_tr_b16 v[190:191], v243 offset:36864
    s_waitcnt lgkmcnt(12)
    s_nop 0
    v_mfma_f32_16x16x32_bf16 v[0:3], v[112:115], v[64:67], v[0:3]
    v_mfma_f32_16x16x32_bf16 v[0:3], v[176:179], v[84:87], v[0:3]
    v_mfma_f32_16x16x32_bf16 v[4:7], v[176:179], v[88:91], v[4:7]
    v_mfma_f32_16x16x32_bf16 v[4:7], v[112:115], v[68:71], v[4:7]
    v_mfma_f32_16x16x32_bf16 v[8:11], v[112:115], v[72:75], v[8:11]
    v_mfma_f32_16x16x32_bf16 v[8:11], v[176:179], v[92:95], v[8:11]
    s_waitcnt lgkmcnt(0)
    s_barrier
    v_mfma_f32_16x16x32_bf16 v[12:15], v[176:179], v[96:99], v[12:15]
    ds_read_b64_tr_b16 v[80:81], v240 offset:40960
    v_mfma_f32_16x16x32_bf16 v[12:15], v[112:115], v[76:79], v[12:15]
    ds_read_b64_tr_b16 v[82:83], v240 offset:45056
    v_mfma_f32_16x16x32_bf16 v[28:31], v[116:119], v[76:79], v[28:31]
    ds_read_b64_tr_b16 v[192:193], v240 offset:49152
    v_mfma_f32_16x16x32_bf16 v[28:31], v[180:183], v[96:99], v[28:31]
    ds_read_b64_tr_b16 v[194:195], v240 offset:53248
    v_mfma_f32_16x16x32_bf16 v[24:27], v[180:183], v[92:95], v[24:27]
    ds_read_b128 v[128:131], v232 offset:24576
    v_mfma_f32_16x16x32_bf16 v[24:27], v[116:119], v[72:75], v[24:27]
    ds_read_b128 v[144:147], v244 offset:24576
    v_mfma_f32_16x16x32_bf16 v[20:23], v[116:119], v[68:71], v[20:23]
    ds_read_b128 v[132:135], v232 offset:25600
    v_mfma_f32_16x16x32_bf16 v[20:23], v[180:183], v[88:91], v[20:23]
    ds_read_b128 v[148:151], v244 offset:25600
    v_mfma_f32_16x16x32_bf16 v[16:19], v[180:183], v[84:87], v[16:19]
    ds_read_b128 v[136:139], v232 offset:26624
    v_mfma_f32_16x16x32_bf16 v[16:19], v[116:119], v[64:67], v[16:19]
    ds_read_b128 v[152:155], v244 offset:26624
    v_mfma_f32_16x16x32_bf16 v[32:35], v[120:123], v[64:67], v[32:35]
    ds_read_b128 v[140:143], v232 offset:27648
    v_mfma_f32_16x16x32_bf16 v[32:35], v[184:187], v[84:87], v[32:35]
    ds_read_b128 v[156:159], v244 offset:27648
    v_mfma_f32_16x16x32_bf16 v[36:39], v[184:187], v[88:91], v[36:39]
    ds_read_b64_tr_b16 v[100:101], v241 offset:40960
    v_mfma_f32_16x16x32_bf16 v[36:39], v[120:123], v[68:71], v[36:39]
    ds_read_b64_tr_b16 v[102:103], v241 offset:45056
    v_mfma_f32_16x16x32_bf16 v[40:43], v[120:123], v[72:75], v[40:43]
    ds_read_b64_tr_b16 v[196:197], v241 offset:49152
    v_mfma_f32_16x16x32_bf16 v[40:43], v[184:187], v[92:95], v[40:43]
    ds_read_b64_tr_b16 v[198:199], v241 offset:53248
    v_mfma_f32_16x16x32_bf16 v[44:47], v[184:187], v[96:99], v[44:47]
    ds_read_b64_tr_b16 v[104:105], v242 offset:40960
    v_mfma_f32_16x16x32_bf16 v[44:47], v[120:123], v[76:79], v[44:47]
    ds_read_b64_tr_b16 v[106:107], v242 offset:45056
    v_mfma_f32_16x16x32_bf16 v[60:63], v[124:127], v[76:79], v[60:63]
    ds_read_b64_tr_b16 v[200:201], v242 offset:49152
    v_mfma_f32_16x16x32_bf16 v[60:63], v[188:191], v[96:99], v[60:63]
    ds_read_b64_tr_b16 v[202:203], v242 offset:53248
    v_mfma_f32_16x16x32_bf16 v[56:59], v[188:191], v[92:95], v[56:59]
    ds_read_b64_tr_b16 v[108:109], v243 offset:40960
    v_mfma_f32_16x16x32_bf16 v[56:59], v[124:127], v[72:75], v[56:59]
    ds_read_b64_tr_b16 v[110:111], v243 offset:45056
    v_mfma_f32_16x16x32_bf16 v[52:55], v[124:127], v[68:71], v[52:55]
    ds_read_b64_tr_b16 v[204:205], v243 offset:49152
    v_mfma_f32_16x16x32_bf16 v[52:55], v[188:191], v[88:91], v[52:55]
    ds_read_b64_tr_b16 v[206:207], v243 offset:53248
    v_mfma_f32_16x16x32_bf16 v[48:51], v[188:191], v[84:87], v[48:51]
    v_mfma_f32_16x16x32_bf16 v[48:51], v[124:127], v[64:67], v[48:51]
    s_waitcnt lgkmcnt(12)
    s_nop 0
    v_mfma_f32_16x16x32_bf16 v[0:3], v[80:83], v[128:131], v[0:3]
    v_mfma_f32_16x16x32_bf16 v[0:3], v[192:195], v[144:147], v[0:3]
    v_mfma_f32_16x16x32_bf16 v[4:7], v[192:195], v[148:151], v[4:7]
    v_mfma_f32_16x16x32_bf16 v[4:7], v[80:83], v[132:135], v[4:7]
    v_mfma_f32_16x16x32_bf16 v[8:11], v[80:83], v[136:139], v[8:11]
    v_mfma_f32_16x16x32_bf16 v[8:11], v[192:195], v[152:155], v[8:11]
    s_waitcnt lgkmcnt(0)
    s_barrier
    v_mfma_f32_16x16x32_bf16 v[12:15], v[192:195], v[156:159], v[12:15]
    ds_read_b64_tr_b16 v[112:113], v240 offset:57344
    ds_read_b64_tr_b16 v[114:115], v240 offset:61440
    v_mfma_f32_16x16x32_bf16 v[12:15], v[80:83], v[140:143], v[12:15]
    ds_read_b64_tr_b16 v[176:177], v246 offset:0
    ds_read_b64_tr_b16 v[178:179], v246 offset:4096
    v_mfma_f32_16x16x32_bf16 v[28:31], v[100:103], v[140:143], v[28:31]
    ds_read_b128 v[64:67], v232 offset:0
    v_mfma_f32_16x16x32_bf16 v[28:31], v[196:199], v[156:159], v[28:31]
    ds_read_b64 v[84:85], v233 offset:32768
    v_mfma_f32_16x16x32_bf16 v[24:27], v[196:199], v[152:155], v[24:27]
    ds_read_b64 v[86:87], v233 offset:33280
    v_mfma_f32_16x16x32_bf16 v[24:27], v[100:103], v[136:139], v[24:27]
    ds_read_b128 v[68:71], v232 offset:1024
    v_mfma_f32_16x16x32_bf16 v[20:23], v[100:103], v[132:135], v[20:23]
    ds_read_b64 v[88:89], v233 offset:33792
    v_mfma_f32_16x16x32_bf16 v[20:23], v[196:199], v[148:151], v[20:23]
    ds_read_b64 v[90:91], v233 offset:34304
    v_mfma_f32_16x16x32_bf16 v[16:19], v[196:199], v[144:147], v[16:19]
    ds_read_b128 v[72:75], v232 offset:2048
    v_mfma_f32_16x16x32_bf16 v[16:19], v[100:103], v[128:131], v[16:19]
    ds_read_b64 v[92:93], v233 offset:34816
    v_mfma_f32_16x16x32_bf16 v[32:35], v[104:107], v[128:131], v[32:35]
    ds_read_b64 v[94:95], v233 offset:35328
    v_mfma_f32_16x16x32_bf16 v[32:35], v[200:203], v[144:147], v[32:35]
    ds_read_b128 v[76:79], v232 offset:3072
    v_mfma_f32_16x16x32_bf16 v[36:39], v[200:203], v[148:151], v[36:39]
    ds_read_b64 v[96:97], v233 offset:35840
    v_mfma_f32_16x16x32_bf16 v[36:39], v[104:107], v[132:135], v[36:39]
    ds_read_b64 v[98:99], v233 offset:36352
    v_mfma_f32_16x16x32_bf16 v[40:43], v[104:107], v[136:139], v[40:43]
    ds_read_b64_tr_b16 v[116:117], v241 offset:57344
    v_mfma_f32_16x16x32_bf16 v[40:43], v[200:203], v[152:155], v[40:43]
    ds_read_b64_tr_b16 v[118:119], v241 offset:61440
    v_mfma_f32_16x16x32_bf16 v[44:47], v[200:203], v[156:159], v[44:47]
    ds_read_b64_tr_b16 v[180:181], v247 offset:0
    v_mfma_f32_16x16x32_bf16 v[44:47], v[104:107], v[140:143], v[44:47]
    ds_read_b64_tr_b16 v[182:183], v247 offset:4096
    v_mfma_f32_16x16x32_bf16 v[60:63], v[108:111], v[140:143], v[60:63]
    ds_read_b64_tr_b16 v[120:121], v242 offset:57344
    v_mfma_f32_16x16x32_bf16 v[60:63], v[204:207], v[156:159], v[60:63]
    ds_read_b64_tr_b16 v[122:123], v242 offset:61440
    v_mfma_f32_16x16x32_bf16 v[56:59], v[204:207], v[152:155], v[56:59]
    ds_read_b64_tr_b16 v[184:185], v248 offset:0
    v_mfma_f32_16x16x32_bf16 v[56:59], v[108:111], v[136:139], v[56:59]
    ds_read_b64_tr_b16 v[186:187], v248 offset:4096
    v_mfma_f32_16x16x32_bf16 v[52:55], v[108:111], v[132:135], v[52:55]
    ds_read_b64_tr_b16 v[124:125], v243 offset:57344
    v_mfma_f32_16x16x32_bf16 v[52:55], v[204:207], v[148:151], v[52:55]
    ds_read_b64_tr_b16 v[126:127], v243 offset:61440
    v_mfma_f32_16x16x32_bf16 v[48:51], v[204:207], v[144:147], v[48:51]
    ds_read_b64_tr_b16 v[188:189], v249 offset:0
    v_mfma_f32_16x16x32_bf16 v[48:51], v[108:111], v[128:131], v[48:51]
    ds_read_b64_tr_b16 v[190:191], v249 offset:4096
    s_waitcnt lgkmcnt(12)
    s_nop 0
    v_mfma_f32_16x16x32_bf16 v[0:3], v[112:115], v[64:67], v[0:3]
    v_mfma_f32_16x16x32_bf16 v[0:3], v[176:179], v[84:87], v[0:3]
    v_mfma_f32_16x16x32_bf16 v[4:7], v[176:179], v[88:91], v[4:7]
    v_mfma_f32_16x16x32_bf16 v[4:7], v[112:115], v[68:71], v[4:7]
    v_mfma_f32_16x16x32_bf16 v[8:11], v[112:115], v[72:75], v[8:11]
    v_mfma_f32_16x16x32_bf16 v[8:11], v[176:179], v[92:95], v[8:11]
    s_waitcnt lgkmcnt(0)
    s_barrier
    v_mfma_f32_16x16x32_bf16 v[12:15], v[176:179], v[96:99], v[12:15]
    ds_read_b64_tr_b16 v[80:81], v246 offset:8192
    v_mfma_f32_16x16x32_bf16 v[12:15], v[112:115], v[76:79], v[12:15]
    ds_read_b64_tr_b16 v[82:83], v246 offset:12288
    v_mfma_f32_16x16x32_bf16 v[28:31], v[116:119], v[76:79], v[28:31]
    ds_read_b64_tr_b16 v[192:193], v246 offset:16384
    v_mfma_f32_16x16x32_bf16 v[28:31], v[180:183], v[96:99], v[28:31]
    ds_read_b64_tr_b16 v[194:195], v246 offset:20480
    v_mfma_f32_16x16x32_bf16 v[24:27], v[180:183], v[92:95], v[24:27]
    ds_read_b128 v[128:131], v232 offset:8192
    v_mfma_f32_16x16x32_bf16 v[24:27], v[116:119], v[72:75], v[24:27]
    ds_read_b128 v[144:147], v232 offset:40960
    v_mfma_f32_16x16x32_bf16 v[20:23], v[116:119], v[68:71], v[20:23]
    ds_read_b128 v[132:135], v232 offset:9216
    v_mfma_f32_16x16x32_bf16 v[20:23], v[180:183], v[88:91], v[20:23]
    ds_read_b128 v[148:151], v232 offset:41984
    v_mfma_f32_16x16x32_bf16 v[16:19], v[180:183], v[84:87], v[16:19]
    ds_read_b128 v[136:139], v232 offset:10240
    v_mfma_f32_16x16x32_bf16 v[16:19], v[116:119], v[64:67], v[16:19]
    ds_read_b128 v[152:155], v232 offset:43008
    v_mfma_f32_16x16x32_bf16 v[32:35], v[120:123], v[64:67], v[32:35]
    ds_read_b128 v[140:143], v232 offset:11264
    v_mfma_f32_16x16x32_bf16 v[32:35], v[184:187], v[84:87], v[32:35]
    ds_read_b128 v[156:159], v232 offset:44032
    v_mfma_f32_16x16x32_bf16 v[36:39], v[184:187], v[88:91], v[36:39]
    ds_read_b64_tr_b16 v[100:101], v247 offset:8192
    v_mfma_f32_16x16x32_bf16 v[36:39], v[120:123], v[68:71], v[36:39]
    ds_read_b64_tr_b16 v[102:103], v247 offset:12288
    v_mfma_f32_16x16x32_bf16 v[40:43], v[120:123], v[72:75], v[40:43]
    ds_read_b64_tr_b16 v[196:197], v247 offset:16384
    v_mfma_f32_16x16x32_bf16 v[40:43], v[184:187], v[92:95], v[40:43]
    ds_read_b64_tr_b16 v[198:199], v247 offset:20480
    v_mfma_f32_16x16x32_bf16 v[44:47], v[184:187], v[96:99], v[44:47]
    ds_read_b64_tr_b16 v[104:105], v248 offset:8192
    v_mfma_f32_16x16x32_bf16 v[44:47], v[120:123], v[76:79], v[44:47]
    ds_read_b64_tr_b16 v[106:107], v248 offset:12288
    v_mfma_f32_16x16x32_bf16 v[60:63], v[124:127], v[76:79], v[60:63]
    ds_read_b64_tr_b16 v[200:201], v248 offset:16384
    v_mfma_f32_16x16x32_bf16 v[60:63], v[188:191], v[96:99], v[60:63]
    ds_read_b64_tr_b16 v[202:203], v248 offset:20480
    v_mfma_f32_16x16x32_bf16 v[56:59], v[188:191], v[92:95], v[56:59]
    ds_read_b64_tr_b16 v[108:109], v249 offset:8192
    v_mfma_f32_16x16x32_bf16 v[56:59], v[124:127], v[72:75], v[56:59]
    ds_read_b64_tr_b16 v[110:111], v249 offset:12288
    v_mfma_f32_16x16x32_bf16 v[52:55], v[124:127], v[68:71], v[52:55]
    ds_read_b64_tr_b16 v[204:205], v249 offset:16384
    v_mfma_f32_16x16x32_bf16 v[52:55], v[188:191], v[88:91], v[52:55]
    ds_read_b64_tr_b16 v[206:207], v249 offset:20480
    v_mfma_f32_16x16x32_bf16 v[48:51], v[188:191], v[84:87], v[48:51]
    v_mfma_f32_16x16x32_bf16 v[48:51], v[124:127], v[64:67], v[48:51]
    s_waitcnt lgkmcnt(12)
    s_nop 0
    v_mfma_f32_16x16x32_bf16 v[0:3], v[80:83], v[128:131], v[0:3]
    v_mfma_f32_16x16x32_bf16 v[0:3], v[192:195], v[144:147], v[0:3]
    v_mfma_f32_16x16x32_bf16 v[4:7], v[192:195], v[148:151], v[4:7]
    v_mfma_f32_16x16x32_bf16 v[4:7], v[80:83], v[132:135], v[4:7]
    v_mfma_f32_16x16x32_bf16 v[8:11], v[80:83], v[136:139], v[8:11]
    v_mfma_f32_16x16x32_bf16 v[8:11], v[192:195], v[152:155], v[8:11]
    s_waitcnt lgkmcnt(0)
    s_barrier
    v_mfma_f32_16x16x32_bf16 v[12:15], v[192:195], v[156:159], v[12:15]
    ds_read_b64_tr_b16 v[112:113], v234 offset:57344
    v_mfma_f32_16x16x32_bf16 v[12:15], v[80:83], v[140:143], v[12:15]
    ds_read_b64_tr_b16 v[114:115], v234 offset:61440
    v_mfma_f32_16x16x32_bf16 v[28:31], v[100:103], v[140:143], v[28:31]
    ds_read_b64_tr_b16 v[176:177], v240 offset:0
    v_mfma_f32_16x16x32_bf16 v[28:31], v[196:199], v[156:159], v[28:31]
    ds_read_b64_tr_b16 v[178:179], v240 offset:4096
    v_mfma_f32_16x16x32_bf16 v[24:27], v[196:199], v[152:155], v[24:27]
    ds_read_b128 v[64:67], v232 offset:16384
    v_mfma_f32_16x16x32_bf16 v[24:27], v[100:103], v[136:139], v[24:27]
    ds_read_b128 v[84:87], v232 offset:49152
    v_mfma_f32_16x16x32_bf16 v[20:23], v[100:103], v[132:135], v[20:23]
    ds_read_b128 v[68:71], v232 offset:17408
    v_mfma_f32_16x16x32_bf16 v[20:23], v[196:199], v[148:151], v[20:23]
    ds_read_b128 v[88:91], v232 offset:50176
    v_mfma_f32_16x16x32_bf16 v[16:19], v[196:199], v[144:147], v[16:19]
    ds_read_b128 v[72:75], v232 offset:18432
    v_mfma_f32_16x16x32_bf16 v[16:19], v[100:103], v[128:131], v[16:19]
    ds_read_b128 v[92:95], v232 offset:51200
    v_mfma_f32_16x16x32_bf16 v[32:35], v[104:107], v[128:131], v[32:35]
    ds_read_b128 v[76:79], v232 offset:19456
    v_mfma_f32_16x16x32_bf16 v[32:35], v[200:203], v[144:147], v[32:35]
    ds_read_b128 v[96:99], v232 offset:52224
    v_mfma_f32_16x16x32_bf16 v[36:39], v[200:203], v[148:151], v[36:39]
    ds_read_b64_tr_b16 v[116:117], v235 offset:57344
    v_mfma_f32_16x16x32_bf16 v[36:39], v[104:107], v[132:135], v[36:39]
    ds_read_b64_tr_b16 v[118:119], v235 offset:61440
    v_mfma_f32_16x16x32_bf16 v[40:43], v[104:107], v[136:139], v[40:43]
    ds_read_b64_tr_b16 v[180:181], v241 offset:0
    v_mfma_f32_16x16x32_bf16 v[40:43], v[200:203], v[152:155], v[40:43]
    ds_read_b64_tr_b16 v[182:183], v241 offset:4096
    v_mfma_f32_16x16x32_bf16 v[44:47], v[200:203], v[156:159], v[44:47]
    ds_read_b64_tr_b16 v[120:121], v236 offset:57344
    v_mfma_f32_16x16x32_bf16 v[44:47], v[104:107], v[140:143], v[44:47]
    ds_read_b64_tr_b16 v[122:123], v236 offset:61440
    v_mfma_f32_16x16x32_bf16 v[60:63], v[108:111], v[140:143], v[60:63]
    ds_read_b64_tr_b16 v[184:185], v242 offset:0
    v_mfma_f32_16x16x32_bf16 v[60:63], v[204:207], v[156:159], v[60:63]
    ds_read_b64_tr_b16 v[186:187], v242 offset:4096
    v_mfma_f32_16x16x32_bf16 v[56:59], v[204:207], v[152:155], v[56:59]
    ds_read_b64_tr_b16 v[124:125], v237 offset:57344
    v_mfma_f32_16x16x32_bf16 v[56:59], v[108:111], v[136:139], v[56:59]
    ds_read_b64_tr_b16 v[126:127], v237 offset:61440
    v_mfma_f32_16x16x32_bf16 v[52:55], v[108:111], v[132:135], v[52:55]
    ds_read_b64_tr_b16 v[188:189], v243 offset:0
    v_mfma_f32_16x16x32_bf16 v[52:55], v[204:207], v[148:151], v[52:55]
    ds_read_b64_tr_b16 v[190:191], v243 offset:4096
    v_mfma_f32_16x16x32_bf16 v[48:51], v[204:207], v[144:147], v[48:51]
    v_mfma_f32_16x16x32_bf16 v[48:51], v[108:111], v[128:131], v[48:51]
    s_waitcnt lgkmcnt(12)
    s_nop 0
    v_mfma_f32_16x16x32_bf16 v[0:3], v[112:115], v[64:67], v[0:3]
    v_mfma_f32_16x16x32_bf16 v[0:3], v[176:179], v[84:87], v[0:3]
    v_mfma_f32_16x16x32_bf16 v[4:7], v[176:179], v[88:91], v[4:7]
    v_mfma_f32_16x16x32_bf16 v[4:7], v[112:115], v[68:71], v[4:7]
    v_mfma_f32_16x16x32_bf16 v[8:11], v[112:115], v[72:75], v[8:11]
    v_mfma_f32_16x16x32_bf16 v[8:11], v[176:179], v[92:95], v[8:11]
    s_waitcnt lgkmcnt(0)
    s_barrier
    v_mfma_f32_16x16x32_bf16 v[12:15], v[176:179], v[96:99], v[12:15]
    ds_read_b64_tr_b16 v[80:81], v240 offset:8192
    ds_read_b64_tr_b16 v[82:83], v240 offset:12288
    v_mfma_f32_16x16x32_bf16 v[12:15], v[112:115], v[76:79], v[12:15]
    ds_read_b64_tr_b16 v[192:193], v240 offset:16384
    ds_read_b64_tr_b16 v[194:195], v240 offset:20480
    v_mfma_f32_16x16x32_bf16 v[28:31], v[116:119], v[76:79], v[28:31]
    ds_read_b64 v[128:129], v233 offset:24576
    v_mfma_f32_16x16x32_bf16 v[28:31], v[180:183], v[96:99], v[28:31]
    ds_read_b64 v[130:131], v233 offset:25088
    v_mfma_f32_16x16x32_bf16 v[24:27], v[180:183], v[92:95], v[24:27]
    ds_read_b128 v[144:147], v244 offset:24576
    v_mfma_f32_16x16x32_bf16 v[24:27], v[116:119], v[72:75], v[24:27]
    ds_read_b64 v[132:133], v233 offset:25600
    v_mfma_f32_16x16x32_bf16 v[20:23], v[116:119], v[68:71], v[20:23]
    ds_read_b64 v[134:135], v233 offset:26112
    v_mfma_f32_16x16x32_bf16 v[20:23], v[180:183], v[88:91], v[20:23]
    ds_read_b128 v[148:151], v244 offset:25600
    v_mfma_f32_16x16x32_bf16 v[16:19], v[180:183], v[84:87], v[16:19]
    ds_read_b64 v[136:137], v233 offset:26624
    v_mfma_f32_16x16x32_bf16 v[16:19], v[116:119], v[64:67], v[16:19]
    ds_read_b64 v[138:139], v233 offset:27136
    v_mfma_f32_16x16x32_bf16 v[32:35], v[120:123], v[64:67], v[32:35]
    ds_read_b128 v[152:155], v244 offset:26624
    v_mfma_f32_16x16x32_bf16 v[32:35], v[184:187], v[84:87], v[32:35]
    ds_read_b64 v[140:141], v233 offset:27648
    v_mfma_f32_16x16x32_bf16 v[36:39], v[184:187], v[88:91], v[36:39]
    ds_read_b64 v[142:143], v233 offset:28160
    v_mfma_f32_16x16x32_bf16 v[36:39], v[120:123], v[68:71], v[36:39]
    ds_read_b128 v[156:159], v244 offset:27648
    v_mfma_f32_16x16x32_bf16 v[40:43], v[120:123], v[72:75], v[40:43]
    ds_read_b64_tr_b16 v[100:101], v241 offset:8192
    v_mfma_f32_16x16x32_bf16 v[40:43], v[184:187], v[92:95], v[40:43]
    ds_read_b64_tr_b16 v[102:103], v241 offset:12288
    v_mfma_f32_16x16x32_bf16 v[44:47], v[184:187], v[96:99], v[44:47]
    ds_read_b64_tr_b16 v[196:197], v241 offset:16384
    v_mfma_f32_16x16x32_bf16 v[44:47], v[120:123], v[76:79], v[44:47]
    ds_read_b64_tr_b16 v[198:199], v241 offset:20480
    v_mfma_f32_16x16x32_bf16 v[60:63], v[124:127], v[76:79], v[60:63]
    ds_read_b64_tr_b16 v[104:105], v242 offset:8192
    v_mfma_f32_16x16x32_bf16 v[60:63], v[188:191], v[96:99], v[60:63]
    ds_read_b64_tr_b16 v[106:107], v242 offset:12288
    v_mfma_f32_16x16x32_bf16 v[56:59], v[188:191], v[92:95], v[56:59]
    ds_read_b64_tr_b16 v[200:201], v242 offset:16384
    v_mfma_f32_16x16x32_bf16 v[56:59], v[124:127], v[72:75], v[56:59]
    ds_read_b64_tr_b16 v[202:203], v242 offset:20480
    v_mfma_f32_16x16x32_bf16 v[52:55], v[124:127], v[68:71], v[52:55]
    ds_read_b64_tr_b16 v[108:109], v243 offset:8192
    v_mfma_f32_16x16x32_bf16 v[52:55], v[188:191], v[88:91], v[52:55]
    ds_read_b64_tr_b16 v[110:111], v243 offset:12288
    v_mfma_f32_16x16x32_bf16 v[48:51], v[188:191], v[84:87], v[48:51]
    ds_read_b64_tr_b16 v[204:205], v243 offset:16384
    v_mfma_f32_16x16x32_bf16 v[48:51], v[124:127], v[64:67], v[48:51]
    ds_read_b64_tr_b16 v[206:207], v243 offset:20480
    s_waitcnt lgkmcnt(12)
    s_nop 0
    v_mfma_f32_16x16x32_bf16 v[0:3], v[80:83], v[128:131], v[0:3]
    v_mfma_f32_16x16x32_bf16 v[0:3], v[192:195], v[144:147], v[0:3]
    v_mfma_f32_16x16x32_bf16 v[4:7], v[192:195], v[148:151], v[4:7]
    v_mfma_f32_16x16x32_bf16 v[4:7], v[80:83], v[132:135], v[4:7]
    v_mfma_f32_16x16x32_bf16 v[8:11], v[80:83], v[136:139], v[8:11]
    v_mfma_f32_16x16x32_bf16 v[8:11], v[192:195], v[152:155], v[8:11]
    s_waitcnt lgkmcnt(0)
    s_barrier
    v_mfma_f32_16x16x32_bf16 v[12:15], v[192:195], v[156:159], v[12:15]
    ds_read_b64_tr_b16 v[112:113], v240 offset:24576
    v_mfma_f32_16x16x32_bf16 v[12:15], v[80:83], v[140:143], v[12:15]
    ds_read_b64_tr_b16 v[114:115], v240 offset:28672
    v_mfma_f32_16x16x32_bf16 v[28:31], v[100:103], v[140:143], v[28:31]
    ds_read_b64_tr_b16 v[176:177], v240 offset:32768
    v_mfma_f32_16x16x32_bf16 v[28:31], v[196:199], v[156:159], v[28:31]
    ds_read_b64_tr_b16 v[178:179], v240 offset:36864
    v_mfma_f32_16x16x32_bf16 v[24:27], v[196:199], v[152:155], v[24:27]
    ds_read_b128 v[64:67], v232 offset:0
    v_mfma_f32_16x16x32_bf16 v[24:27], v[100:103], v[136:139], v[24:27]
    ds_read_b128 v[84:87], v232 offset:32768
    v_mfma_f32_16x16x32_bf16 v[20:23], v[100:103], v[132:135], v[20:23]
    ds_read_b128 v[68:71], v232 offset:1024
    v_mfma_f32_16x16x32_bf16 v[20:23], v[196:199], v[148:151], v[20:23]
    ds_read_b128 v[88:91], v232 offset:33792
    v_mfma_f32_16x16x32_bf16 v[16:19], v[196:199], v[144:147], v[16:19]
    ds_read_b128 v[72:75], v232 offset:2048
    v_mfma_f32_16x16x32_bf16 v[16:19], v[100:103], v[128:131], v[16:19]
    ds_read_b128 v[92:95], v232 offset:34816
    v_mfma_f32_16x16x32_bf16 v[32:35], v[104:107], v[128:131], v[32:35]
    ds_read_b128 v[76:79], v232 offset:3072
    v_mfma_f32_16x16x32_bf16 v[32:35], v[200:203], v[144:147], v[32:35]
    ds_read_b128 v[96:99], v232 offset:35840
    v_mfma_f32_16x16x32_bf16 v[36:39], v[200:203], v[148:151], v[36:39]
    ds_read_b64_tr_b16 v[116:117], v241 offset:24576
    v_mfma_f32_16x16x32_bf16 v[36:39], v[104:107], v[132:135], v[36:39]
    ds_read_b64_tr_b16 v[118:119], v241 offset:28672
    v_mfma_f32_16x16x32_bf16 v[40:43], v[104:107], v[136:139], v[40:43]
    ds_read_b64_tr_b16 v[180:181], v241 offset:32768
    v_mfma_f32_16x16x32_bf16 v[40:43], v[200:203], v[152:155], v[40:43]
    ds_read_b64_tr_b16 v[182:183], v241 offset:36864
    v_mfma_f32_16x16x32_bf16 v[44:47], v[200:203], v[156:159], v[44:47]
    ds_read_b64_tr_b16 v[120:121], v242 offset:24576
    v_mfma_f32_16x16x32_bf16 v[44:47], v[104:107], v[140:143], v[44:47]
    ds_read_b64_tr_b16 v[122:123], v242 offset:28672
    v_mfma_f32_16x16x32_bf16 v[60:63], v[108:111], v[140:143], v[60:63]
    ds_read_b64_tr_b16 v[184:185], v242 offset:32768
    v_mfma_f32_16x16x32_bf16 v[60:63], v[204:207], v[156:159], v[60:63]
    ds_read_b64_tr_b16 v[186:187], v242 offset:36864
    v_mfma_f32_16x16x32_bf16 v[56:59], v[204:207], v[152:155], v[56:59]
    ds_read_b64_tr_b16 v[124:125], v243 offset:24576
    v_mfma_f32_16x16x32_bf16 v[56:59], v[108:111], v[136:139], v[56:59]
    ds_read_b64_tr_b16 v[126:127], v243 offset:28672
    v_mfma_f32_16x16x32_bf16 v[52:55], v[108:111], v[132:135], v[52:55]
    ds_read_b64_tr_b16 v[188:189], v243 offset:32768
    v_mfma_f32_16x16x32_bf16 v[52:55], v[204:207], v[148:151], v[52:55]
    ds_read_b64_tr_b16 v[190:191], v243 offset:36864
    v_mfma_f32_16x16x32_bf16 v[48:51], v[204:207], v[144:147], v[48:51]
    v_mfma_f32_16x16x32_bf16 v[48:51], v[108:111], v[128:131], v[48:51]
    s_waitcnt lgkmcnt(12)
    s_nop 0
    v_mfma_f32_16x16x32_bf16 v[0:3], v[112:115], v[64:67], v[0:3]
    v_mfma_f32_16x16x32_bf16 v[0:3], v[176:179], v[84:87], v[0:3]
    v_mfma_f32_16x16x32_bf16 v[4:7], v[176:179], v[88:91], v[4:7]
    v_mfma_f32_16x16x32_bf16 v[4:7], v[112:115], v[68:71], v[4:7]
    v_mfma_f32_16x16x32_bf16 v[8:11], v[112:115], v[72:75], v[8:11]
    v_mfma_f32_16x16x32_bf16 v[8:11], v[176:179], v[92:95], v[8:11]
    s_waitcnt lgkmcnt(0)
    s_barrier
    v_mfma_f32_16x16x32_bf16 v[12:15], v[176:179], v[96:99], v[12:15]
    ds_read_b64_tr_b16 v[80:81], v240 offset:40960
    ds_read_b64_tr_b16 v[82:83], v240 offset:45056
    v_mfma_f32_16x16x32_bf16 v[12:15], v[112:115], v[76:79], v[12:15]
    ds_read_b64_tr_b16 v[192:193], v240 offset:49152
    ds_read_b64_tr_b16 v[194:195], v240 offset:53248
    v_mfma_f32_16x16x32_bf16 v[28:31], v[116:119], v[76:79], v[28:31]
    ds_read_b128 v[128:131], v232 offset:8192
    v_mfma_f32_16x16x32_bf16 v[28:31], v[180:183], v[96:99], v[28:31]
    ds_read_b64 v[144:145], v233 offset:40960
    v_mfma_f32_16x16x32_bf16 v[24:27], v[180:183], v[92:95], v[24:27]
    ds_read_b64 v[146:147], v233 offset:41472
    v_mfma_f32_16x16x32_bf16 v[24:27], v[116:119], v[72:75], v[24:27]
    ds_read_b128 v[132:135], v232 offset:9216
    v_mfma_f32_16x16x32_bf16 v[20:23], v[116:119], v[68:71], v[20:23]
    ds_read_b64 v[148:149], v233 offset:41984
    v_mfma_f32_16x16x32_bf16 v[20:23], v[180:183], v[88:91], v[20:23]
    ds_read_b64 v[150:151], v233 offset:42496
    v_mfma_f32_16x16x32_bf16 v[16:19], v[180:183], v[84:87], v[16:19]
    ds_read_b128 v[136:139], v232 offset:10240
    v_mfma_f32_16x16x32_bf16 v[16:19], v[116:119], v[64:67], v[16:19]
    ds_read_b64 v[152:153], v233 offset:43008
    v_mfma_f32_16x16x32_bf16 v[32:35], v[120:123], v[64:67], v[32:35]
    ds_read_b64 v[154:155], v233 offset:43520
    v_mfma_f32_16x16x32_bf16 v[32:35], v[184:187], v[84:87], v[32:35]
    ds_read_b128 v[140:143], v232 offset:11264
    v_mfma_f32_16x16x32_bf16 v[36:39], v[184:187], v[88:91], v[36:39]
    ds_read_b64 v[156:157], v233 offset:44032
    v_mfma_f32_16x16x32_bf16 v[36:39], v[120:123], v[68:71], v[36:39]
    ds_read_b64 v[158:159], v233 offset:44544
    v_mfma_f32_16x16x32_bf16 v[40:43], v[120:123], v[72:75], v[40:43]
    ds_read_b64_tr_b16 v[100:101], v241 offset:40960
    v_mfma_f32_16x16x32_bf16 v[40:43], v[184:187], v[92:95], v[40:43]
    ds_read_b64_tr_b16 v[102:103], v241 offset:45056
    v_mfma_f32_16x16x32_bf16 v[44:47], v[184:187], v[96:99], v[44:47]
    ds_read_b64_tr_b16 v[196:197], v241 offset:49152
    v_mfma_f32_16x16x32_bf16 v[44:47], v[120:123], v[76:79], v[44:47]
    ds_read_b64_tr_b16 v[198:199], v241 offset:53248
    v_mfma_f32_16x16x32_bf16 v[60:63], v[124:127], v[76:79], v[60:63]
    ds_read_b64_tr_b16 v[104:105], v242 offset:40960
    v_mfma_f32_16x16x32_bf16 v[60:63], v[188:191], v[96:99], v[60:63]
    ds_read_b64_tr_b16 v[106:107], v242 offset:45056
    v_mfma_f32_16x16x32_bf16 v[56:59], v[188:191], v[92:95], v[56:59]
    ds_read_b64_tr_b16 v[200:201], v242 offset:49152
    v_mfma_f32_16x16x32_bf16 v[56:59], v[124:127], v[72:75], v[56:59]
    ds_read_b64_tr_b16 v[202:203], v242 offset:53248
    v_mfma_f32_16x16x32_bf16 v[52:55], v[124:127], v[68:71], v[52:55]
    ds_read_b64_tr_b16 v[108:109], v243 offset:40960
    v_mfma_f32_16x16x32_bf16 v[52:55], v[188:191], v[88:91], v[52:55]
    ds_read_b64_tr_b16 v[110:111], v243 offset:45056
    v_mfma_f32_16x16x32_bf16 v[48:51], v[188:191], v[84:87], v[48:51]
    ds_read_b64_tr_b16 v[204:205], v243 offset:49152
    v_mfma_f32_16x16x32_bf16 v[48:51], v[124:127], v[64:67], v[48:51]
    ds_read_b64_tr_b16 v[206:207], v243 offset:53248
    s_waitcnt lgkmcnt(12)
    s_nop 0
    v_mfma_f32_16x16x32_bf16 v[0:3], v[80:83], v[128:131], v[0:3]
    v_mfma_f32_16x16x32_bf16 v[0:3], v[192:195], v[144:147], v[0:3]
    v_mfma_f32_16x16x32_bf16 v[4:7], v[192:195], v[148:151], v[4:7]
    v_mfma_f32_16x16x32_bf16 v[4:7], v[80:83], v[132:135], v[4:7]
    v_mfma_f32_16x16x32_bf16 v[8:11], v[80:83], v[136:139], v[8:11]
    v_mfma_f32_16x16x32_bf16 v[8:11], v[192:195], v[152:155], v[8:11]
    s_waitcnt lgkmcnt(0)
    s_barrier
    v_mfma_f32_16x16x32_bf16 v[12:15], v[192:195], v[156:159], v[12:15]
    ds_read_b64_tr_b16 v[112:113], v240 offset:57344
    v_mfma_f32_16x16x32_bf16 v[12:15], v[80:83], v[140:143], v[12:15]
    ds_read_b64_tr_b16 v[114:115], v240 offset:61440
    v_mfma_f32_16x16x32_bf16 v[28:31], v[100:103], v[140:143], v[28:31]
    ds_read_b64_tr_b16 v[176:177], v246 offset:0
    v_mfma_f32_16x16x32_bf16 v[28:31], v[196:199], v[156:159], v[28:31]
    ds_read_b64_tr_b16 v[178:179], v246 offset:4096
    v_mfma_f32_16x16x32_bf16 v[24:27], v[196:199], v[152:155], v[24:27]
    ds_read_b128 v[64:67], v232 offset:16384
    v_mfma_f32_16x16x32_bf16 v[24:27], v[100:103], v[136:139], v[24:27]
    ds_read_b128 v[84:87], v232 offset:49152
    v_mfma_f32_16x16x32_bf16 v[20:23], v[100:103], v[132:135], v[20:23]
    ds_read_b128 v[68:71], v232 offset:17408
    v_mfma_f32_16x16x32_bf16 v[20:23], v[196:199], v[148:151], v[20:23]
    ds_read_b128 v[88:91], v232 offset:50176
    v_mfma_f32_16x16x32_bf16 v[16:19], v[196:199], v[144:147], v[16:19]
    ds_read_b128 v[72:75], v232 offset:18432
    v_mfma_f32_16x16x32_bf16 v[16:19], v[100:103], v[128:131], v[16:19]
    ds_read_b128 v[92:95], v232 offset:51200
    v_mfma_f32_16x16x32_bf16 v[32:35], v[104:107], v[128:131], v[32:35]
    ds_read_b128 v[76:79], v232 offset:19456
    v_mfma_f32_16x16x32_bf16 v[32:35], v[200:203], v[144:147], v[32:35]
    ds_read_b128 v[96:99], v232 offset:52224
    v_mfma_f32_16x16x32_bf16 v[36:39], v[200:203], v[148:151], v[36:39]
    ds_read_b64_tr_b16 v[116:117], v241 offset:57344
    v_mfma_f32_16x16x32_bf16 v[36:39], v[104:107], v[132:135], v[36:39]
    ds_read_b64_tr_b16 v[118:119], v241 offset:61440
    v_mfma_f32_16x16x32_bf16 v[40:43], v[104:107], v[136:139], v[40:43]
    ds_read_b64_tr_b16 v[180:181], v247 offset:0
    v_mfma_f32_16x16x32_bf16 v[40:43], v[200:203], v[152:155], v[40:43]
    ds_read_b64_tr_b16 v[182:183], v247 offset:4096
    v_mfma_f32_16x16x32_bf16 v[44:47], v[200:203], v[156:159], v[44:47]
    ds_read_b64_tr_b16 v[120:121], v242 offset:57344
    v_mfma_f32_16x16x32_bf16 v[44:47], v[104:107], v[140:143], v[44:47]
    ds_read_b64_tr_b16 v[122:123], v242 offset:61440
    v_mfma_f32_16x16x32_bf16 v[60:63], v[108:111], v[140:143], v[60:63]
    ds_read_b64_tr_b16 v[184:185], v248 offset:0
    v_mfma_f32_16x16x32_bf16 v[60:63], v[204:207], v[156:159], v[60:63]
    ds_read_b64_tr_b16 v[186:187], v248 offset:4096
    v_mfma_f32_16x16x32_bf16 v[56:59], v[204:207], v[152:155], v[56:59]
    ds_read_b64_tr_b16 v[124:125], v243 offset:57344
    v_mfma_f32_16x16x32_bf16 v[56:59], v[108:111], v[136:139], v[56:59]
    ds_read_b64_tr_b16 v[126:127], v243 offset:61440
    v_mfma_f32_16x16x32_bf16 v[52:55], v[108:111], v[132:135], v[52:55]
    ds_read_b64_tr_b16 v[188:189], v249 offset:0
    v_mfma_f32_16x16x32_bf16 v[52:55], v[204:207], v[148:151], v[52:55]
    ds_read_b64_tr_b16 v[190:191], v249 offset:4096
    v_mfma_f32_16x16x32_bf16 v[48:51], v[204:207], v[144:147], v[48:51]
    v_mfma_f32_16x16x32_bf16 v[48:51], v[108:111], v[128:131], v[48:51]
    s_waitcnt lgkmcnt(12)
    s_nop 0
L_wp6:
    s_cbranch_vccnz L_warm_done
    s_nop 0
    v_mfma_f32_16x16x32_bf16 v[0:3], v[112:115], v[64:67], v[0:3]
    v_mfma_f32_16x16x32_bf16 v[0:3], v[176:179], v[84:87], v[0:3]
    v_mfma_f32_16x16x32_bf16 v[4:7], v[176:179], v[88:91], v[4:7]
    v_mfma_f32_16x16x32_bf16 v[4:7], v[112:115], v[68:71], v[4:7]
    v_mfma_f32_16x16x32_bf16 v[8:11], v[112:115], v[72:75], v[8:11]
    v_mfma_f32_16x16x32_bf16 v[8:11], v[176:179], v[92:95], v[8:11]
    s_waitcnt lgkmcnt(0)
    s_barrier
    v_mfma_f32_16x16x32_bf16 v[12:15], v[176:179], v[96:99], v[12:15]
    ds_read_b64_tr_b16 v[80:81], v246 offset:8192
    v_mfma_f32_16x16x32_bf16 v[12:15], v[112:115], v[76:79], v[12:15]
    ds_read_b64_tr_b16 v[82:83], v246 offset:12288
    v_mfma_f32_16x16x32_bf16 v[28:31], v[116:119], v[76:79], v[28:31]
    ds_read_b64_tr_b16 v[192:193], v246 offset:16384
    v_mfma_f32_16x16x32_bf16 v[28:31], v[180:183], v[96:99], v[28:31]
    ds_read_b64_tr_b16 v[194:195], v246 offset:20480
    v_mfma_f32_16x16x32_bf16 v[24:27], v[180:183], v[92:95], v[24:27]
    ds_read_b128 v[128:131], v232 offset:24576
    v_mfma_f32_16x16x32_bf16 v[24:27], v[116:119], v[72:75], v[24:27]
    ds_read_b128 v[144:147], v244 offset:24576
    v_mfma_f32_16x16x32_bf16 v[20:23], v[116:119], v[68:71], v[20:23]
    ds_read_b128 v[132:135], v232 offset:25600
    v_mfma_f32_16x16x32_bf16 v[20:23], v[180:183], v[88:91], v[20:23]
    ds_read_b128 v[148:151], v244 offset:25600
    v_mfma_f32_16x16x32_bf16 v[16:19], v[180:183], v[84:87], v[16:19]
    ds_read_b128 v[136:139], v232 offset:26624
    v_mfma_f32_16x16x32_bf16 v[16:19], v[116:119], v[64:67], v[16:19]
    ds_read_b128 v[152:155], v244 offset:26624
    v_mfma_f32_16x16x32_bf16 v[32:35], v[120:123], v[64:67], v[32:35]
    ds_read_b128 v[140:143], v232 offset:27648
    v_mfma_f32_16x16x32_bf16 v[32:35], v[184:187], v[84:87], v[32:35]
    ds_read_b128 v[156:159], v244 offset:27648
    v_mfma_f32_16x16x32_bf16 v[36:39], v[184:187], v[88:91], v[36:39]
    ds_read_b64_tr_b16 v[100:101], v247 offset:8192
    v_mfma_f32_16x16x32_bf16 v[36:39], v[120:123], v[68:71], v[36:39]
    ds_read_b64_tr_b16 v[102:103], v247 offset:12288
    v_mfma_f32_16x16x32_bf16 v[40:43], v[120:123], v[72:75], v[40:43]
    ds_read_b64_tr_b16 v[196:197], v247 offset:16384
    v_mfma_f32_16x16x32_bf16 v[40:43], v[184:187], v[92:95], v[40:43]
    ds_read_b64_tr_b16 v[198:199], v247 offset:20480
    v_mfma_f32_16x16x32_bf16 v[44:47], v[184:187], v[96:99], v[44:47]
    ds_read_b64_tr_b16 v[104:105], v248 offset:8192
    v_mfma_f32_16x16x32_bf16 v[44:47], v[120:123], v[76:79], v[44:47]
    ds_read_b64_tr_b16 v[106:107], v248 offset:12288
    v_mfma_f32_16x16x32_bf16 v[60:63], v[124:127], v[76:79], v[60:63]
    ds_read_b64_tr_b16 v[200:201], v248 offset:16384
    v_mfma_f32_16x16x32_bf16 v[60:63], v[188:191], v[96:99], v[60:63]
    ds_read_b64_tr_b16 v[202:203], v248 offset:20480
    v_mfma_f32_16x16x32_bf16 v[56:59], v[188:191], v[92:95], v[56:59]
    ds_read_b64_tr_b16 v[108:109], v249 offset:8192
    v_mfma_f32_16x16x32_bf16 v[56:59], v[124:127], v[72:75], v[56:59]
    ds_read_b64_tr_b16 v[110:111], v249 offset:12288
    v_mfma_f32_16x16x32_bf16 v[52:55], v[124:127], v[68:71], v[52:55]
    ds_read_b64_tr_b16 v[204:205], v249 offset:16384
    v_mfma_f32_16x16x32_bf16 v[52:55], v[188:191], v[88:91], v[52:55]
    ds_read_b64_tr_b16 v[206:207], v249 offset:20480
    v_mfma_f32_16x16x32_bf16 v[48:51], v[188:191], v[84:87], v[48:51]
    v_mfma_f32_16x16x32_bf16 v[48:51], v[124:127], v[64:67], v[48:51]
    s_waitcnt lgkmcnt(12)
    s_nop 0
    v_mfma_f32_16x16x32_bf16 v[0:3], v[80:83], v[128:131], v[0:3]
    v_mfma_f32_16x16x32_bf16 v[0:3], v[192:195], v[144:147], v[0:3]
    v_mfma_f32_16x16x32_bf16 v[4:7], v[192:195], v[148:151], v[4:7]
    v_mfma_f32_16x16x32_bf16 v[4:7], v[80:83], v[132:135], v[4:7]
    v_mfma_f32_16x16x32_bf16 v[8:11], v[80:83], v[136:139], v[8:11]
    v_mfma_f32_16x16x32_bf16 v[8:11], v[192:195], v[152:155], v[8:11]
    s_waitcnt lgkmcnt(0)
    s_barrier
    v_mfma_f32_16x16x32_bf16 v[12:15], v[192:195], v[156:159], v[12:15]
    ds_read_b64_tr_b16 v[112:113], v234 offset:57344
    ds_read_b64_tr_b16 v[114:115], v234 offset:61440
    v_mfma_f32_16x16x32_bf16 v[12:15], v[80:83], v[140:143], v[12:15]
    ds_read_b64_tr_b16 v[176:177], v240 offset:0
    ds_read_b64_tr_b16 v[178:179], v240 offset:4096
    v_mfma_f32_16x16x32_bf16 v[28:31], v[100:103], v[140:143], v[28:31]
    ds_read_b64 v[64:65], v233 offset:0
    v_mfma_f32_16x16x32_bf16 v[28:31], v[196:199], v[156:159], v[28:31]
    ds_read_b64 v[66:67], v233 offset:512
    v_mfma_f32_16x16x32_bf16 v[24:27], v[196:199], v[152:155], v[24:27]
    ds_read_b128 v[84:87], v232 offset:32768
    v_mfma_f32_16x16x32_bf16 v[24:27], v[100:103], v[136:139], v[24:27]
    ds_read_b64 v[68:69], v233 offset:1024
    v_mfma_f32_16x16x32_bf16 v[20:23], v[100:103], v[132:135], v[20:23]
    ds_read_b64 v[70:71], v233 offset:1536
    v_mfma_f32_16x16x32_bf16 v[20:23], v[196:199], v[148:151], v[20:23]
    ds_read_b128 v[88:91], v232 offset:33792
    v_mfma_f32_16x16x32_bf16 v[16:19], v[196:199], v[144:147], v[16:19]
    ds_read_b64 v[72:73], v233 offset:2048
    v_mfma_f32_16x16x32_bf16 v[16:19], v[100:103], v[128:131], v[16:19]
    ds_read_b64 v[74:75], v233 offset:2560
    v_mfma_f32_16x16x32_bf16 v[32:35], v[104:107], v[128:131], v[32:35]
    ds_read_b128 v[92:95], v232 offset:34816
    v_mfma_f32_16x16x32_bf16 v[32:35], v[200:203], v[144:147], v[32:35]
    ds_read_b64 v[76:77], v233 offset:3072
    v_mfma_f32_16x16x32_bf16 v[36:39], v[200:203], v[148:151], v[36:39]
    ds_read_b64 v[78:79], v233 offset:3584
    v_mfma_f32_16x16x32_bf16 v[36:39], v[104:107], v[132:135], v[36:39]
    ds_read_b128 v[96:99], v232 offset:35840
    v_mfma_f32_16x16x32_bf16 v[40:43], v[104:107], v[136:139], v[40:43]
    ds_read_b64_tr_b16 v[116:117], v235 offset:57344
    v_mfma_f32_16x16x32_bf16 v[40:43], v[200:203], v[152:155], v[40:43]
    ds_read_b64_tr_b16 v[118:119], v235 offset:61440
    v_mfma_f32_16x16x32_bf16 v[44:47], v[200:203], v[156:159], v[44:47]
    ds_read_b64_tr_b16 v[180:181], v241 offset:0
    v_mfma_f32_16x16x32_bf16 v[44:47], v[104:107], v[140:143], v[44:47]
    ds_read_b64_tr_b16 v[182:183], v241 offset:4096
    v_mfma_f32_16x16x32_bf16 v[60:63], v[108:111], v[140:143], v[60:63]
    ds_read_b64_tr_b16 v[120:121], v236 offset:57344
    v_mfma_f32_16x16x32_bf16 v[60:63], v[204:207], v[156:159], v[60:63]
    ds_read_b64_tr_b16 v[122:123], v236 offset:61440
    v_mfma_f32_16x16x32_bf16 v[56:59], v[204:207], v[152:155], v[56:59]
    ds_read_b64_tr_b16 v[184:185], v242 offset:0
    v_mfma_f32_16x16x32_bf16 v[56:59], v[108:111], v[136:139], v[56:59]
    ds_read_b64_tr_b16 v[186:187], v242 offset:4096
    v_mfma_f32_16x16x32_bf16 v[52:55], v[108:111], v[132:135], v[52:55]
    ds_read_b64_tr_b16 v[124:125], v237 offset:57344
    v_mfma_f32_16x16x32_bf16 v[52:55], v[204:207], v[148:151], v[52:55]
    ds_read_b64_tr_b16 v[126:127], v237 offset:61440
    v_mfma_f32_16x16x32_bf16 v[48:51], v[204:207], v[144:147], v[48:51]
    ds_read_b64_tr_b16 v[188:189], v243 offset:0
    v_mfma_f32_16x16x32_bf16 v[48:51], v[108:111], v[128:131], v[48:51]
    ds_read_b64_tr_b16 v[190:191], v243 offset:4096
    s_waitcnt lgkmcnt(12)
    s_nop 0
    v_mfma_f32_16x16x32_bf16 v[0:3], v[112:115], v[64:67], v[0:3]
    v_mfma_f32_16x16x32_bf16 v[0:3], v[176:179], v[84:87], v[0:3]
    v_mfma_f32_16x16x32_bf16 v[4:7], v[176:179], v[88:91], v[4:7]
    v_mfma_f32_16x16x32_bf16 v[4:7], v[112:115], v[68:71], v[4:7]
    v_mfma_f32_16x16x32_bf16 v[8:11], v[112:115], v[72:75], v[8:11]
    v_mfma_f32_16x16x32_bf16 v[8:11], v[176:179], v[92:95], v[8:11]
    s_waitcnt lgkmcnt(0)
    s_barrier
    v_mfma_f32_16x16x32_bf16 v[12:15], v[176:179], v[96:99], v[12:15]
    ds_read_b64_tr_b16 v[80:81], v240 offset:8192
    v_mfma_f32_16x16x32_bf16 v[12:15], v[112:115], v[76:79], v[12:15]
    ds_read_b64_tr_b16 v[82:83], v240 offset:12288
    v_mfma_f32_16x16x32_bf16 v[28:31], v[116:119], v[76:79], v[28:31]
    ds_read_b64_tr_b16 v[192:193], v240 offset:16384
    v_mfma_f32_16x16x32_bf16 v[28:31], v[180:183], v[96:99], v[28:31]
    ds_read_b64_tr_b16 v[194:195], v240 offset:20480
    v_mfma_f32_16x16x32_bf16 v[24:27], v[180:183], v[92:95], v[24:27]
    ds_read_b128 v[128:131], v232 offset:8192
    v_mfma_f32_16x16x32_bf16 v[24:27], v[116:119], v[72:75], v[24:27]
    ds_read_b128 v[144:147], v232 offset:40960
    v_mfma_f32_16x16x32_bf16 v[20:23], v[116:119], v[68:71], v[20:23]
    ds_read_b128 v[132:135], v232 offset:9216
    v_mfma_f32_16x16x32_bf16 v[20:23], v[180:183], v[88:91], v[20:23]
    ds_read_b128 v[148:151], v232 offset:41984
    v_mfma_f32_16x16x32_bf16 v[16:19], v[180:183], v[84:87], v[16:19]
    ds_read_b128 v[136:139], v232 offset:10240
    v_mfma_f32_16x16x32_bf16 v[16:19], v[116:119], v[64:67], v[16:19]
    ds_read_b128 v[152:155], v232 offset:43008
    v_mfma_f32_16x16x32_bf16 v[32:35], v[120:123], v[64:67], v[32:35]
    ds_read_b128 v[140:143], v232 offset:11264
    v_mfma_f32_16x16x32_bf16 v[32:35], v[184:187], v[84:87], v[32:35]
    ds_read_b128 v[156:159], v232 offset:44032
    v_mfma_f32_16x16x32_bf16 v[36:39], v[184:187], v[88:91], v[36:39]
    ds_read_b64_tr_b16 v[100:101], v241 offset:8192
    v_mfma_f32_16x16x32_bf16 v[36:39], v[120:123], v[68:71], v[36:39]
    ds_read_b64_tr_b16 v[102:103], v241 offset:12288
    v_mfma_f32_16x16x32_bf16 v[40:43], v[120:123], v[72:75], v[40:43]
    ds_read_b64_tr_b16 v[196:197], v241 offset:16384
    v_mfma_f32_16x16x32_bf16 v[40:43], v[184:187], v[92:95], v[40:43]
    ds_read_b64_tr_b16 v[198:199], v241 offset:20480
    v_mfma_f32_16x16x32_bf16 v[44:47], v[184:187], v[96:99], v[44:47]
    ds_read_b64_tr_b16 v[104:105], v242 offset:8192
    v_mfma_f32_16x16x32_bf16 v[44:47], v[120:123], v[76:79], v[44:47]
    ds_read_b64_tr_b16 v[106:107], v242 offset:12288
    v_mfma_f32_16x16x32_bf16 v[60:63], v[124:127], v[76:79], v[60:63]
    ds_read_b64_tr_b16 v[200:201], v242 offset:16384
    v_mfma_f32_16x16x32_bf16 v[60:63], v[188:191], v[96:99], v[60:63]
    ds_read_b64_tr_b16 v[202:203], v242 offset:20480
    v_mfma_f32_16x16x32_bf16 v[56:59], v[188:191], v[92:95], v[56:59]
    ds_read_b64_tr_b16 v[108:109], v243 offset:8192
    v_mfma_f32_16x16x32_bf16 v[56:59], v[124:127], v[72:75], v[56:59]
    ds_read_b64_tr_b16 v[110:111], v243 offset:12288
    v_mfma_f32_16x16x32_bf16 v[52:55], v[124:127], v[68:71], v[52:55]
    ds_read_b64_tr_b16 v[204:205], v243 offset:16384
    v_mfma_f32_16x16x32_bf16 v[52:55], v[188:191], v[88:91], v[52:55]
    ds_read_b64_tr_b16 v[206:207], v243 offset:20480
    v_mfma_f32_16x16x32_bf16 v[48:51], v[188:191], v[84:87], v[48:51]
    v_mfma_f32_16x16x32_bf16 v[48:51], v[124:127], v[64:67], v[48:51]
    s_waitcnt lgkmcnt(12)
    s_nop 0
    v_mfma_f32_16x16x32_bf16 v[0:3], v[80:83], v[128:131], v[0:3]
    v_mfma_f32_16x16x32_bf16 v[0:3], v[192:195], v[144:147], v[0:3]
    v_mfma_f32_16x16x32_bf16 v[4:7], v[192:195], v[148:151], v[4:7]
    v_mfma_f32_16x16x32_bf16 v[4:7], v[80:83], v[132:135], v[4:7]
    v_mfma_f32_16x16x32_bf16 v[8:11], v[80:83], v[136:139], v[8:11]
    v_mfma_f32_16x16x32_bf16 v[8:11], v[192:195], v[152:155], v[8:11]
    s_waitcnt lgkmcnt(0)
    s_barrier
    v_mfma_f32_16x16x32_bf16 v[12:15], v[192:195], v[156:159], v[12:15]
    ds_read_b64_tr_b16 v[112:113], v240 offset:24576
    ds_read_b64_tr_b16 v[114:115], v240 offset:28672
    v_mfma_f32_16x16x32_bf16 v[12:15], v[80:83], v[140:143], v[12:15]
    ds_read_b64_tr_b16 v[176:177], v240 offset:32768
    ds_read_b64_tr_b16 v[178:179], v240 offset:36864
    v_mfma_f32_16x16x32_bf16 v[28:31], v[100:103], v[140:143], v[28:31]
    ds_read_b128 v[64:67], v232 offset:16384
    v_mfma_f32_16x16x32_bf16 v[28:31], v[196:199], v[156:159], v[28:31]
    ds_read_b64 v[84:85], v233 offset:49152
    v_mfma_f32_16x16x32_bf16 v[24:27], v[196:199], v[152:155], v[24:27]
    ds_read_b64 v[86:87], v233 offset:49664
    v_mfma_f32_16x16x32_bf16 v[24:27], v[100:103], v[136:139], v[24:27]
    ds_read_b128 v[68:71], v232 offset:17408
    v_mfma_f32_16x16x32_bf16 v[20:23], v[100:103], v[132:135], v[20:23]
    ds_read_b64 v[88:89], v233 offset:50176
    v_mfma_f32_16x16x32_bf16 v[20:23], v[196:199], v[148:151], v[20:23]
    ds_read_b64 v[90:91], v233 offset:50688
    v_mfma_f32_16x16x32_bf16 v[16:19], v[196:199], v[144:147], v[16:19]
    ds_read_b128 v[72:75], v232 offset:18432
    v_mfma_f32_16x16x32_bf16 v[16:19], v[100:103], v[128:131], v[16:19]
    ds_read_b64 v[92:93], v233 offset:51200
    v_mfma_f32_16x16x32_bf16 v[32:35], v[104:107], v[128:131], v[32:35]
    ds_read_b64 v[94:95], v233 offset:51712
    v_mfma_f32_16x16x32_bf16 v[32:35], v[200:203], v[144:147], v[32:35]
    ds_read_b128 v[76:79], v232 offset:19456
    v_mfma_f32_16x16x32_bf16 v[36:39], v[200:203], v[148:151], v[36:39]
    ds_read_b64 v[96:97], v233 offset:52224
    v_mfma_f32_16x16x32_bf16 v[36:39], v[104:107], v[132:135], v[36:39]
    ds_read_b64 v[98:99], v233 offset:52736
    v_mfma_f32_16x16x32_bf16 v[40:43], v[104:107], v[136:139], v[40:43]
    ds_read_b64_tr_b16 v[116:117], v241 offset:24576
    v_mfma_f32_16x16x32_bf16 v[40:43], v[200:203], v[152:155], v[40:43]
    ds_read_b64_tr_b16 v[118:119], v241 offset:28672
    v_mfma_f32_16x16x32_bf16 v[44:47], v[200:203], v[156:159], v[44:47]
    ds_read_b64_tr_b16 v[180:181], v241 offset:32768
    v_mfma_f32_16x16x32_bf16 v[44:47], v[104:107], v[140:143], v[44:47]
    ds_read_b64_tr_b16 v[182:183], v241 offset:36864
    v_mfma_f32_16x16x32_bf16 v[60:63], v[108:111], v[140:143], v[60:63]
    ds_read_b64_tr_b16 v[120:121], v242 offset:24576
    v_mfma_f32_16x16x32_bf16 v[60:63], v[204:207], v[156:159], v[60:63]
    ds_read_b64_tr_b16 v[122:123], v242 offset:28672
    v_mfma_f32_16x16x32_bf16 v[56:59], v[204:207], v[152:155], v[56:59]
    ds_read_b64_tr_b16 v[184:185], v242 offset:32768
    v_mfma_f32_16x16x32_bf16 v[56:59], v[108:111], v[136:139], v[56:59]
    ds_read_b64_tr_b16 v[186:187], v242 offset:36864
    v_mfma_f32_16x16x32_bf16 v[52:55], v[108:111], v[132:135], v[52:55]
    ds_read_b64_tr_b16 v[124:125], v243 offset:24576
    v_mfma_f32_16x16x32_bf16 v[52:55], v[204:207], v[148:151], v[52:55]
    ds_read_b64_tr_b16 v[126:127], v243 offset:28672
    v_mfma_f32_16x16x32_bf16 v[48:51], v[204:207], v[144:147], v[48:51]
    ds_read_b64_tr_b16 v[188:189], v243 offset:32768
    v_mfma_f32_16x16x32_bf16 v[48:51], v[108:111], v[128:131], v[48:51]
    ds_read_b64_tr_b16 v[190:191], v243 offset:36864
    s_waitcnt lgkmcnt(12)
    s_nop 0
    v_mfma_f32_16x16x32_bf16 v[0:3], v[112:115], v[64:67], v[0:3]
    v_mfma_f32_16x16x32_bf16 v[0:3], v[176:179], v[84:87], v[0:3]
    v_mfma_f32_16x16x32_bf16 v[4:7], v[176:179], v[88:91], v[4:7]
    v_mfma_f32_16x16x32_bf16 v[4:7], v[112:115], v[68:71], v[4:7]
    v_mfma_f32_16x16x32_bf16 v[8:11], v[112:115], v[72:75], v[8:11]
    v_mfma_f32_16x16x32_bf16 v[8:11], v[176:179], v[92:95], v[8:11]
    s_waitcnt lgkmcnt(0)
    s_barrier
    v_mfma_f32_16x16x32_bf16 v[12:15], v[176:179], v[96:99], v[12:15]
    ds_read_b64_tr_b16 v[104:105], v242 offset:40960
    v_mfma_f32_16x16x32_bf16 v[12:15], v[112:115], v[76:79], v[12:15]
    ds_read_b64_tr_b16 v[106:107], v242 offset:45056
    v_mfma_f32_16x16x32_bf16 v[28:31], v[116:119], v[76:79], v[28:31]
    ds_read_b64_tr_b16 v[200:201], v242 offset:49152
    v_mfma_f32_16x16x32_bf16 v[28:31], v[180:183], v[96:99], v[28:31]
    ds_read_b64_tr_b16 v[202:203], v242 offset:53248
    v_mfma_f32_16x16x32_bf16 v[24:27], v[180:183], v[92:95], v[24:27]
    ds_read_b128 v[128:131], v232 offset:24576
    v_mfma_f32_16x16x32_bf16 v[24:27], v[116:119], v[72:75], v[24:27]
    ds_read_b128 v[144:147], v244 offset:24576
    v_mfma_f32_16x16x32_bf16 v[20:23], v[116:119], v[68:71], v[20:23]
    ds_read_b128 v[132:135], v232 offset:25600
    v_mfma_f32_16x16x32_bf16 v[20:23], v[180:183], v[88:91], v[20:23]
    ds_read_b128 v[148:151], v244 offset:25600
    v_mfma_f32_16x16x32_bf16 v[16:19], v[180:183], v[84:87], v[16:19]
    ds_read_b128 v[136:139], v232 offset:26624
    v_mfma_f32_16x16x32_bf16 v[16:19], v[116:119], v[64:67], v[16:19]
    ds_read_b128 v[152:155], v244 offset:26624
    v_mfma_f32_16x16x32_bf16 v[32:35], v[120:123], v[64:67], v[32:35]
    ds_read_b128 v[140:143], v232 offset:27648
    v_mfma_f32_16x16x32_bf16 v[32:35], v[184:187], v[84:87], v[32:35]
    ds_read_b128 v[156:159], v244 offset:27648
    v_mfma_f32_16x16x32_bf16 v[36:39], v[184:187], v[88:91], v[36:39]
    ds_read_b64_tr_b16 v[108:109], v243 offset:40960
    v_mfma_f32_16x16x32_bf16 v[36:39], v[120:123], v[68:71], v[36:39]
    ds_read_b64_tr_b16 v[110:111], v243 offset:45056
    v_mfma_f32_16x16x32_bf16 v[40:43], v[120:123], v[72:75], v[40:43]
    ds_read_b64_tr_b16 v[204:205], v243 offset:49152
    v_mfma_f32_16x16x32_bf16 v[40:43], v[184:187], v[92:95], v[40:43]
    ds_read_b64_tr_b16 v[206:207], v243 offset:53248
    v_mfma_f32_16x16x32_bf16 v[44:47], v[184:187], v[96:99], v[44:47]
    ds_read_b64_tr_b16 v[80:81], v240 offset:40960
    v_mfma_f32_16x16x32_bf16 v[44:47], v[120:123], v[76:79], v[44:47]
    ds_read_b64_tr_b16 v[82:83], v240 offset:45056
    v_mfma_f32_16x16x32_bf16 v[60:63], v[124:127], v[76:79], v[60:63]
    ds_read_b64_tr_b16 v[192:193], v240 offset:49152
    v_mfma_f32_16x16x32_bf16 v[60:63], v[188:191], v[96:99], v[60:63]
    ds_read_b64_tr_b16 v[194:195], v240 offset:53248
    v_mfma_f32_16x16x32_bf16 v[56:59], v[188:191], v[92:95], v[56:59]
    ds_read_b64_tr_b16 v[100:101], v241 offset:40960
    v_mfma_f32_16x16x32_bf16 v[56:59], v[124:127], v[72:75], v[56:59]
    ds_read_b64_tr_b16 v[102:103], v241 offset:45056
    v_mfma_f32_16x16x32_bf16 v[52:55], v[124:127], v[68:71], v[52:55]
    ds_read_b64_tr_b16 v[196:197], v241 offset:49152
    v_mfma_f32_16x16x32_bf16 v[52:55], v[188:191], v[88:91], v[52:55]
    ds_read_b64_tr_b16 v[198:199], v241 offset:53248
    v_mfma_f32_16x16x32_bf16 v[48:51], v[188:191], v[84:87], v[48:51]
    v_mfma_f32_16x16x32_bf16 v[48:51], v[124:127], v[64:67], v[48:51]
    s_waitcnt lgkmcnt(12)
    s_nop 0
    v_mfma_f32_16x16x32_bf16 v[32:35], v[104:107], v[128:131], v[32:35]
    v_lshlrev_b32_e64 v64, 16, v216
    v_mfma_f32_16x16x32_bf16 v[32:35], v[200:203], v[144:147], v[32:35]
    v_and_b32_e64 v65, s83, v216
    v_mfma_f32_16x16x32_bf16 v[36:39], v[200:203], v[148:151], v[36:39]
    v_lshlrev_b32_e64 v66, 16, v217
    v_mfma_f32_16x16x32_bf16 v[36:39], v[104:107], v[132:135], v[36:39]
    v_and_b32_e64 v67, s83, v217
    v_mfma_f32_16x16x32_bf16 v[40:43], v[104:107], v[136:139], v[40:43]
    v_lshlrev_b32_e64 v68, 16, v218
    v_mfma_f32_16x16x32_bf16 v[40:43], v[200:203], v[152:155], v[40:43]
    v_and_b32_e64 v69, s83, v218
    v_mfma_f32_16x16x32_bf16 v[44:47], v[200:203], v[156:159], v[44:47]
    v_lshlrev_b32_e64 v70, 16, v219
    v_mfma_f32_16x16x32_bf16 v[44:47], v[104:107], v[140:143], v[44:47]
    v_and_b32 v71, s83, v219
    s_waitcnt lgkmcnt(8)
    v_mfma_f32_16x16x32_bf16 v[60:63], v[108:111], v[140:143], v[60:63]
    v_mfma_f32_16x16x32_bf16 v[60:63], v[204:207], v[156:159], v[60:63]
    v_mfma_f32_16x16x32_bf16 v[56:59], v[204:207], v[152:155], v[56:59]
    v_mfma_f32_16x16x32_bf16 v[56:59], v[108:111], v[136:139], v[56:59]
    v_mfma_f32_16x16x32_bf16 v[52:55], v[108:111], v[132:135], v[52:55]
    v_mfma_f32_16x16x32_bf16 v[52:55], v[204:207], v[148:151], v[52:55]
    v_mfma_f32_16x16x32_bf16 v[48:51], v[204:207], v[144:147], v[48:51]
    v_mfma_f32_16x16x32_bf16 v[48:51], v[108:111], v[128:131], v[48:51]
    s_waitcnt lgkmcnt(4)
    s_nop 0
    v_mfma_f32_16x16x32_bf16 v[0:3], v[80:83], v[128:131], v[0:3]
    v_cvt_pk_bf16_f32 v96, v44, v45
    v_mfma_f32_16x16x32_bf16 v[0:3], v[192:195], v[144:147], v[0:3]
    v_cvt_pk_bf16_f32 v97, v46, v47
    v_mfma_f32_16x16x32_bf16 v[4:7], v[192:195], v[148:151], v[4:7]
    v_cvt_pk_bf16_f32 v98, v60, v61
    v_mfma_f32_16x16x32_bf16 v[4:7], v[80:83], v[132:135], v[4:7]
    v_cvt_pk_bf16_f32 v99, v62, v63
    v_mfma_f32_16x16x32_bf16 v[8:11], v[80:83], v[136:139], v[8:11]
    buffer_store_dwordx4 v[96:99], v231, s[40:43], s79 offen offset:3072 sc1
    v_cvt_pk_bf16_f32 v92, v40, v41
    v_mfma_f32_16x16x32_bf16 v[8:11], v[192:195], v[152:155], v[8:11]
    v_cvt_pk_bf16_f32 v93, v42, v43
    v_cvt_pk_bf16_f32 v94, v56, v57
    v_mfma_f32_16x16x32_bf16 v[12:15], v[192:195], v[156:159], v[12:15]
    v_cvt_pk_bf16_f32 v95, v58, v59
    buffer_store_dwordx4 v[92:95], v231, s[40:43], s79 offen offset:2048 sc1
    v_mfma_f32_16x16x32_bf16 v[12:15], v[80:83], v[140:143], v[12:15]
    v_cvt_pk_bf16_f32 v88, v36, v37
    v_cvt_pk_bf16_f32 v89, v38, v39
    s_waitcnt lgkmcnt(0)
    s_nop 0
    v_mfma_f32_16x16x32_bf16 v[28:31], v[100:103], v[140:143], v[28:31]
    v_cvt_pk_bf16_f32 v90, v52, v53
    v_cvt_pk_bf16_f32 v91, v54, v55
    v_mfma_f32_16x16x32_bf16 v[28:31], v[196:199], v[156:159], v[28:31]
    buffer_store_dwordx4 v[88:91], v231, s[40:43], s79 offen offset:1024 sc1
    v_cvt_pk_bf16_f32 v84, v32, v33
    v_mfma_f32_16x16x32_bf16 v[24:27], v[196:199], v[152:155], v[24:27]
    v_cvt_pk_bf16_f32 v85, v34, v35
    v_cvt_pk_bf16_f32 v86, v48, v49
    v_mfma_f32_16x16x32_bf16 v[24:27], v[100:103], v[136:139], v[24:27]
    v_cvt_pk_bf16_f32 v87, v50, v51
    buffer_store_dwordx4 v[84:87], v231, s[40:43], s79 offen offset:0 sc1
    v_mfma_f32_16x16x32_bf16 v[20:23], v[100:103], v[132:135], v[20:23]
    v_mfma_f32_16x16x32_bf16 v[20:23], v[196:199], v[148:151], v[20:23]
    v_mfma_f32_16x16x32_bf16 v[16:19], v[196:199], v[144:147], v[16:19]
    v_mfma_f32_16x16x32_bf16 v[16:19], v[100:103], v[128:131], v[16:19]
    s_nop 7
    s_nop 0
    v_pk_add_f32 v[0:1], v[0:1], v[64:65]
    v_pk_add_f32 v[2:3], v[2:3], v[66:67]
    v_pk_add_f32 v[4:5], v[4:5], v[64:65]
    v_pk_add_f32 v[6:7], v[6:7], v[66:67]
    v_pk_add_f32 v[8:9], v[8:9], v[64:65]
    v_pk_add_f32 v[10:11], v[10:11], v[66:67]
    v_pk_add_f32 v[12:13], v[12:13], v[64:65]
    v_pk_add_f32 v[14:15], v[14:15], v[66:67]
    v_pk_add_f32 v[16:17], v[16:17], v[68:69]
    v_pk_add_f32 v[18:19], v[18:19], v[70:71]
    v_pk_add_f32 v[20:21], v[20:21], v[68:69]
    v_pk_add_f32 v[22:23], v[22:23], v[70:71]
    v_pk_add_f32 v[24:25], v[24:25], v[68:69]
    v_pk_add_f32 v[26:27], v[26:27], v[70:71]
    v_pk_add_f32 v[28:29], v[28:29], v[68:69]
    v_pk_add_f32 v[30:31], v[30:31], v[70:71]
    s_waitcnt vmcnt(0)
    s_nop 0
    buffer_store_dword v255, v251, s[40:43], s81 offen sc1
    s_mov_b32 s71, 0
L_wp7:
    s_cbranch_vccnz L_warm_done
    s_nop 0
L_x_poll:
    s_nop 0
    buffer_load_dword v72, v251, s[40:43], s82 offen sc1
    s_add_u32 s71, s71, 1
    s_waitcnt vmcnt(0)
    v_cmp_ne_u32 vcc, 1, v72
    s_nop 0
    s_cmp_ge_u32 s71, 131072
    s_cbranch_scc1 L_x_go
    s_nop 0
    s_cbranch_vccnz L_x_poll
L_x_go:
    s_nop 0
    buffer_load_dwordx4 v[112:115], v231, s[40:43], s80 offen offset:0 sc1
    buffer_load_dwordx4 v[116:119], v231, s[40:43], s80 offen offset:1024 sc1
    buffer_load_dwordx4 v[120:123], v231, s[40:43], s80 offen offset:2048 sc1
    buffer_load_dwordx4 v[124:127], v231, s[40:43], s80 offen offset:3072 sc1
    s_waitcnt vmcnt(3)
    v_lshlrev_b32 v128, 16, v112
    v_and_b32 v129, s83, v112
    v_lshlrev_b32 v130, 16, v113
    v_and_b32 v131, s83, v113
    v_lshlrev_b32 v132, 16, v114
    v_and_b32 v133, s83, v114
    v_lshlrev_b32 v134, 16, v115
    v_and_b32_e64 v135, s83, v115
    v_pk_add_f32 v[0:1], v[0:1], v[128:129]
    v_pk_add_f32 v[2:3], v[2:3], v[130:131]
    v_pk_add_f32 v[16:17], v[16:17], v[132:133]
    v_pk_add_f32 v[18:19], v[18:19], v[134:135]
    v_cvt_pk_bf16_f32 v144, v0, v1
    v_cvt_pk_bf16_f32 v145, v2, v3
    v_cvt_pk_bf16_f32 v146, v16, v17
    v_cvt_pk_bf16_f32 v147, v18, v19
    s_nop 1
    v_permlane16_swap_b32 v144, v146
    v_permlane16_swap_b32 v145, v147
    s_nop 0
    buffer_store_dwordx4 v[144:147], v230, s[36:39], s75 offen
    s_waitcnt vmcnt(3)
    v_lshlrev_b32 v128, 16, v116
    v_and_b32 v129, s83, v116
    v_lshlrev_b32 v130, 16, v117
    v_and_b32 v131, s83, v117
    v_lshlrev_b32 v132, 16, v118
    v_and_b32 v133, s83, v118
    v_lshlrev_b32 v134, 16, v119
    v_and_b32_e64 v135, s83, v119
    v_pk_add_f32 v[4:5], v[4:5], v[128:129]
    v_pk_add_f32 v[6:7], v[6:7], v[130:131]
    v_pk_add_f32 v[20:21], v[20:21], v[132:133]
    v_pk_add_f32 v[22:23], v[22:23], v[134:135]
    v_cvt_pk_bf16_f32 v148, v4, v5
    v_cvt_pk_bf16_f32 v149, v6, v7
    v_cvt_pk_bf16_f32 v150, v20, v21
    v_cvt_pk_bf16_f32 v151, v22, v23
    s_nop 1
    v_permlane16_swap_b32 v148, v150
    v_permlane16_swap_b32 v149, v151
    s_nop 0
    buffer_store_dwordx4 v[148:151], v230, s[36:39], s76 offen
    s_waitcnt vmcnt(3)
    v_lshlrev_b32 v128, 16, v120
    v_and_b32 v129, s83, v120
    v_lshlrev_b32 v130, 16, v121
    v_and_b32 v131, s83, v121
    v_lshlrev_b32 v132, 16, v122
    v_and_b32 v133, s83, v122
    v_lshlrev_b32 v134, 16, v123
    v_and_b32_e64 v135, s83, v123
    v_pk_add_f32 v[8:9], v[8:9], v[128:129]
    v_pk_add_f32 v[10:11], v[10:11], v[130:131]
    v_pk_add_f32 v[24:25], v[24:25], v[132:133]
    v_pk_add_f32 v[26:27], v[26:27], v[134:135]
    v_cvt_pk_bf16_f32 v152, v8, v9
    v_cvt_pk_bf16_f32 v153, v10, v11
    v_cvt_pk_bf16_f32 v154, v24, v25
    v_cvt_pk_bf16_f32 v155, v26, v27
    s_nop 1
    v_permlane16_swap_b32 v152, v154
    v_permlane16_swap_b32 v153, v155
    s_nop 0
    buffer_store_dwordx4 v[152:155], v230, s[36:39], s77 offen
    s_waitcnt vmcnt(3)
    v_lshlrev_b32 v128, 16, v124
    v_and_b32 v129, s83, v124
    v_lshlrev_b32 v130, 16, v125
    v_and_b32 v131, s83, v125
    v_lshlrev_b32 v132, 16, v126
    v_and_b32 v133, s83, v126
    v_lshlrev_b32 v134, 16, v127
    v_and_b32_e64 v135, s83, v127
    v_pk_add_f32 v[12:13], v[12:13], v[128:129]
    v_pk_add_f32 v[14:15], v[14:15], v[130:131]
    v_pk_add_f32 v[28:29], v[28:29], v[132:133]
    v_pk_add_f32 v[30:31], v[30:31], v[134:135]
    v_cvt_pk_bf16_f32 v156, v12, v13
    v_cvt_pk_bf16_f32 v157, v14, v15
    v_cvt_pk_bf16_f32 v158, v28, v29
    v_cvt_pk_bf16_f32 v159, v30, v31
    s_nop 1
    v_permlane16_swap_b32 v156, v158
    v_permlane16_swap_b32 v157, v159
    s_nop 0
    buffer_store_dwordx4 v[156:159], v230, s[36:39], s78 offen
L_end:
    s_endpgm
L_codeend:
.section .rodata,"a"
.p2align 6
.amdhsa_kernel standalone__mixer_channel_mlp__prompt_kernel
  .amdhsa_next_free_vgpr 256
  .amdhsa_next_free_sgpr 102
  .amdhsa_accum_offset 256
  .amdhsa_group_segment_fixed_size 0
  .amdhsa_kernarg_size 64
  .amdhsa_user_sgpr_count 2
  .amdhsa_user_sgpr_kernarg_segment_ptr 1
  .amdhsa_system_sgpr_workgroup_id_x 1
  .amdhsa_float_denorm_mode_32 3
.end_amdhsa_kernel
```
